```python
import torch

def _softmax(x, axis=-1):
    return torch.softmax(x, dim=axis)
def _gelu(x):
    return torch.nn.functional.gelu(x, approximate="tanh")
def _silu(x):
    return torch.nn.functional.silu(x)
def _sigmoid(x):
    return torch.sigmoid(x)
def _layernorm(x, axis=-1, eps=1e-5):
    m = x.mean(dim=axis, keepdim=True)
    v = x.var(dim=axis, keepdim=True, unbiased=False)
    return (x - m) / torch.sqrt(v + eps)
def _scatter_add(tgt, idx, src, axis=0):
    return tgt.clone().index_add_(axis, idx, src)
def _segment_sum(src, seg, n):
    out = torch.zeros((n,) + src.shape[1:], dtype=src.dtype)
    return out.index_add_(0, seg, src)
def _pad(x, pw):
    flat = tuple(v for pair in reversed(pw) for v in pair)
    return torch.nn.functional.pad(x, flat)

kernel_name = 'recurrent_scan__linear_attn_block__glu_gated_geglu__prompt'

def setup_inputs():

    _w = (lambda a: (lambda t: t.to(torch.bfloat16) if t.is_floating_point() else t)(torch.as_tensor(a)))
    def _A_setup():
        B, S, D = 1, 2048, 640
        return {
            "x": _w((lambda *s: torch.randn(*s, dtype=torch.bfloat16) * 0.05)(B, S, D)),
            "wqkv": _w((lambda *s: torch.randn(*s, dtype=torch.bfloat16) * 0.8)(D, 3 * D)),
            "wo": _w((lambda *s: torch.randn(*s, dtype=torch.bfloat16) * 0.8)(D, D)),
        }
    _A_in = _A_setup()

    def _B_setup():
        B, S, Dm, Df = 1, 2048, 640, 1536
        return {
            "x": _w((lambda *s: torch.randn(*s, dtype=torch.bfloat16) * 0.05)(B, S, Dm)),
            "w_gate": _w((lambda *s: torch.randn(*s, dtype=torch.bfloat16) * 0.2)(Dm, Df) * (Dm ** -0.5)),
            "w_up": _w((lambda *s: torch.randn(*s, dtype=torch.bfloat16) * 0.2)(Dm, Df) * (Dm ** -0.5)),
            "w_down": _w((lambda *s: torch.randn(*s, dtype=torch.bfloat16) * 0.2)(Df, Dm) * (Df ** -0.5)),
        }
    _B_in = _B_setup()

    return {
        "A_x": _A_in["x"],
        "A_wqkv": _A_in["wqkv"],
        "A_wo": _A_in["wo"],
        "B_x": _B_in["x"],
        "B_w_gate": _B_in["w_gate"],
        "B_w_up": _B_in["w_up"],
        "B_w_down": _B_in["w_down"],
    }

def reference(A_x, A_wqkv, A_wo, B_x, B_w_gate, B_w_up, B_w_down):
    def _A_ref(x, wqkv, wo):
        B, S, D = x.shape
        H = 32; Dh = D // H
        qkv = (lambda x, *d: x.permute(*d))((x @ wqkv).reshape(B, S, 3, H, Dh), 2, 0, 3, 1, 4)
        q, k, v = qkv[0], qkv[1], qkv[2]
        phi = lambda t: torch.where(t > 0, t + 1, torch.exp(t)) + 1e-6
        pq, pk = phi(q), phi(k)
        kv = torch.einsum("bhsd,bhse->bhde", pk, v)
        z = torch.einsum("bhsd->bhd", pk)
        num = torch.einsum("bhqd,bhde->bhqe", pq, kv)
        den = torch.einsum("bhqd,bhd->bhq", pq, z)[..., None] + 1e-6
        o = num / den
        return (lambda x, *d: x.permute(*d))(o, 0, 2, 1, 3).reshape(B, S, D) @ wo

    def _B_ref(x, w_gate, w_up, w_down):
        g = torch.einsum("bsd,df->bsf", x, w_gate)
        u = torch.einsum("bsd,df->bsf", x, w_up)
        h = _gelu(g) * u
        return torch.einsum("bsf,fd->bsd", h, w_down)

    x = A_x
    xn = _layernorm(x, axis=-1)
    s = _A_ref(xn, A_wqkv, A_wo)
    g = _silu(_B_ref(xn, B_w_gate, B_w_up, B_w_down))
    return x + s * g
```

```asm
; @launch grid=(256,1,1) block=(512,1,1) lds=163840
.amdgcn_target "amdgcn-amd-amdhsa--gfx950"
.text
.globl recurrent_scan__linear_attn_block__glu_gated_geglu__prompt_kernel
.p2align 8
.type recurrent_scan__linear_attn_block__glu_gated_geglu__prompt_kernel,@function
recurrent_scan__linear_attn_block__glu_gated_geglu__prompt_kernel:
    s_cmp_ge_u32 s2, 192
    s_cbranch_scc1 K1_nq
K1GQ:
    s_load_dwordx16 s[4:19], s[0:1], 0
    s_load_dwordx2 s[22:23], s[0:1], 72
    s_getpc_b64 s[96:97]
    v_lshlrev_b32 v32, 7, v0
    v_min_u32 v32, (P2_end-K1GQ-64), v32
    global_load_dword v33, v32, s[96:97]
    v_lshrrev_b32 v39, 6, v0
    v_and_b32 v34, 63, v0
    v_lshrrev_b32 v40, 3, v0
    v_readfirstlane_b32 s98, v39
    v_and_b32 v36, 7, v0
    s_and_b32 s3, s2, 7
    s_lshr_b32 s68, s2, 3
    s_lshr_b32 s20, s3, 2
    s_lshl_b32 s20, s20, 3
    s_and_b32 s69, s68, 7
    s_add_u32 s20, s20, s69
    s_lshr_b32 s70, s68, 3
    s_lshl_b32 s21, s70, 2
    s_and_b32 s3, s3, 3
    s_add_u32 s21, s21, s3
    s_mul_i32 s70, s70, 3
    s_add_u32 s99, s69, s70
    s_cmp_ge_u32 s99, 10
    s_cselect_b32 s70, 10, 0
    s_sub_u32 s99, s99, s70
    s_lshl_b32 s101, s98, 10
    s_lshl_b32 s88, s99, 7
    s_mul_i32 s78, s99, 0x3c000
    s_add_u32 s99, s99, 1
    s_cmp_eq_u32 s99, 10
    s_cselect_b32 s99, 0, s99
    s_lshl_b32 s89, s99, 7
    s_mul_i32 s79, s99, 0x3c000
    s_add_u32 s99, s99, 1
    s_cmp_eq_u32 s99, 10
    s_cselect_b32 s99, 0, s99
    v_and_b32 v39, 2, v40
    v_lshlrev_b32 v39, 1, v39
    v_xor_b32 v39, v39, v36
    v_bfe_u32 v41, v40, 1, 3
    v_xor_b32 v41, v41, v36
    v_mul_u32_u24 v60, 0x500, v40
    v_lshl_add_u32 v60, v41, 4, v60
    v_mul_u32_u24 v61, 0xf00, v40
    v_lshl_add_u32 v61, v39, 4, v61
    s_waitcnt lgkmcnt(0)
    s_cmp_lt_u32 s21, 10
    s_cselect_b32 s11, 0, 10
    s_sub_u32 s11, s21, s11
    s_lshl_b32 s3, s11, 7
    s_add_u32 s48, s6, s3
    s_addc_u32 s49, s7, 0
    s_sub_u32 s50, 0x258000, s3
    s_mov_b32 s51, 0x20000
    s_mul_i32 s3, s20, 0x28000
    s_add_u32 s24, s4, s3
    s_addc_u32 s25, s5, 0
    s_sub_u32 s26, 0x280000, s3
    s_mov_b32 s27, 0x20000
    s_add_u32 s3, s3, 0x14000
    s_add_u32 s28, s4, s3
    s_addc_u32 s29, s5, 0
    s_sub_u32 s30, 0x280000, s3
    s_mov_b32 s31, 0x20000
    s_add_u32 m0, s101, 0
    s_nop 0
    buffer_load_dwordx4 v61, s[48:51], s78 offen lds
    s_add_u32 m0, s101, 0x10000
    s_nop 0
    buffer_load_dwordx4 v60, s[24:27], s88 offen lds
    s_add_u32 m0, s101, 0x12000
    s_nop 0
    buffer_load_dwordx4 v60, s[28:31], s88 offen lds
    s_add_u32 m0, s101, 0x2000
    s_nop 0
    buffer_load_dwordx4 v61, s[48:51], s79 offen lds
    s_add_u32 m0, s101, 0x14000
    s_nop 0
    buffer_load_dwordx4 v60, s[24:27], s89 offen lds
    s_add_u32 m0, s101, 0x16000
    s_nop 0
    buffer_load_dwordx4 v60, s[28:31], s89 offen lds
    s_lshl_b32 s90, s99, 7
    s_mul_i32 s80, s99, 0x3c000
    s_add_u32 s99, s99, 1
    s_cmp_eq_u32 s99, 10
    s_cselect_b32 s99, 0, s99
    s_lshl_b32 s91, s99, 7
    s_mul_i32 s81, s99, 0x3c000
    s_add_u32 s99, s99, 1
    s_cmp_eq_u32 s99, 10
    s_cselect_b32 s99, 0, s99
    s_lshl_b32 s92, s99, 7
    s_mul_i32 s82, s99, 0x3c000
    s_add_u32 s99, s99, 1
    s_cmp_eq_u32 s99, 10
    s_cselect_b32 s99, 0, s99
    s_lshl_b32 s93, s99, 7
    s_mul_i32 s83, s99, 0x3c000
    s_add_u32 s99, s99, 1
    s_cmp_eq_u32 s99, 10
    s_cselect_b32 s99, 0, s99
    s_lshl_b32 s94, s99, 7
    s_mul_i32 s84, s99, 0x3c000
    s_add_u32 s99, s99, 1
    s_cmp_eq_u32 s99, 10
    s_cselect_b32 s99, 0, s99
    s_lshl_b32 s95, s99, 7
    s_mul_i32 s85, s99, 0x3c000
    s_add_u32 s99, s99, 1
    s_cmp_eq_u32 s99, 10
    s_cselect_b32 s99, 0, s99
    s_lshl_b32 s96, s99, 7
    s_mul_i32 s86, s99, 0x3c000
    s_add_u32 s99, s99, 1
    s_cmp_eq_u32 s99, 10
    s_cselect_b32 s99, 0, s99
    s_lshl_b32 s97, s99, 7
    s_mul_i32 s87, s99, 0x3c000
    s_mul_i32 s68, s88, 0x600
    s_mul_i32 s69, s89, 0x600
    s_mul_i32 s70, s90, 0x600
    s_mul_i32 s71, s91, 0x600
    s_mul_i32 s72, s92, 0x600
    s_mul_i32 s73, s93, 0x600
    s_mul_i32 s74, s94, 0x600
    s_mul_i32 s75, s95, 0x600
    s_mul_i32 s76, s96, 0x600
    s_mul_i32 s77, s97, 0x600
    s_and_b32 s99, s98, 3
    s_lshr_b32 s100, s98, 2
    v_lshrrev_b32 v37, 5, v34
    v_and_b32 v38, 31, v34
    v_mul_u32_u24 v0, 0xc00, v40
    v_lshl_add_u32 v0, v39, 4, v0
    s_lshl_b32 s3, s21, 8
    s_add_u32 s32, s12, s3
    s_addc_u32 s33, s13, 0
    s_sub_u32 s34, 0x1e0000, s3
    s_mov_b32 s35, 0x20000
    s_add_u32 s40, s14, s3
    s_addc_u32 s41, s15, 0
    s_sub_u32 s42, 0x1e0000, s3
    s_mov_b32 s43, 0x20000
    s_add_u32 s3, s3, 0x80
    s_add_u32 s36, s12, s3
    s_addc_u32 s37, s13, 0
    s_sub_u32 s38, 0x1e0000, s3
    s_mov_b32 s39, 0x20000
    s_add_u32 s44, s14, s3
    s_addc_u32 s45, s15, 0
    s_sub_u32 s46, 0x1e0000, s3
    s_mov_b32 s47, 0x20000
    s_mul_i32 s3, s20, 0x60000
    s_lshl_b32 s10, s21, 12
    s_add_u32 s3, s3, s10
    s_add_u32 s52, s22, s3
    s_addc_u32 s53, s23, 0
    s_sub_u32 s54, 0x600000, s3
    s_mov_b32 s55, 0x20000
    s_mul_i32 s3, s20, 0x28000
    s_lshl_b32 s10, s11, 11
    s_add_u32 s3, s3, s10
    s_add_u32 s56, s22, s3
    s_addc_u32 s57, s23, 0
    s_add_u32 s56, s56, 0x600000
    s_addc_u32 s57, s57, 0
    s_sub_u32 s58, 0x280000, s3
    s_mov_b32 s59, 0x20000
    s_cmp_lt_u32 s21, 10
    s_cselect_b32 s58, s58, 0
    s_mov_b32 s10, 0x3f803f80
    v_and_b32 v39, 3, v34
    v_bfe_u32 v40, v34, 2, 2
    v_bfe_u32 v41, v34, 4, 1
    v_lshrrev_b32 v43, 1, v39
    v_lshl_add_u32 v43, v41, 1, v43
    s_lshl_b32 s3, s100, 2
    v_add_u32 v43, s3, v43
    v_lshrrev_b32 v44, 1, v40
    v_lshlrev_b32 v44, 2, v44
    v_xor_b32 v43, v43, v44
    v_lshl_add_u32 v44, v37, 3, v40
    v_lshlrev_b32 v44, 7, v44
    v_lshl_add_u32 v44, v43, 4, v44
    v_and_b32 v43, 1, v39
    v_lshl_add_u32 v44, v43, 3, v44
    s_lshl_b32 s5, s100, 1
    s_xor_b32 s5, s5, s99
    s_xor_b32 s3, s5, 0
    s_lshl_b32 s3, s3, 11
    v_add_u32 v16, s3, v44
    s_xor_b32 s3, s5, 1
    s_lshl_b32 s3, s3, 11
    v_add_u32 v17, s3, v44
    s_xor_b32 s3, s5, 2
    s_lshl_b32 s3, s3, 11
    v_add_u32 v18, s3, v44
    s_xor_b32 s3, s5, 3
    s_lshl_b32 s3, s3, 11
    v_add_u32 v19, s3, v44
    s_lshl_b32 s3, s99, 5
    v_add_u32 v43, s3, v38
    v_lshrrev_b32 v44, 1, v43
    v_and_b32 v44, 7, v44
    v_xor_b32 v44, v44, v37
    v_lshlrev_b32 v44, 4, v44
    v_lshl_add_u32 v44, v43, 7, v44
    s_xor_b32 s3, s5, 0
    s_lshl_b32 s3, s3, 5
    v_xor_b32 v48, s3, v44
    v_add_u32 v48, 0x18000, v48
    v_subrev_u32 v52, 0x8000, v48
    s_xor_b32 s3, s5, 1
    s_lshl_b32 s3, s3, 5
    v_xor_b32 v49, s3, v44
    v_add_u32 v49, 0x18000, v49
    v_subrev_u32 v53, 0x8000, v49
    s_xor_b32 s3, s5, 2
    s_lshl_b32 s3, s3, 5
    v_xor_b32 v50, s3, v44
    v_add_u32 v50, 0x18000, v50
    v_subrev_u32 v54, 0x8000, v50
    s_xor_b32 s3, s5, 3
    s_lshl_b32 s3, s3, 5
    v_xor_b32 v51, s3, v44
    v_add_u32 v51, 0x18000, v51
    v_subrev_u32 v55, 0x8000, v51
    v_lshlrev_b32 v56, 5, v43
    s_lshl_b32 s3, s100, 4
    s_add_u32 s3, s3, 0x25800
    v_lshl_add_u32 v56, v37, 3, v56
    v_add_u32 v56, s3, v56
    s_lshl_b32 s3, s98, 8
    s_add_u32 s3, s3, 0x25000
    v_lshl_add_u32 v7, v37, 4, s3
    s_lshl_b32 s3, s100, 7
    s_add_u32 s3, s3, s99
    s_lshl_b32 s3, s3, 3
    s_add_u32 s3, s3, 0x26800
    v_lshl_add_u32 v8, v37, 2, s3
    v_lshl_add_u32 v8, v38, 5, v8
    v_and_b32 v44, 15, v38
    v_lshlrev_b32 v44, 4, v44
    v_lshl_add_u32 v44, v37, 8, v44
    s_lshl_b32 s3, s100, 10
    v_add_u32 v44, s3, v44
    v_lshrrev_b32 v43, 4, v43
    v_mul_u32_u24 v2, 0x5000, v43
    v_add_u32 v2, v2, v44
    v_mov_b32 v5, 0
    v_mov_b32 v6, 0
    v_mov_b32 v58, 0
    v_mov_b32 v59, 0
    s_mul_i32 s3, s20, 12
    s_add_u32 s3, s3, s21
    s_lshl_b32 s3, s3, 2
    s_add_u32 s3, s3, s98
    s_cmp_lt_u32 s98, 4
    s_cselect_b32 s3, s3, 0x3e8
    s_mul_i32 s4, s3, 0x199a
    s_lshr_b32 s4, s4, 16
    s_mul_i32 s19, s4, 10
    s_sub_u32 s19, s3, s19
    s_cmp_lt_u32 s4, 48
    s_cselect_b32 s60, s16, s8
    s_cselect_b32 s61, s17, s9
    s_cselect_b32 s66, 0, 48
    s_cselect_b32 s62, 12, 5
    s_cselect_b32 s15, 1, 0
    s_mul_i32 s62, s62, 0x28000
    s_sub_u32 s66, s4, s66
    s_mul_i32 s66, s66, 0xa000
    s_lshl_b32 s18, s19, 7
    s_add_u32 s66, s66, s18
    s_add_u32 s60, s60, s66
    s_addc_u32 s61, s61, 0
    s_sub_u32 s62, s62, s66
    s_mov_b32 s63, 0x20000
    s_mul_i32 s4, s4, 0xa000
    s_lshl_b32 s19, s19, 12
    s_add_u32 s4, s4, s19
    s_add_u32 s64, s22, s4
    s_addc_u32 s65, s23, 0
    s_add_u32 s64, s64, 0xa00000
    s_addc_u32 s65, s65, 0
    s_sub_u32 s66, 0x2a8000, s4
    s_mov_b32 s67, 0x20000
    s_cmp_lt_u32 s3, 0x2a8
    s_cselect_b32 s62, s62, 0
    s_cselect_b32 s66, s66, 0
    s_lshl_b32 s18, s98, 12
    s_add_u32 s18, s18, 0x1c000
    s_lshl_b32 s12, s99, 10
    s_add_u32 s12, s12, 0x25800
    s_lshl_b32 s13, s100, 10
    s_add_u32 s13, s13, 0x26800
    s_lshl_b32 s14, s98, 8
    s_add_u32 s14, s14, 0x25000
    s_add_u32 m0, s101, 0x4000
    s_nop 0
    buffer_load_dwordx4 v61, s[48:51], s80 offen lds
    s_add_u32 m0, s101, 0x18000
    s_nop 0
    buffer_load_dwordx4 v60, s[24:27], s90 offen lds
    s_add_u32 m0, s101, 0x1a000
    s_nop 0
    buffer_load_dwordx4 v60, s[28:31], s90 offen lds
    s_load_dwordx2 s[8:9], s[0:1], 64
    v_mbcnt_lo_u32_b32 v84, -1, 0
    v_mbcnt_hi_u32_b32 v84, -1, v84
    v_lshlrev_b32 v84, 4, v84
    s_waitcnt lgkmcnt(0)
    s_waitcnt vmcnt(6)
    s_barrier
    ds_read_b128 v[96:99], v52
    ds_read_b64_tr_b16 v[20:21], v16
    ds_read_b64_tr_b16 v[22:23], v16 offset:512
    ds_read_b128 v[100:103], v53
    ds_read_b64_tr_b16 v[24:25], v17
    ds_read_b64_tr_b16 v[26:27], v17 offset:512
    ds_read_b128 v[104:107], v54
    ds_read_b64_tr_b16 v[28:29], v18
    ds_read_b64_tr_b16 v[30:31], v18 offset:512
    s_waitcnt vmcnt(3)
    s_waitcnt lgkmcnt(6)
    v_mfma_f32_32x32x16_bf16 v[64:79], v[20:23], v[96:99], 0
    s_barrier
    v_dot2c_f32_bf16 v5, s10, v20
    v_dot2c_f32_bf16 v5, s10, v21
    v_dot2c_f32_bf16 v5, s10, v22
    v_dot2c_f32_bf16 v5, s10, v23
    ds_read_b128 v[108:111], v55
    ds_read_b64_tr_b16 v[20:21], v19
    ds_read_b64_tr_b16 v[22:23], v19 offset:512
    v_dot2c_f32_bf16 v58, s10, v96
    v_dot2c_f32_bf16 v59, v96, v96
    v_dot2c_f32_bf16 v58, s10, v97
    v_dot2c_f32_bf16 v59, v97, v97
    v_dot2c_f32_bf16 v58, s10, v98
    v_dot2c_f32_bf16 v59, v98, v98
    v_dot2c_f32_bf16 v58, s10, v99
    v_dot2c_f32_bf16 v59, v99, v99
    s_add_u32 m0, s101, 0x6000
    s_nop 0
    buffer_load_dwordx4 v61, s[48:51], s81 offen lds
    s_waitcnt lgkmcnt(6)
    v_mfma_f32_32x32x16_bf16 v[64:79], v[24:27], v[100:103], v[64:79]
    ds_read_b128 v[112:115], v52 offset:16384
    ds_read_b64_tr_b16 v[24:25], v16 offset:8192
    ds_read_b64_tr_b16 v[26:27], v16 offset:8704
    s_add_u32 m0, s101, 0x1c000
    s_nop 0
    buffer_load_dwordx4 v60, s[24:27], s91 offen lds
    s_waitcnt lgkmcnt(6)
    v_mfma_f32_32x32x16_bf16 v[64:79], v[28:31], v[104:107], v[64:79]
    ds_read_b128 v[116:119], v53 offset:16384
    ds_read_b64_tr_b16 v[28:29], v17 offset:8192
    ds_read_b64_tr_b16 v[30:31], v17 offset:8704
    s_add_u32 m0, s101, 0x1e000
    s_nop 0
    buffer_load_dwordx4 v60, s[28:31], s91 offen lds
    s_waitcnt lgkmcnt(6)
    v_mfma_f32_32x32x16_bf16 v[64:79], v[20:23], v[108:111], v[64:79]
    ds_read_b128 v[120:123], v54 offset:16384
    ds_read_b64_tr_b16 v[20:21], v18 offset:8192
    ds_read_b64_tr_b16 v[22:23], v18 offset:8704
    s_add_u32 m0, s101, 0x8000
    s_nop 0
    buffer_load_dwordx4 v61, s[48:51], s82 offen lds
    s_waitcnt vmcnt(4)
    s_waitcnt lgkmcnt(6)
    v_mfma_f32_32x32x16_bf16 v[64:79], v[24:27], v[112:115], v[64:79]
    s_barrier
    v_dot2c_f32_bf16 v5, s10, v24
    v_dot2c_f32_bf16 v5, s10, v25
    v_dot2c_f32_bf16 v5, s10, v26
    v_dot2c_f32_bf16 v5, s10, v27
    ds_read_b128 v[124:127], v55 offset:16384
    ds_read_b64_tr_b16 v[24:25], v19 offset:8192
    ds_read_b64_tr_b16 v[26:27], v19 offset:8704
    v_dot2c_f32_bf16 v58, s10, v100
    v_dot2c_f32_bf16 v59, v100, v100
    v_dot2c_f32_bf16 v58, s10, v101
    v_dot2c_f32_bf16 v59, v101, v101
    v_dot2c_f32_bf16 v58, s10, v102
    v_dot2c_f32_bf16 v59, v102, v102
    v_dot2c_f32_bf16 v58, s10, v103
    v_dot2c_f32_bf16 v59, v103, v103
    v_dot2c_f32_bf16 v58, s10, v112
    v_dot2c_f32_bf16 v59, v112, v112
    v_dot2c_f32_bf16 v58, s10, v113
    v_dot2c_f32_bf16 v59, v113, v113
    v_dot2c_f32_bf16 v58, s10, v114
    v_dot2c_f32_bf16 v59, v114, v114
    v_dot2c_f32_bf16 v58, s10, v115
    v_dot2c_f32_bf16 v59, v115, v115
    s_add_u32 m0, s101, 0x20000
    s_nop 0
    buffer_load_dwordx4 v60, s[24:27], s92 offen lds
    s_waitcnt lgkmcnt(6)
    v_mfma_f32_32x32x16_bf16 v[64:79], v[28:31], v[116:119], v[64:79]
    ds_read_b128 v[128:131], v48
    ds_read_b64_tr_b16 v[28:29], v16 offset:16384
    ds_read_b64_tr_b16 v[30:31], v16 offset:16896
    s_add_u32 m0, s101, 0x22000
    s_nop 0
    buffer_load_dwordx4 v60, s[28:31], s92 offen lds
    s_waitcnt lgkmcnt(6)
    v_mfma_f32_32x32x16_bf16 v[64:79], v[20:23], v[120:123], v[64:79]
    ds_read_b128 v[132:135], v49
    ds_read_b64_tr_b16 v[20:21], v17 offset:16384
    ds_read_b64_tr_b16 v[22:23], v17 offset:16896
    s_add_u32 m0, s101, 0xa000
    s_nop 0
    buffer_load_dwordx4 v61, s[48:51], s83 offen lds
    s_waitcnt lgkmcnt(6)
    v_mfma_f32_32x32x16_bf16 v[64:79], v[24:27], v[124:127], v[64:79]
    ds_read_b128 v[136:139], v50
    ds_read_b64_tr_b16 v[24:25], v18 offset:16384
    ds_read_b64_tr_b16 v[26:27], v18 offset:16896
    s_add_u32 m0, s101, 0x10000
    s_nop 0
    buffer_load_dwordx4 v60, s[24:27], s93 offen lds
    s_waitcnt vmcnt(5)
    s_waitcnt lgkmcnt(6)
    v_mfma_f32_32x32x16_bf16 v[64:79], v[28:31], v[128:131], v[64:79]
    s_barrier
    v_dot2c_f32_bf16 v5, s10, v28
    v_dot2c_f32_bf16 v5, s10, v29
    v_dot2c_f32_bf16 v5, s10, v30
    v_dot2c_f32_bf16 v5, s10, v31
    ds_read_b128 v[140:143], v51
    ds_read_b64_tr_b16 v[28:29], v19 offset:16384
    ds_read_b64_tr_b16 v[30:31], v19 offset:16896
    v_dot2c_f32_bf16 v58, s10, v116
    v_dot2c_f32_bf16 v59, v116, v116
    v_dot2c_f32_bf16 v58, s10, v117
    v_dot2c_f32_bf16 v59, v117, v117
    v_dot2c_f32_bf16 v58, s10, v118
    v_dot2c_f32_bf16 v59, v118, v118
    v_dot2c_f32_bf16 v58, s10, v119
    v_dot2c_f32_bf16 v59, v119, v119
    v_dot2c_f32_bf16 v58, s10, v128
    v_dot2c_f32_bf16 v59, v128, v128
    v_dot2c_f32_bf16 v58, s10, v129
    v_dot2c_f32_bf16 v59, v129, v129
    v_dot2c_f32_bf16 v58, s10, v130
    v_dot2c_f32_bf16 v59, v130, v130
    v_dot2c_f32_bf16 v58, s10, v131
    v_dot2c_f32_bf16 v59, v131, v131
    s_add_u32 m0, s101, 0x12000
    s_nop 0
    buffer_load_dwordx4 v60, s[28:31], s93 offen lds
    s_waitcnt lgkmcnt(6)
    v_mfma_f32_32x32x16_bf16 v[64:79], v[20:23], v[132:135], v[64:79]
    ds_read_b128 v[144:147], v48 offset:16384
    ds_read_b64_tr_b16 v[20:21], v16 offset:24576
    ds_read_b64_tr_b16 v[22:23], v16 offset:25088
    s_add_u32 m0, s101, 0xc000
    s_nop 0
    buffer_load_dwordx4 v61, s[48:51], s84 offen lds
    s_waitcnt lgkmcnt(6)
    v_mfma_f32_32x32x16_bf16 v[64:79], v[24:27], v[136:139], v[64:79]
    ds_read_b128 v[148:151], v49 offset:16384
    ds_read_b64_tr_b16 v[24:25], v17 offset:24576
    ds_read_b64_tr_b16 v[26:27], v17 offset:25088
    s_add_u32 m0, s101, 0x14000
    s_nop 0
    buffer_load_dwordx4 v60, s[24:27], s94 offen lds
    s_waitcnt lgkmcnt(6)
    v_mfma_f32_32x32x16_bf16 v[64:79], v[28:31], v[140:143], v[64:79]
    ds_read_b128 v[152:155], v50 offset:16384
    ds_read_b64_tr_b16 v[28:29], v18 offset:24576
    ds_read_b64_tr_b16 v[30:31], v18 offset:25088
    s_add_u32 m0, s101, 0x16000
    s_nop 0
    buffer_load_dwordx4 v60, s[28:31], s94 offen lds
    s_waitcnt vmcnt(6)
    s_waitcnt lgkmcnt(6)
    v_mfma_f32_32x32x16_bf16 v[64:79], v[20:23], v[144:147], v[64:79]
    s_barrier
    v_dot2c_f32_bf16 v5, s10, v20
    v_dot2c_f32_bf16 v5, s10, v21
    v_dot2c_f32_bf16 v5, s10, v22
    v_dot2c_f32_bf16 v5, s10, v23
    ds_read_b128 v[156:159], v51 offset:16384
    ds_read_b64_tr_b16 v[20:21], v19 offset:24576
    ds_read_b64_tr_b16 v[22:23], v19 offset:25088
    v_dot2c_f32_bf16 v58, s10, v132
    v_dot2c_f32_bf16 v59, v132, v132
    v_dot2c_f32_bf16 v58, s10, v133
    v_dot2c_f32_bf16 v59, v133, v133
    v_dot2c_f32_bf16 v58, s10, v134
    v_dot2c_f32_bf16 v59, v134, v134
    v_dot2c_f32_bf16 v58, s10, v135
    v_dot2c_f32_bf16 v59, v135, v135
    v_dot2c_f32_bf16 v58, s10, v144
    v_dot2c_f32_bf16 v59, v144, v144
    v_dot2c_f32_bf16 v58, s10, v145
    v_dot2c_f32_bf16 v59, v145, v145
    v_dot2c_f32_bf16 v58, s10, v146
    v_dot2c_f32_bf16 v59, v146, v146
    v_dot2c_f32_bf16 v58, s10, v147
    v_dot2c_f32_bf16 v59, v147, v147
    s_add_u32 m0, s101, 0xe000
    s_nop 0
    buffer_load_dwordx4 v61, s[48:51], s85 offen lds
    s_waitcnt lgkmcnt(6)
    v_mfma_f32_32x32x16_bf16 v[64:79], v[24:27], v[148:151], v[64:79]
    ds_read_b128 v[160:163], v48 offset:32768
    ds_read_b64_tr_b16 v[24:25], v16 offset:32768
    ds_read_b64_tr_b16 v[26:27], v16 offset:33280
    s_add_u32 m0, s101, 0x18000
    s_nop 0
    buffer_load_dwordx4 v60, s[24:27], s95 offen lds
    s_waitcnt lgkmcnt(6)
    v_mfma_f32_32x32x16_bf16 v[64:79], v[28:31], v[152:155], v[64:79]
    ds_read_b128 v[164:167], v49 offset:32768
    ds_read_b64_tr_b16 v[28:29], v17 offset:32768
    ds_read_b64_tr_b16 v[30:31], v17 offset:33280
    s_add_u32 m0, s101, 0x1a000
    s_nop 0
    buffer_load_dwordx4 v60, s[28:31], s95 offen lds
    s_waitcnt lgkmcnt(6)
    v_mfma_f32_32x32x16_bf16 v[64:79], v[20:23], v[156:159], v[64:79]
    ds_read_b128 v[168:171], v50 offset:32768
    ds_read_b64_tr_b16 v[20:21], v18 offset:32768
    ds_read_b64_tr_b16 v[22:23], v18 offset:33280
    s_add_u32 m0, s101, 0
    s_nop 0
    buffer_load_dwordx4 v61, s[48:51], s86 offen lds
    s_waitcnt vmcnt(7)
    s_waitcnt lgkmcnt(6)
    v_mfma_f32_32x32x16_bf16 v[64:79], v[24:27], v[160:163], v[64:79]
    s_barrier
    v_dot2c_f32_bf16 v5, s10, v24
    v_dot2c_f32_bf16 v5, s10, v25
    v_dot2c_f32_bf16 v5, s10, v26
    v_dot2c_f32_bf16 v5, s10, v27
    ds_read_b128 v[172:175], v51 offset:32768
    ds_read_b64_tr_b16 v[24:25], v19 offset:32768
    ds_read_b64_tr_b16 v[26:27], v19 offset:33280
    v_dot2c_f32_bf16 v58, s10, v148
    v_dot2c_f32_bf16 v59, v148, v148
    v_dot2c_f32_bf16 v58, s10, v149
    v_dot2c_f32_bf16 v59, v149, v149
    v_dot2c_f32_bf16 v58, s10, v150
    v_dot2c_f32_bf16 v59, v150, v150
    v_dot2c_f32_bf16 v58, s10, v151
    v_dot2c_f32_bf16 v59, v151, v151
    v_dot2c_f32_bf16 v58, s10, v160
    v_dot2c_f32_bf16 v59, v160, v160
    v_dot2c_f32_bf16 v58, s10, v161
    v_dot2c_f32_bf16 v59, v161, v161
    v_dot2c_f32_bf16 v58, s10, v162
    v_dot2c_f32_bf16 v59, v162, v162
    v_dot2c_f32_bf16 v58, s10, v163
    v_dot2c_f32_bf16 v59, v163, v163
    s_add_u32 m0, s101, 0x1c000
    s_nop 0
    buffer_load_dwordx4 v60, s[24:27], s96 offen lds
    s_waitcnt lgkmcnt(6)
    v_mfma_f32_32x32x16_bf16 v[64:79], v[28:31], v[164:167], v[64:79]
    ds_read_b128 v[176:179], v52
    ds_read_b64_tr_b16 v[28:29], v16 offset:40960
    ds_read_b64_tr_b16 v[30:31], v16 offset:41472
    s_add_u32 m0, s101, 0x1e000
    s_nop 0
    buffer_load_dwordx4 v60, s[28:31], s96 offen lds
    s_waitcnt lgkmcnt(6)
    v_mfma_f32_32x32x16_bf16 v[64:79], v[20:23], v[168:171], v[64:79]
    ds_read_b128 v[180:183], v53
    ds_read_b64_tr_b16 v[20:21], v17 offset:40960
    ds_read_b64_tr_b16 v[22:23], v17 offset:41472
    s_add_u32 m0, s101, 0x2000
    s_nop 0
    buffer_load_dwordx4 v61, s[48:51], s87 offen lds
    s_waitcnt lgkmcnt(6)
    v_mfma_f32_32x32x16_bf16 v[64:79], v[24:27], v[172:175], v[64:79]
    ds_read_b128 v[184:187], v54
    ds_read_b64_tr_b16 v[24:25], v18 offset:40960
    ds_read_b64_tr_b16 v[26:27], v18 offset:41472
    s_add_u32 m0, s101, 0x4000
    s_nop 0
    buffer_load_dwordx4 v0, s[32:35], s68 offen lds
    s_waitcnt vmcnt(8)
    s_waitcnt lgkmcnt(6)
    v_mfma_f32_32x32x16_bf16 v[64:79], v[28:31], v[176:179], v[64:79]
    s_barrier
    v_dot2c_f32_bf16 v5, s10, v28
    v_dot2c_f32_bf16 v5, s10, v29
    v_dot2c_f32_bf16 v5, s10, v30
    v_dot2c_f32_bf16 v5, s10, v31
    ds_read_b128 v[188:191], v55
    ds_read_b64_tr_b16 v[28:29], v19 offset:40960
    ds_read_b64_tr_b16 v[30:31], v19 offset:41472
    v_dot2c_f32_bf16 v58, s10, v164
    v_dot2c_f32_bf16 v59, v164, v164
    v_dot2c_f32_bf16 v58, s10, v165
    v_dot2c_f32_bf16 v59, v165, v165
    v_dot2c_f32_bf16 v58, s10, v166
    v_dot2c_f32_bf16 v59, v166, v166
    v_dot2c_f32_bf16 v58, s10, v167
    v_dot2c_f32_bf16 v59, v167, v167
    v_dot2c_f32_bf16 v58, s10, v176
    v_dot2c_f32_bf16 v59, v176, v176
    v_dot2c_f32_bf16 v58, s10, v177
    v_dot2c_f32_bf16 v59, v177, v177
    v_dot2c_f32_bf16 v58, s10, v178
    v_dot2c_f32_bf16 v59, v178, v178
    v_dot2c_f32_bf16 v58, s10, v179
    v_dot2c_f32_bf16 v59, v179, v179
    s_add_u32 m0, s101, 0x20000
    s_nop 0
    buffer_load_dwordx4 v60, s[24:27], s97 offen lds
    s_waitcnt lgkmcnt(6)
    v_mfma_f32_32x32x16_bf16 v[64:79], v[20:23], v[180:183], v[64:79]
    ds_read_b128 v[192:195], v52 offset:16384
    ds_read_b64_tr_b16 v[20:21], v16 offset:49152
    ds_read_b64_tr_b16 v[22:23], v16 offset:49664
    s_add_u32 m0, s101, 0x22000
    s_nop 0
    buffer_load_dwordx4 v60, s[28:31], s97 offen lds
    s_waitcnt lgkmcnt(6)
    v_mfma_f32_32x32x16_bf16 v[64:79], v[24:27], v[184:187], v[64:79]
    ds_read_b128 v[196:199], v53 offset:16384
    ds_read_b64_tr_b16 v[24:25], v17 offset:49152
    ds_read_b64_tr_b16 v[26:27], v17 offset:49664
    s_add_u32 m0, s101, 0x6000
    s_nop 0
    buffer_load_dwordx4 v0, s[36:39], s68 offen lds
    s_waitcnt lgkmcnt(6)
    v_mfma_f32_32x32x16_bf16 v[64:79], v[28:31], v[188:191], v[64:79]
    ds_read_b128 v[200:203], v54 offset:16384
    ds_read_b64_tr_b16 v[28:29], v18 offset:49152
    ds_read_b64_tr_b16 v[30:31], v18 offset:49664
    s_add_u32 m0, s101, 0x8000
    s_nop 0
    buffer_load_dwordx4 v0, s[32:35], s69 offen lds
    s_waitcnt vmcnt(9)
    s_waitcnt lgkmcnt(6)
    v_mfma_f32_32x32x16_bf16 v[64:79], v[20:23], v[192:195], v[64:79]
    s_barrier
    v_dot2c_f32_bf16 v5, s10, v20
    v_dot2c_f32_bf16 v5, s10, v21
    v_dot2c_f32_bf16 v5, s10, v22
    v_dot2c_f32_bf16 v5, s10, v23
    ds_read_b128 v[204:207], v55 offset:16384
    ds_read_b64_tr_b16 v[20:21], v19 offset:49152
    ds_read_b64_tr_b16 v[22:23], v19 offset:49664
    v_dot2c_f32_bf16 v58, s10, v180
    v_dot2c_f32_bf16 v59, v180, v180
    v_dot2c_f32_bf16 v58, s10, v181
    v_dot2c_f32_bf16 v59, v181, v181
    v_dot2c_f32_bf16 v58, s10, v182
    v_dot2c_f32_bf16 v59, v182, v182
    v_dot2c_f32_bf16 v58, s10, v183
    v_dot2c_f32_bf16 v59, v183, v183
    v_dot2c_f32_bf16 v58, s10, v192
    v_dot2c_f32_bf16 v59, v192, v192
    v_dot2c_f32_bf16 v58, s10, v193
    v_dot2c_f32_bf16 v59, v193, v193
    v_dot2c_f32_bf16 v58, s10, v194
    v_dot2c_f32_bf16 v59, v194, v194
    v_dot2c_f32_bf16 v58, s10, v195
    v_dot2c_f32_bf16 v59, v195, v195
    s_add_u32 m0, s101, 0xa000
    s_nop 0
    buffer_load_dwordx4 v0, s[36:39], s69 offen lds
    s_waitcnt lgkmcnt(6)
    v_mfma_f32_32x32x16_bf16 v[64:79], v[24:27], v[196:199], v[64:79]
    ds_read_b128 v[208:211], v48
    ds_read_b64_tr_b16 v[24:25], v16 offset:57344
    ds_read_b64_tr_b16 v[26:27], v16 offset:57856
    s_waitcnt lgkmcnt(6)
    v_mfma_f32_32x32x16_bf16 v[64:79], v[28:31], v[200:203], v[64:79]
    ds_read_b128 v[212:215], v49
    ds_read_b64_tr_b16 v[28:29], v17 offset:57344
    ds_read_b64_tr_b16 v[30:31], v17 offset:57856
    s_waitcnt lgkmcnt(6)
    v_mfma_f32_32x32x16_bf16 v[64:79], v[20:23], v[204:207], v[64:79]
    ds_read_b128 v[216:219], v50
    ds_read_b64_tr_b16 v[20:21], v18 offset:57344
    ds_read_b64_tr_b16 v[22:23], v18 offset:57856
    s_waitcnt vmcnt(7)
    s_waitcnt lgkmcnt(6)
    v_mfma_f32_32x32x16_bf16 v[64:79], v[24:27], v[208:211], v[64:79]
    s_barrier
    v_dot2c_f32_bf16 v5, s10, v24
    v_dot2c_f32_bf16 v5, s10, v25
    v_dot2c_f32_bf16 v5, s10, v26
    v_dot2c_f32_bf16 v5, s10, v27
    ds_read_b128 v[220:223], v51
    ds_read_b64_tr_b16 v[24:25], v19 offset:57344
    ds_read_b64_tr_b16 v[26:27], v19 offset:57856
    v_dot2c_f32_bf16 v58, s10, v196
    v_dot2c_f32_bf16 v59, v196, v196
    v_dot2c_f32_bf16 v58, s10, v197
    v_dot2c_f32_bf16 v59, v197, v197
    v_dot2c_f32_bf16 v58, s10, v198
    v_dot2c_f32_bf16 v59, v198, v198
    v_dot2c_f32_bf16 v58, s10, v199
    v_dot2c_f32_bf16 v59, v199, v199
    v_dot2c_f32_bf16 v58, s10, v208
    v_dot2c_f32_bf16 v59, v208, v208
    v_dot2c_f32_bf16 v58, s10, v209
    v_dot2c_f32_bf16 v59, v209, v209
    v_dot2c_f32_bf16 v58, s10, v210
    v_dot2c_f32_bf16 v59, v210, v210
    v_dot2c_f32_bf16 v58, s10, v211
    v_dot2c_f32_bf16 v59, v211, v211
    s_add_u32 m0, s101, 0xc000
    s_nop 0
    buffer_load_dwordx4 v0, s[32:35], s70 offen lds
    s_waitcnt lgkmcnt(6)
    v_mfma_f32_32x32x16_bf16 v[64:79], v[28:31], v[212:215], v[64:79]
    ds_read_b128 v[224:227], v48 offset:16384
    ds_read_b64_tr_b16 v[28:29], v16
    ds_read_b64_tr_b16 v[30:31], v16 offset:512
    s_waitcnt lgkmcnt(6)
    v_mfma_f32_32x32x16_bf16 v[64:79], v[20:23], v[216:219], v[64:79]
    ds_read_b128 v[228:231], v49 offset:16384
    ds_read_b64_tr_b16 v[20:21], v17
    ds_read_b64_tr_b16 v[22:23], v17 offset:512
    s_waitcnt lgkmcnt(6)
    v_mfma_f32_32x32x16_bf16 v[64:79], v[24:27], v[220:223], v[64:79]
    ds_read_b128 v[232:235], v50 offset:16384
    ds_read_b64_tr_b16 v[24:25], v18
    ds_read_b64_tr_b16 v[26:27], v18 offset:512
    s_waitcnt vmcnt(4)
    s_waitcnt lgkmcnt(6)
    v_mfma_f32_32x32x16_bf16 v[64:79], v[28:31], v[224:227], v[64:79]
    s_barrier
    v_dot2c_f32_bf16 v5, s10, v28
    v_dot2c_f32_bf16 v5, s10, v29
    v_dot2c_f32_bf16 v5, s10, v30
    v_dot2c_f32_bf16 v5, s10, v31
    ds_read_b128 v[236:239], v51 offset:16384
    ds_read_b64_tr_b16 v[28:29], v19
    ds_read_b64_tr_b16 v[30:31], v19 offset:512
    v_dot2c_f32_bf16 v58, s10, v212
    v_dot2c_f32_bf16 v59, v212, v212
    v_dot2c_f32_bf16 v58, s10, v213
    v_dot2c_f32_bf16 v59, v213, v213
    v_dot2c_f32_bf16 v58, s10, v214
    v_dot2c_f32_bf16 v59, v214, v214
    v_dot2c_f32_bf16 v58, s10, v215
    v_dot2c_f32_bf16 v59, v215, v215
    v_dot2c_f32_bf16 v58, s10, v224
    v_dot2c_f32_bf16 v59, v224, v224
    v_dot2c_f32_bf16 v58, s10, v225
    v_dot2c_f32_bf16 v59, v225, v225
    v_dot2c_f32_bf16 v58, s10, v226
    v_dot2c_f32_bf16 v59, v226, v226
    v_dot2c_f32_bf16 v58, s10, v227
    v_dot2c_f32_bf16 v59, v227, v227
    s_add_u32 m0, s101, 0xe000
    s_nop 0
    buffer_load_dwordx4 v0, s[36:39], s70 offen lds
    s_waitcnt lgkmcnt(6)
    v_mfma_f32_32x32x16_bf16 v[64:79], v[20:23], v[228:231], v[64:79]
    ds_read_b128 v[240:243], v48 offset:32768
    ds_read_b64_tr_b16 v[20:21], v16 offset:8192
    ds_read_b64_tr_b16 v[22:23], v16 offset:8704
    s_waitcnt lgkmcnt(6)
    v_mfma_f32_32x32x16_bf16 v[64:79], v[24:27], v[232:235], v[64:79]
    ds_read_b128 v[244:247], v49 offset:32768
    ds_read_b64_tr_b16 v[24:25], v17 offset:8192
    ds_read_b64_tr_b16 v[26:27], v17 offset:8704
    s_waitcnt lgkmcnt(6)
    v_mfma_f32_32x32x16_bf16 v[64:79], v[28:31], v[236:239], v[64:79]
    ds_read_b128 v[248:251], v50 offset:32768
    ds_read_b64_tr_b16 v[28:29], v18 offset:8192
    ds_read_b64_tr_b16 v[30:31], v18 offset:8704
    s_waitcnt vmcnt(4)
    s_waitcnt lgkmcnt(6)
    v_mfma_f32_32x32x16_bf16 v[64:79], v[20:23], v[240:243], v[64:79]
    s_barrier
    v_dot2c_f32_bf16 v5, s10, v20
    v_dot2c_f32_bf16 v5, s10, v21
    v_dot2c_f32_bf16 v5, s10, v22
    v_dot2c_f32_bf16 v5, s10, v23
    ds_read_b128 v[252:255], v51 offset:32768
    ds_read_b64_tr_b16 v[20:21], v19 offset:8192
    ds_read_b64_tr_b16 v[22:23], v19 offset:8704
    v_dot2c_f32_bf16 v58, s10, v228
    v_dot2c_f32_bf16 v59, v228, v228
    v_dot2c_f32_bf16 v58, s10, v229
    v_dot2c_f32_bf16 v59, v229, v229
    v_dot2c_f32_bf16 v58, s10, v230
    v_dot2c_f32_bf16 v59, v230, v230
    v_dot2c_f32_bf16 v58, s10, v231
    v_dot2c_f32_bf16 v59, v231, v231
    v_dot2c_f32_bf16 v58, s10, v240
    v_dot2c_f32_bf16 v59, v240, v240
    v_dot2c_f32_bf16 v58, s10, v241
    v_dot2c_f32_bf16 v59, v241, v241
    v_dot2c_f32_bf16 v58, s10, v242
    v_dot2c_f32_bf16 v59, v242, v242
    v_dot2c_f32_bf16 v58, s10, v243
    v_dot2c_f32_bf16 v59, v243, v243
    s_waitcnt lgkmcnt(8)
    v_dot2c_f32_bf16 v58, s10, v244
    v_dot2c_f32_bf16 v59, v244, v244
    v_dot2c_f32_bf16 v58, s10, v245
    v_dot2c_f32_bf16 v59, v245, v245
    v_dot2c_f32_bf16 v58, s10, v246
    v_dot2c_f32_bf16 v59, v246, v246
    v_dot2c_f32_bf16 v58, s10, v247
    v_dot2c_f32_bf16 v59, v247, v247
    s_add_u32 m0, s101, 0
    s_nop 0
    buffer_load_dwordx4 v0, s[32:35], s71 offen lds
    s_waitcnt lgkmcnt(6)
    v_mfma_f32_32x32x16_bf16 v[64:79], v[24:27], v[244:247], v[64:79]
    ds_read_b64_tr_b16 v[24:25], v16 offset:16384
    ds_read_b64_tr_b16 v[26:27], v16 offset:16896
    ds_write_b32 v8, v5
    v_mov_b32 v5, 0
    ds_write_b64 v56, v[58:59]
    s_waitcnt lgkmcnt(7)
    v_mfma_f32_32x32x16_bf16 v[64:79], v[28:31], v[248:251], v[64:79]
    ds_read_b64_tr_b16 v[28:29], v16 offset:24576
    ds_read_b64_tr_b16 v[30:31], v16 offset:25088
    s_waitcnt lgkmcnt(6)
    v_mfma_f32_32x32x16_bf16 v[32:47], v[20:23], v[252:255], v[64:79]
    ds_read_b64_tr_b16 v[20:21], v17 offset:16384
    ds_read_b64_tr_b16 v[22:23], v17 offset:16896
    s_waitcnt vmcnt(3)
    s_waitcnt lgkmcnt(4)
    v_mfma_f32_32x32x16_bf16 v[64:79], v[24:27], v[96:99], 0
    s_barrier
    s_add_u32 m0, s101, 0x2000
    s_nop 0
    buffer_load_dwordx4 v0, s[36:39], s71 offen lds
    s_lshl_b32 s3, s20, 5
    s_add_u32 s3, s3, s21
    s_lshl_b32 s3, s3, 2
    s_add_u32 s24, s22, s3
    s_addc_u32 s25, s23, 0
    s_add_u32 s24, s24, 0x9c0000
    s_addc_u32 s25, s25, 0
    s_sub_u32 s26, 0x800, s3
    s_mov_b32 s27, 0x20000
    s_cmp_eq_u32 s98, 0
    s_cselect_b32 s26, 4, 0
    v_mbcnt_lo_u32_b32 v15, -1, 0
    v_mbcnt_hi_u32_b32 v15, -1, v15
    v_lshlrev_b32 v15, 2, v15
    v_mov_b32 v14, 0
    buffer_store_dword v14, v15, s[24:27], 0 offen sc1
    s_waitcnt lgkmcnt(2)
    v_mfma_f32_32x32x16_bf16 v[80:95], v[28:31], v[96:99], 0
    v_dot2c_f32_bf16 v5, s10, v24
    v_dot2c_f32_bf16 v5, s10, v25
    v_dot2c_f32_bf16 v5, s10, v26
    v_dot2c_f32_bf16 v5, s10, v27
    v_dot2c_f32_bf16 v6, s10, v28
    v_dot2c_f32_bf16 v6, s10, v29
    v_dot2c_f32_bf16 v6, s10, v30
    v_dot2c_f32_bf16 v6, s10, v31
    ds_read_b64_tr_b16 v[24:25], v17 offset:24576
    ds_read_b64_tr_b16 v[26:27], v17 offset:25088
    ds_read_b64_tr_b16 v[28:29], v18 offset:16384
    ds_read_b64_tr_b16 v[30:31], v18 offset:16896
    s_waitcnt lgkmcnt(4)
    v_mfma_f32_32x32x16_bf16 v[64:79], v[20:23], v[100:103], v[64:79]
    ds_read_b64_tr_b16 v[20:21], v18 offset:24576
    ds_read_b64_tr_b16 v[22:23], v18 offset:25088
    s_waitcnt lgkmcnt(4)
    v_mfma_f32_32x32x16_bf16 v[80:95], v[24:27], v[100:103], v[80:95]
    ds_read_b64_tr_b16 v[24:25], v19 offset:16384
    ds_read_b64_tr_b16 v[26:27], v19 offset:16896
    v_mbcnt_lo_u32_b32 v9, -1, 0
    v_mbcnt_hi_u32_b32 v9, -1, v9
    s_waitcnt lgkmcnt(4)
    v_mfma_f32_32x32x16_bf16 v[64:79], v[28:31], v[104:107], v[64:79]
    ds_read_b64_tr_b16 v[28:29], v19 offset:24576
    ds_read_b64_tr_b16 v[30:31], v19 offset:25088
    v_and_b32 v9, 31, v9
    v_lshl_add_u32 v9, v9, 5, s12
    ds_read_b128 v[48:51], v9
    ds_read_b128 v[52:55], v9 offset:16
    v_mbcnt_lo_u32_b32 v15, -1, 0
    v_mbcnt_hi_u32_b32 v15, -1, v15
    s_waitcnt lgkmcnt(6)
    v_mfma_f32_32x32x16_bf16 v[80:95], v[20:23], v[104:107], v[80:95]
    ds_read_b64_tr_b16 v[20:21], v16 offset:32768
    ds_read_b64_tr_b16 v[22:23], v16 offset:33280
    v_lshrrev_b32 v14, 3, v15
    v_mul_u32_u24 v14, 0x500, v14
    v_and_b32 v15, 7, v15
    v_lshl_add_u32 v14, v15, 4, v14
    s_add_u32 m0, s18, 0
    s_mov_b32 s3, 0
    buffer_load_dwordx4 v14, s[60:63], s3 offen lds
    s_waitcnt lgkmcnt(6)
    v_mfma_f32_32x32x16_bf16 v[64:79], v[24:27], v[108:111], v[64:79]
    ds_read_b64_tr_b16 v[24:25], v16 offset:40960
    ds_read_b64_tr_b16 v[26:27], v16 offset:41472
    s_add_u32 m0, s18, 0x400
    s_mov_b32 s3, 0x2800
    buffer_load_dwordx4 v14, s[60:63], s3 offen lds
    s_add_u32 m0, s18, 0x800
    s_mov_b32 s3, 0x5000
    buffer_load_dwordx4 v14, s[60:63], s3 offen lds
    s_waitcnt lgkmcnt(6)
    v_mfma_f32_32x32x16_bf16 v[80:95], v[28:31], v[108:111], v[80:95]
    ds_read_b64_tr_b16 v[28:29], v17 offset:32768
    ds_read_b64_tr_b16 v[30:31], v17 offset:33280
    s_add_u32 m0, s18, 0xc00
    s_mov_b32 s3, 0x7800
    buffer_load_dwordx4 v14, s[60:63], s3 offen lds
    v_mbcnt_lo_u32_b32 v14, -1, 0
    v_mbcnt_hi_u32_b32 v14, -1, v14
    v_lshrrev_b32 v15, 5, v14
    s_waitcnt vmcnt(7)
    s_waitcnt lgkmcnt(4)
    v_mfma_f32_32x32x16_bf16 v[64:79], v[20:23], v[112:115], v[64:79]
    s_barrier
    s_add_u32 m0, s101, 0x4000
    s_nop 0
    buffer_load_dwordx4 v0, s[32:35], s72 offen lds
    v_lshlrev_b32 v15, 10, v15
    v_lshl_add_u32 v15, v14, 5, v15
    v_add_u32 v15, s13, v15
    s_waitcnt lgkmcnt(2)
    v_mfma_f32_32x32x16_bf16 v[80:95], v[24:27], v[112:115], v[80:95]
    v_dot2c_f32_bf16 v5, s10, v20
    v_dot2c_f32_bf16 v5, s10, v21
    v_dot2c_f32_bf16 v5, s10, v22
    v_dot2c_f32_bf16 v5, s10, v23
    v_dot2c_f32_bf16 v6, s10, v24
    v_dot2c_f32_bf16 v6, s10, v25
    v_dot2c_f32_bf16 v6, s10, v26
    v_dot2c_f32_bf16 v6, s10, v27
    ds_read_b64_tr_b16 v[20:21], v17 offset:40960
    ds_read_b64_tr_b16 v[22:23], v17 offset:41472
    ds_read_b64_tr_b16 v[24:25], v18 offset:32768
    ds_read_b64_tr_b16 v[26:27], v18 offset:33280
    s_add_u32 m0, s101, 0x6000
    s_nop 0
    buffer_load_dwordx4 v0, s[36:39], s72 offen lds
    s_waitcnt lgkmcnt(4)
    v_mfma_f32_32x32x16_bf16 v[64:79], v[28:31], v[116:119], v[64:79]
    ds_read_b64_tr_b16 v[28:29], v18 offset:40960
    ds_read_b64_tr_b16 v[30:31], v18 offset:41472
    ds_read_b128 v[10:13], v15
    v_lshl_add_u32 v14, v14, 2, s14
    v_add_f32 v4, v48, v50
    v_add_f32 v3, v49, v51
    s_waitcnt lgkmcnt(5)
    v_mfma_f32_32x32x16_bf16 v[80:95], v[20:23], v[116:119], v[80:95]
    ds_read_b64_tr_b16 v[20:21], v19 offset:32768
    ds_read_b64_tr_b16 v[22:23], v19 offset:33280
    v_add_f32 v52, v52, v54
    v_add_f32 v53, v53, v55
    v_add_f32 v4, v4, v52
    v_add_f32 v3, v3, v53
    v_mul_f32 v4, 0x3acccccd, v4
    s_waitcnt lgkmcnt(5)
    v_mfma_f32_32x32x16_bf16 v[64:79], v[24:27], v[120:123], v[64:79]
    ds_read_b64_tr_b16 v[24:25], v19 offset:40960
    ds_read_b64_tr_b16 v[26:27], v19 offset:41472
    v_mul_f32 v3, 0x3acccccd, v3
    v_fma_f32 v3, -v4, v4, v3
    v_max_f32 v3, 0, v3
    s_waitcnt lgkmcnt(5)
    v_mfma_f32_32x32x16_bf16 v[80:95], v[28:31], v[120:123], v[80:95]
    ds_read_b64_tr_b16 v[28:29], v16 offset:49152
    ds_read_b64_tr_b16 v[30:31], v16 offset:49664
    s_waitcnt lgkmcnt(4)
    v_mfma_f32_32x32x16_bf16 v[64:79], v[20:23], v[124:127], v[64:79]
    ds_read_b64_tr_b16 v[20:21], v16 offset:57344
    ds_read_b64_tr_b16 v[22:23], v16 offset:57856
    v_add_f32 v1, v10, v11
    v_add_f32 v12, v12, v13
    v_add_f32 v1, v1, v12
    ds_read_b128 v[10:13], v15 offset:16
    v_cvt_pk_bf16_f32 v48, v4, v3
    v_lshlrev_b32 v4, 16, v48
    v_and_b32 v3, 0xffff0000, v48
    v_add_f32 v3, 0x3727c5ac, v3
    v_cvt_pk_bf16_f32 v48, v3, v3
    v_lshlrev_b32 v3, 16, v48
    v_sqrt_f32 v3, v3
    s_waitcnt lgkmcnt(5)
    v_mfma_f32_32x32x16_bf16 v[80:95], v[24:27], v[124:127], v[80:95]
    ds_read_b64_tr_b16 v[24:25], v17 offset:49152
    ds_read_b64_tr_b16 v[26:27], v17 offset:49664
    v_sub_f32 v4, 0, v4
    v_cvt_pk_bf16_f32 v48, v3, v3
    v_lshlrev_b32 v3, 16, v48
    v_rcp_f32 v3, v3
    s_waitcnt vmcnt(7)
    s_waitcnt lgkmcnt(5)
    v_mfma_f32_32x32x16_bf16 v[64:79], v[28:31], v[128:131], v[64:79]
    s_barrier
    s_add_u32 m0, s101, 0x8000
    s_nop 0
    buffer_load_dwordx4 v0, s[32:35], s73 offen lds
    s_waitcnt lgkmcnt(3)
    v_mfma_f32_32x32x16_bf16 v[80:95], v[20:23], v[128:131], v[80:95]
    v_dot2c_f32_bf16 v5, s10, v28
    v_dot2c_f32_bf16 v5, s10, v29
    v_dot2c_f32_bf16 v5, s10, v30
    v_dot2c_f32_bf16 v5, s10, v31
    v_dot2c_f32_bf16 v6, s10, v20
    v_dot2c_f32_bf16 v6, s10, v21
    v_dot2c_f32_bf16 v6, s10, v22
    v_dot2c_f32_bf16 v6, s10, v23
    ds_read_b64_tr_b16 v[28:29], v17 offset:57344
    ds_read_b64_tr_b16 v[30:31], v17 offset:57856
    ds_read_b64_tr_b16 v[20:21], v18 offset:49152
    ds_read_b64_tr_b16 v[22:23], v18 offset:49664
    s_add_u32 m0, s101, 0xa000
    s_nop 0
    buffer_load_dwordx4 v0, s[36:39], s73 offen lds
    s_waitcnt lgkmcnt(4)
    v_mfma_f32_32x32x16_bf16 v[64:79], v[24:27], v[132:135], v[64:79]
    ds_read_b64_tr_b16 v[24:25], v18 offset:57344
    ds_read_b64_tr_b16 v[26:27], v18 offset:57856
    v_add_f32 v10, v10, v11
    v_add_f32 v12, v12, v13
    v_add_f32 v1, v1, v10
    v_add_f32 v1, v1, v12
    ds_write_b32 v14, v1
    v_mbcnt_lo_u32_b32 v14, -1, 0
    v_mbcnt_hi_u32_b32 v14, -1, v14
    s_waitcnt lgkmcnt(5)
    v_mfma_f32_32x32x16_bf16 v[80:95], v[28:31], v[132:135], v[80:95]
    ds_read_b64_tr_b16 v[28:29], v19 offset:49152
    ds_read_b64_tr_b16 v[30:31], v19 offset:49664
    v_lshrrev_b32 v1, 4, v14
    v_lshlrev_b32 v15, 2, v1
    v_lshrrev_b32 v9, 1, v1
    v_lshlrev_b32 v9, 3, v9
    s_waitcnt lgkmcnt(5)
    v_mfma_f32_32x32x16_bf16 v[64:79], v[20:23], v[136:139], v[64:79]
    ds_read_b64_tr_b16 v[20:21], v19 offset:57344
    ds_read_b64_tr_b16 v[22:23], v19 offset:57856
    v_mul_u32_u24 v9, s15, v9
    v_add_u32 v15, v15, v9
    v_bfe_u32 v1, v14, 2, 2
    v_add_u32 v15, v15, v1
    v_lshlrev_b32 v15, 7, v15
    s_waitcnt lgkmcnt(5)
    v_mfma_f32_32x32x16_bf16 v[80:95], v[24:27], v[136:139], v[80:95]
    ds_read_b64_tr_b16 v[24:25], v16
    ds_read_b64_tr_b16 v[26:27], v16 offset:512
    v_and_b32 v1, 3, v14
    v_lshl_add_u32 v15, v1, 3, v15
    v_add_u32 v15, s18, v15
    s_lshl_b32 s3, s15, 10
    s_sub_u32 s3, 0x800, s3
    v_add_u32 v9, s3, v15
    s_waitcnt lgkmcnt(4)
    v_mfma_f32_32x32x16_bf16 v[64:79], v[28:31], v[140:143], v[64:79]
    ds_read_b64_tr_b16 v[28:29], v16 offset:8192
    ds_read_b64_tr_b16 v[30:31], v16 offset:8704
    v_lshlrev_b32 v14, 4, v14
    s_waitcnt vmcnt(4)
    ds_read_b64_tr_b16 v[48:49], v15
    ds_read_b64_tr_b16 v[50:51], v9
    ds_read_b64_tr_b16 v[52:53], v15 offset:32
    ds_read_b64_tr_b16 v[54:55], v9 offset:32
    ds_read_b64_tr_b16 v[56:57], v15 offset:64
    ds_read_b64_tr_b16 v[58:59], v9 offset:64
    ds_read_b64_tr_b16 v[60:61], v15 offset:96
    s_waitcnt lgkmcnt(11)
    v_mfma_f32_32x32x16_bf16 v[80:95], v[20:23], v[140:143], v[80:95]
    ds_read_b64_tr_b16 v[20:21], v17
    ds_read_b64_tr_b16 v[22:23], v17 offset:512
    ds_read_b64_tr_b16 v[62:63], v9 offset:96
    s_waitcnt vmcnt(2)
    s_waitcnt lgkmcnt(12)
    v_mfma_f32_32x32x16_bf16 v[64:79], v[24:27], v[144:147], v[64:79]
    s_barrier
    s_add_u32 m0, s101, 0xc000
    s_nop 0
    buffer_load_dwordx4 v0, s[32:35], s74 offen lds
    s_waitcnt lgkmcnt(10)
    v_mfma_f32_32x32x16_bf16 v[80:95], v[28:31], v[144:147], v[80:95]
    v_dot2c_f32_bf16 v5, s10, v24
    v_dot2c_f32_bf16 v5, s10, v25
    v_dot2c_f32_bf16 v5, s10, v26
    v_dot2c_f32_bf16 v5, s10, v27
    v_dot2c_f32_bf16 v6, s10, v28
    v_dot2c_f32_bf16 v6, s10, v29
    v_dot2c_f32_bf16 v6, s10, v30
    v_dot2c_f32_bf16 v6, s10, v31
    ds_read_b64_tr_b16 v[24:25], v17 offset:8192
    ds_read_b64_tr_b16 v[26:27], v17 offset:8704
    ds_read_b64_tr_b16 v[28:29], v18
    ds_read_b64_tr_b16 v[30:31], v18 offset:512
    s_add_u32 m0, s101, 0xe000
    s_nop 0
    buffer_load_dwordx4 v0, s[36:39], s74 offen lds
    s_waitcnt lgkmcnt(12)
    buffer_store_dwordx4 v[48:51], v14, s[64:67], 0 offen sc1
    s_waitcnt lgkmcnt(10)
    buffer_store_dwordx4 v[52:55], v14, s[64:67], 0 offen offset:1024 sc1
    s_waitcnt lgkmcnt(8)
    buffer_store_dwordx4 v[56:59], v14, s[64:67], 0 offen offset:2048 sc1
    s_waitcnt lgkmcnt(4)
    buffer_store_dwordx4 v[60:63], v14, s[64:67], 0 offen offset:3072 sc1
    ds_read_b128 v[10:13], v7
    v_mfma_f32_32x32x16_bf16 v[64:79], v[20:23], v[148:151], v[64:79]
    ds_read_b64_tr_b16 v[20:21], v18 offset:8192
    ds_read_b64_tr_b16 v[22:23], v18 offset:8704
    s_waitcnt lgkmcnt(5)
    v_mfma_f32_32x32x16_bf16 v[80:95], v[24:27], v[148:151], v[80:95]
    ds_read_b64_tr_b16 v[24:25], v19
    ds_read_b64_tr_b16 v[26:27], v19 offset:512
    s_waitcnt lgkmcnt(4)
    v_fmac_f32 v32, v4, v10
    v_fmac_f32 v33, v4, v11
    v_fmac_f32 v34, v4, v12
    v_fmac_f32 v35, v4, v13
    ds_read_b128 v[10:13], v7 offset:32
    v_mul_f32 v32, v3, v32
    v_mul_f32 v33, v3, v33
    v_mul_f32 v34, v3, v34
    v_mul_f32 v35, v3, v35
    v_mul_f32 v14, 0x3fb8aa3b, v32
    v_mul_f32 v15, 0x3fb8aa3b, v33
    v_mul_f32 v9, 0x3fb8aa3b, v34
    v_mfma_f32_32x32x16_bf16 v[64:79], v[28:31], v[152:155], v[64:79]
    ds_read_b64_tr_b16 v[28:29], v19 offset:8192
    ds_read_b64_tr_b16 v[30:31], v19 offset:8704
    v_mul_f32 v1, 0x3fb8aa3b, v35
    v_min_f32 v14, 0, v14
    v_min_f32 v15, 0, v15
    v_min_f32 v9, 0, v9
    v_min_f32 v1, 0, v1
    s_waitcnt lgkmcnt(5)
    v_mfma_f32_32x32x16_bf16 v[80:95], v[20:23], v[152:155], v[80:95]
    ds_read_b64_tr_b16 v[20:21], v16 offset:16384
    ds_read_b64_tr_b16 v[22:23], v16 offset:16896
    v_exp_f32 v14, v14
    v_exp_f32 v15, v15
    v_exp_f32 v9, v9
    s_waitcnt lgkmcnt(5)
    v_mfma_f32_32x32x16_bf16 v[64:79], v[24:27], v[156:159], v[64:79]
    ds_read_b64_tr_b16 v[24:25], v16 offset:24576
    ds_read_b64_tr_b16 v[26:27], v16 offset:25088
    v_exp_f32 v1, v1
    v_max_f32 v32, 0x358637bd, v32
    s_waitcnt lgkmcnt(4)
    v_mfma_f32_32x32x16_bf16 v[80:95], v[28:31], v[156:159], v[80:95]
    ds_read_b64_tr_b16 v[28:29], v17 offset:16384
    ds_read_b64_tr_b16 v[30:31], v17 offset:16896
    v_max_f32 v33, 0x358637bd, v33
    v_max_f32 v34, 0x358637bd, v34
    v_max_f32 v35, 0x358637bd, v35
    v_add_f32 v32, v32, v14
    v_add_f32 v33, v33, v15
    s_waitcnt vmcnt(6)
    s_waitcnt lgkmcnt(4)
    v_mfma_f32_32x32x16_bf16 v[64:79], v[20:23], v[160:163], v[64:79]
    s_barrier
    s_add_u32 m0, s101, 0
    s_nop 0
    buffer_load_dwordx4 v0, s[32:35], s75 offen lds
    v_add_f32 v34, v34, v9
    v_add_f32 v35, v35, v1
    v_cvt_pk_bf16_f32 v32, v32, v33
    v_cvt_pk_bf16_f32 v33, v34, v35
    s_waitcnt lgkmcnt(2)
    v_mfma_f32_32x32x16_bf16 v[80:95], v[24:27], v[160:163], v[80:95]
    v_dot2c_f32_bf16 v5, s10, v20
    v_dot2c_f32_bf16 v5, s10, v21
    v_dot2c_f32_bf16 v5, s10, v22
    v_dot2c_f32_bf16 v5, s10, v23
    v_dot2c_f32_bf16 v6, s10, v24
    v_dot2c_f32_bf16 v6, s10, v25
    v_dot2c_f32_bf16 v6, s10, v26
    v_dot2c_f32_bf16 v6, s10, v27
    ds_read_b64_tr_b16 v[20:21], v17 offset:24576
    ds_read_b64_tr_b16 v[22:23], v17 offset:25088
    ds_read_b64_tr_b16 v[24:25], v18 offset:16384
    ds_read_b64_tr_b16 v[26:27], v18 offset:16896
    s_add_u32 m0, s101, 0x2000
    s_nop 0
    buffer_load_dwordx4 v0, s[36:39], s75 offen lds
    s_waitcnt lgkmcnt(4)
    v_mfma_f32_32x32x16_bf16 v[64:79], v[28:31], v[164:167], v[64:79]
    ds_read_b64_tr_b16 v[28:29], v18 offset:24576
    ds_read_b64_tr_b16 v[30:31], v18 offset:25088
    v_fmac_f32 v36, v4, v10
    v_fmac_f32 v37, v4, v11
    v_fmac_f32 v38, v4, v12
    s_waitcnt lgkmcnt(4)
    v_mfma_f32_32x32x16_bf16 v[80:95], v[20:23], v[164:167], v[80:95]
    ds_read_b64_tr_b16 v[20:21], v19 offset:16384
    ds_read_b64_tr_b16 v[22:23], v19 offset:16896
    v_fmac_f32 v39, v4, v13
    ds_read_b128 v[10:13], v7 offset:64
    v_mul_f32 v36, v3, v36
    v_mul_f32 v37, v3, v37
    v_mul_f32 v38, v3, v38
    s_waitcnt lgkmcnt(5)
    v_mfma_f32_32x32x16_bf16 v[64:79], v[24:27], v[168:171], v[64:79]
    ds_read_b64_tr_b16 v[24:25], v19 offset:24576
    ds_read_b64_tr_b16 v[26:27], v19 offset:25088
    v_mul_f32 v39, v3, v39
    v_mul_f32 v14, 0x3fb8aa3b, v36
    v_mul_f32 v15, 0x3fb8aa3b, v37
    v_mul_f32 v9, 0x3fb8aa3b, v38
    v_mul_f32 v1, 0x3fb8aa3b, v39
    s_waitcnt lgkmcnt(5)
    v_mfma_f32_32x32x16_bf16 v[80:95], v[28:31], v[168:171], v[80:95]
    ds_read_b64_tr_b16 v[28:29], v16 offset:32768
    ds_read_b64_tr_b16 v[30:31], v16 offset:33280
    v_min_f32 v14, 0, v14
    v_min_f32 v15, 0, v15
    v_min_f32 v9, 0, v9
    v_min_f32 v1, 0, v1
    v_exp_f32 v14, v14
    s_waitcnt lgkmcnt(5)
    v_mfma_f32_32x32x16_bf16 v[64:79], v[20:23], v[172:175], v[64:79]
    ds_read_b64_tr_b16 v[20:21], v16 offset:40960
    ds_read_b64_tr_b16 v[22:23], v16 offset:41472
    v_exp_f32 v15, v15
    v_exp_f32 v9, v9
    s_waitcnt lgkmcnt(4)
    v_mfma_f32_32x32x16_bf16 v[80:95], v[24:27], v[172:175], v[80:95]
    ds_read_b64_tr_b16 v[24:25], v17 offset:32768
    ds_read_b64_tr_b16 v[26:27], v17 offset:33280
    v_exp_f32 v1, v1
    v_max_f32 v36, 0x358637bd, v36
    v_max_f32 v37, 0x358637bd, v37
    s_waitcnt vmcnt(6)
    s_waitcnt lgkmcnt(4)
    v_mfma_f32_32x32x16_bf16 v[64:79], v[28:31], v[176:179], v[64:79]
    s_barrier
    s_add_u32 m0, s101, 0x4000
    s_nop 0
    buffer_load_dwordx4 v0, s[32:35], s76 offen lds
    v_max_f32 v38, 0x358637bd, v38
    v_max_f32 v39, 0x358637bd, v39
    v_add_f32 v36, v36, v14
    v_add_f32 v37, v37, v15
    s_waitcnt lgkmcnt(2)
    v_mfma_f32_32x32x16_bf16 v[80:95], v[20:23], v[176:179], v[80:95]
    v_dot2c_f32_bf16 v5, s10, v28
    v_dot2c_f32_bf16 v5, s10, v29
    v_dot2c_f32_bf16 v5, s10, v30
    v_dot2c_f32_bf16 v5, s10, v31
    v_dot2c_f32_bf16 v6, s10, v20
    v_dot2c_f32_bf16 v6, s10, v21
    v_dot2c_f32_bf16 v6, s10, v22
    v_dot2c_f32_bf16 v6, s10, v23
    ds_read_b64_tr_b16 v[28:29], v17 offset:40960
    ds_read_b64_tr_b16 v[30:31], v17 offset:41472
    ds_read_b64_tr_b16 v[20:21], v18 offset:32768
    ds_read_b64_tr_b16 v[22:23], v18 offset:33280
    s_add_u32 m0, s101, 0x6000
    s_nop 0
    buffer_load_dwordx4 v0, s[36:39], s76 offen lds
    s_waitcnt lgkmcnt(4)
    v_mfma_f32_32x32x16_bf16 v[64:79], v[24:27], v[180:183], v[64:79]
    ds_read_b64_tr_b16 v[24:25], v18 offset:40960
    ds_read_b64_tr_b16 v[26:27], v18 offset:41472
    v_add_f32 v38, v38, v9
    v_add_f32 v39, v39, v1
    v_cvt_pk_bf16_f32 v34, v36, v37
    s_waitcnt lgkmcnt(4)
    v_mfma_f32_32x32x16_bf16 v[80:95], v[28:31], v[180:183], v[80:95]
    ds_read_b64_tr_b16 v[28:29], v19 offset:32768
    ds_read_b64_tr_b16 v[30:31], v19 offset:33280
    v_cvt_pk_bf16_f32 v35, v38, v39
    buffer_store_dwordx4 v[32:35], v2, s[56:59], 0 offen sc1
    v_fmac_f32 v40, v4, v10
    v_fmac_f32 v41, v4, v11
    v_fmac_f32 v42, v4, v12
    s_waitcnt lgkmcnt(4)
    v_mfma_f32_32x32x16_bf16 v[64:79], v[20:23], v[184:187], v[64:79]
    ds_read_b64_tr_b16 v[20:21], v19 offset:40960
    ds_read_b64_tr_b16 v[22:23], v19 offset:41472
    v_fmac_f32 v43, v4, v13
    ds_read_b128 v[10:13], v7 offset:96
    v_mul_f32 v40, v3, v40
    v_mul_f32 v41, v3, v41
    v_mul_f32 v42, v3, v42
    s_waitcnt lgkmcnt(5)
    v_mfma_f32_32x32x16_bf16 v[80:95], v[24:27], v[184:187], v[80:95]
    ds_read_b64_tr_b16 v[24:25], v16 offset:49152
    ds_read_b64_tr_b16 v[26:27], v16 offset:49664
    v_mul_f32 v43, v3, v43
    v_mul_f32 v14, 0x3fb8aa3b, v40
    v_mul_f32 v15, 0x3fb8aa3b, v41
    v_mul_f32 v9, 0x3fb8aa3b, v42
    v_mul_f32 v1, 0x3fb8aa3b, v43
    s_waitcnt lgkmcnt(5)
    v_mfma_f32_32x32x16_bf16 v[64:79], v[28:31], v[188:191], v[64:79]
    ds_read_b64_tr_b16 v[28:29], v16 offset:57344
    ds_read_b64_tr_b16 v[30:31], v16 offset:57856
    v_min_f32 v14, 0, v14
    v_min_f32 v15, 0, v15
    v_min_f32 v9, 0, v9
    v_min_f32 v1, 0, v1
    v_exp_f32 v14, v14
    s_waitcnt lgkmcnt(5)
    v_mfma_f32_32x32x16_bf16 v[80:95], v[20:23], v[188:191], v[80:95]
    ds_read_b64_tr_b16 v[20:21], v17 offset:49152
    ds_read_b64_tr_b16 v[22:23], v17 offset:49664
    v_exp_f32 v15, v15
    v_exp_f32 v9, v9
    s_waitcnt vmcnt(3)
    s_waitcnt lgkmcnt(4)
    v_mfma_f32_32x32x16_bf16 v[64:79], v[24:27], v[192:195], v[64:79]
    s_barrier
    s_add_u32 m0, s101, 0x8000
    s_nop 0
    buffer_load_dwordx4 v0, s[32:35], s77 offen lds
    v_exp_f32 v1, v1
    v_max_f32 v40, 0x358637bd, v40
    s_waitcnt lgkmcnt(2)
    v_mfma_f32_32x32x16_bf16 v[80:95], v[28:31], v[192:195], v[80:95]
    v_dot2c_f32_bf16 v5, s10, v24
    v_dot2c_f32_bf16 v5, s10, v25
    v_dot2c_f32_bf16 v5, s10, v26
    v_dot2c_f32_bf16 v5, s10, v27
    v_dot2c_f32_bf16 v6, s10, v28
    v_dot2c_f32_bf16 v6, s10, v29
    v_dot2c_f32_bf16 v6, s10, v30
    v_dot2c_f32_bf16 v6, s10, v31
    ds_read_b64_tr_b16 v[24:25], v17 offset:57344
    ds_read_b64_tr_b16 v[26:27], v17 offset:57856
    ds_read_b64_tr_b16 v[28:29], v18 offset:49152
    ds_read_b64_tr_b16 v[30:31], v18 offset:49664
    s_add_u32 m0, s101, 0xa000
    s_nop 0
    buffer_load_dwordx4 v0, s[36:39], s77 offen lds
    s_waitcnt lgkmcnt(4)
    v_mfma_f32_32x32x16_bf16 v[64:79], v[20:23], v[196:199], v[64:79]
    ds_read_b64_tr_b16 v[20:21], v18 offset:57344
    ds_read_b64_tr_b16 v[22:23], v18 offset:57856
    v_max_f32 v41, 0x358637bd, v41
    v_max_f32 v42, 0x358637bd, v42
    v_max_f32 v43, 0x358637bd, v43
    s_waitcnt lgkmcnt(4)
    v_mfma_f32_32x32x16_bf16 v[80:95], v[24:27], v[196:199], v[80:95]
    ds_read_b64_tr_b16 v[24:25], v19 offset:49152
    ds_read_b64_tr_b16 v[26:27], v19 offset:49664
    v_add_f32 v40, v40, v14
    v_add_f32 v41, v41, v15
    v_add_f32 v42, v42, v9
    v_add_f32 v43, v43, v1
    v_cvt_pk_bf16_f32 v40, v40, v41
    s_waitcnt lgkmcnt(4)
    v_mfma_f32_32x32x16_bf16 v[64:79], v[28:31], v[200:203], v[64:79]
    ds_read_b64_tr_b16 v[28:29], v19 offset:57344
    ds_read_b64_tr_b16 v[30:31], v19 offset:57856
    v_cvt_pk_bf16_f32 v41, v42, v43
    v_fmac_f32 v44, v4, v10
    v_fmac_f32 v45, v4, v11
    v_fmac_f32 v46, v4, v12
    v_fmac_f32 v47, v4, v13
    s_waitcnt lgkmcnt(4)
    v_mfma_f32_32x32x16_bf16 v[80:95], v[20:23], v[200:203], v[80:95]
    ds_read_b64_tr_b16 v[20:21], v16
    ds_read_b64_tr_b16 v[22:23], v16 offset:512
    v_mul_f32 v44, v3, v44
    v_mul_f32 v45, v3, v45
    v_mul_f32 v46, v3, v46
    v_mul_f32 v47, v3, v47
    v_mul_f32 v14, 0x3fb8aa3b, v44
    s_waitcnt lgkmcnt(4)
    v_mfma_f32_32x32x16_bf16 v[64:79], v[24:27], v[204:207], v[64:79]
    ds_read_b64_tr_b16 v[24:25], v16 offset:8192
    ds_read_b64_tr_b16 v[26:27], v16 offset:8704
    v_mul_f32 v15, 0x3fb8aa3b, v45
    v_mul_f32 v9, 0x3fb8aa3b, v46
    v_mul_f32 v1, 0x3fb8aa3b, v47
    v_min_f32 v14, 0, v14
    v_min_f32 v15, 0, v15
    s_waitcnt lgkmcnt(4)
    v_mfma_f32_32x32x16_bf16 v[80:95], v[28:31], v[204:207], v[80:95]
    ds_read_b64_tr_b16 v[28:29], v17
    ds_read_b64_tr_b16 v[30:31], v17 offset:512
    v_min_f32 v9, 0, v9
    v_min_f32 v1, 0, v1
    v_exp_f32 v14, v14
    s_waitcnt vmcnt(3)
    s_waitcnt lgkmcnt(4)
    v_mfma_f32_32x32x16_bf16 v[64:79], v[20:23], v[208:211], v[64:79]
    s_barrier
    s_add_u32 m0, s101, 0xc000
    s_nop 0
    buffer_load_dwordx4 v0, s[40:43], s68 offen lds
    v_exp_f32 v15, v15
    v_exp_f32 v9, v9
    s_waitcnt lgkmcnt(2)
    v_mfma_f32_32x32x16_bf16 v[80:95], v[24:27], v[208:211], v[80:95]
    v_dot2c_f32_bf16 v5, s10, v20
    v_dot2c_f32_bf16 v5, s10, v21
    v_dot2c_f32_bf16 v5, s10, v22
    v_dot2c_f32_bf16 v5, s10, v23
    v_dot2c_f32_bf16 v6, s10, v24
    v_dot2c_f32_bf16 v6, s10, v25
    v_dot2c_f32_bf16 v6, s10, v26
    v_dot2c_f32_bf16 v6, s10, v27
    ds_read_b64_tr_b16 v[20:21], v17 offset:8192
    ds_read_b64_tr_b16 v[22:23], v17 offset:8704
    ds_read_b64_tr_b16 v[24:25], v18
    ds_read_b64_tr_b16 v[26:27], v18 offset:512
    s_add_u32 m0, s101, 0xe000
    s_nop 0
    buffer_load_dwordx4 v0, s[44:47], s68 offen lds
    s_waitcnt lgkmcnt(4)
    v_mfma_f32_32x32x16_bf16 v[64:79], v[28:31], v[212:215], v[64:79]
    ds_read_b64_tr_b16 v[28:29], v18 offset:8192
    ds_read_b64_tr_b16 v[30:31], v18 offset:8704
    v_exp_f32 v1, v1
    v_max_f32 v44, 0x358637bd, v44
    s_waitcnt lgkmcnt(4)
    v_mfma_f32_32x32x16_bf16 v[80:95], v[20:23], v[212:215], v[80:95]
    ds_read_b64_tr_b16 v[20:21], v19
    ds_read_b64_tr_b16 v[22:23], v19 offset:512
    v_max_f32 v45, 0x358637bd, v45
    v_max_f32 v46, 0x358637bd, v46
    v_max_f32 v47, 0x358637bd, v47
    v_add_f32 v44, v44, v14
    v_add_f32 v45, v45, v15
    s_waitcnt lgkmcnt(4)
    v_mfma_f32_32x32x16_bf16 v[64:79], v[24:27], v[216:219], v[64:79]
    ds_read_b64_tr_b16 v[24:25], v19 offset:8192
    ds_read_b64_tr_b16 v[26:27], v19 offset:8704
    v_add_f32 v46, v46, v9
    v_add_f32 v47, v47, v1
    v_cvt_pk_bf16_f32 v42, v44, v45
    v_cvt_pk_bf16_f32 v43, v46, v47
    buffer_store_dwordx4 v[40:43], v2, s[56:59], 0 offen offset:512 sc1
    s_waitcnt lgkmcnt(4)
    v_mfma_f32_32x32x16_bf16 v[80:95], v[28:31], v[216:219], v[80:95]
    ds_read_b64_tr_b16 v[28:29], v16 offset:16384
    ds_read_b64_tr_b16 v[30:31], v16 offset:16896
    v_mbcnt_lo_u32_b32 v1, -1, 0
    v_mbcnt_hi_u32_b32 v1, -1, v1
    v_bfe_u32 v1, v1, 4, 1
    s_lshl_b32 s3, s99, 1
    v_add_u32 v1, s3, v1
    s_waitcnt lgkmcnt(4)
    v_mfma_f32_32x32x16_bf16 v[64:79], v[20:23], v[220:223], v[64:79]
    ds_read_b64_tr_b16 v[20:21], v16 offset:24576
    ds_read_b64_tr_b16 v[22:23], v16 offset:25088
    v_mul_u32_u24 v1, 0x7000, v1
    v_add_u32 v2, v2, v1
    s_waitcnt lgkmcnt(4)
    v_mfma_f32_32x32x16_bf16 v[80:95], v[24:27], v[220:223], v[80:95]
    ds_read_b64_tr_b16 v[24:25], v17 offset:16384
    ds_read_b64_tr_b16 v[26:27], v17 offset:16896
    s_waitcnt vmcnt(3)
    s_waitcnt lgkmcnt(4)
    v_mfma_f32_32x32x16_bf16 v[64:79], v[28:31], v[224:227], v[64:79]
    s_barrier
    s_add_u32 m0, s101, 0
    s_nop 0
    buffer_load_dwordx4 v0, s[40:43], s69 offen lds
    s_waitcnt lgkmcnt(2)
    v_mfma_f32_32x32x16_bf16 v[80:95], v[20:23], v[224:227], v[80:95]
    v_dot2c_f32_bf16 v5, s10, v28
    v_dot2c_f32_bf16 v5, s10, v29
    v_dot2c_f32_bf16 v5, s10, v30
    v_dot2c_f32_bf16 v5, s10, v31
    v_dot2c_f32_bf16 v6, s10, v20
    v_dot2c_f32_bf16 v6, s10, v21
    v_dot2c_f32_bf16 v6, s10, v22
    v_dot2c_f32_bf16 v6, s10, v23
    ds_read_b64_tr_b16 v[28:29], v17 offset:24576
    ds_read_b64_tr_b16 v[30:31], v17 offset:25088
    ds_read_b64_tr_b16 v[20:21], v18 offset:16384
    ds_read_b64_tr_b16 v[22:23], v18 offset:16896
    s_add_u32 m0, s101, 0x2000
    s_nop 0
    buffer_load_dwordx4 v0, s[44:47], s69 offen lds
    s_waitcnt lgkmcnt(4)
    v_mfma_f32_32x32x16_bf16 v[64:79], v[24:27], v[228:231], v[64:79]
    ds_read_b64_tr_b16 v[24:25], v18 offset:24576
    ds_read_b64_tr_b16 v[26:27], v18 offset:25088
    s_waitcnt lgkmcnt(4)
    v_mfma_f32_32x32x16_bf16 v[80:95], v[28:31], v[228:231], v[80:95]
    ds_read_b64_tr_b16 v[28:29], v19 offset:16384
    ds_read_b64_tr_b16 v[30:31], v19 offset:16896
    s_waitcnt lgkmcnt(4)
    v_mfma_f32_32x32x16_bf16 v[64:79], v[20:23], v[232:235], v[64:79]
    ds_read_b64_tr_b16 v[20:21], v19 offset:24576
    ds_read_b64_tr_b16 v[22:23], v19 offset:25088
    s_waitcnt lgkmcnt(4)
    v_mfma_f32_32x32x16_bf16 v[80:95], v[24:27], v[232:235], v[80:95]
    ds_read_b64_tr_b16 v[24:25], v16 offset:32768
    ds_read_b64_tr_b16 v[26:27], v16 offset:33280
    s_waitcnt lgkmcnt(4)
    v_mfma_f32_32x32x16_bf16 v[64:79], v[28:31], v[236:239], v[64:79]
    ds_read_b64_tr_b16 v[28:29], v16 offset:40960
    ds_read_b64_tr_b16 v[30:31], v16 offset:41472
    s_waitcnt lgkmcnt(4)
    v_mfma_f32_32x32x16_bf16 v[80:95], v[20:23], v[236:239], v[80:95]
    ds_read_b64_tr_b16 v[20:21], v17 offset:32768
    ds_read_b64_tr_b16 v[22:23], v17 offset:33280
    s_waitcnt vmcnt(3)
    s_waitcnt lgkmcnt(4)
    v_mfma_f32_32x32x16_bf16 v[64:79], v[24:27], v[240:243], v[64:79]
    s_barrier
    s_add_u32 m0, s101, 0x4000
    s_nop 0
    buffer_load_dwordx4 v0, s[40:43], s70 offen lds
    s_waitcnt lgkmcnt(2)
    v_mfma_f32_32x32x16_bf16 v[80:95], v[28:31], v[240:243], v[80:95]
    v_dot2c_f32_bf16 v5, s10, v24
    v_dot2c_f32_bf16 v5, s10, v25
    v_dot2c_f32_bf16 v5, s10, v26
    v_dot2c_f32_bf16 v5, s10, v27
    v_dot2c_f32_bf16 v6, s10, v28
    v_dot2c_f32_bf16 v6, s10, v29
    v_dot2c_f32_bf16 v6, s10, v30
    v_dot2c_f32_bf16 v6, s10, v31
    ds_read_b64_tr_b16 v[24:25], v17 offset:40960
    ds_read_b64_tr_b16 v[26:27], v17 offset:41472
    ds_read_b64_tr_b16 v[28:29], v18 offset:32768
    ds_read_b64_tr_b16 v[30:31], v18 offset:33280
    s_add_u32 m0, s101, 0x6000
    s_nop 0
    buffer_load_dwordx4 v0, s[44:47], s70 offen lds
    s_waitcnt lgkmcnt(4)
    v_mfma_f32_32x32x16_bf16 v[64:79], v[20:23], v[244:247], v[64:79]
    ds_read_b64_tr_b16 v[20:21], v18 offset:40960
    ds_read_b64_tr_b16 v[22:23], v18 offset:41472
    s_waitcnt lgkmcnt(4)
    v_mfma_f32_32x32x16_bf16 v[80:95], v[24:27], v[244:247], v[80:95]
    ds_read_b64_tr_b16 v[24:25], v19 offset:32768
    ds_read_b64_tr_b16 v[26:27], v19 offset:33280
    ds_write_b32 v8, v5
    v_mov_b32 v5, 0
    ds_write_b32 v8, v6 offset:2048
    v_mov_b32 v6, 0
    s_waitcnt lgkmcnt(6)
    v_mfma_f32_32x32x16_bf16 v[64:79], v[28:31], v[248:251], v[64:79]
    ds_read_b64_tr_b16 v[28:29], v19 offset:40960
    ds_read_b64_tr_b16 v[30:31], v19 offset:41472
    s_waitcnt lgkmcnt(6)
    v_mfma_f32_32x32x16_bf16 v[80:95], v[20:23], v[248:251], v[80:95]
    ds_read_b64_tr_b16 v[20:21], v16 offset:49152
    ds_read_b64_tr_b16 v[22:23], v16 offset:49664
    s_waitcnt lgkmcnt(6)
    v_mfma_f32_32x32x16_bf16 v[32:47], v[24:27], v[252:255], v[64:79]
    ds_read_b64_tr_b16 v[24:25], v16 offset:57344
    ds_read_b64_tr_b16 v[26:27], v16 offset:57856
    s_waitcnt lgkmcnt(4)
    v_mfma_f32_32x32x16_bf16 v[48:63], v[28:31], v[252:255], v[80:95]
    ds_read_b64_tr_b16 v[28:29], v17 offset:49152
    ds_read_b64_tr_b16 v[30:31], v17 offset:49664
    s_waitcnt vmcnt(2)
    s_waitcnt lgkmcnt(4)
    v_mfma_f32_32x32x16_bf16 v[64:79], v[20:23], v[96:99], 0
    s_barrier
    s_add_u32 m0, s101, 0x8000
    s_nop 0
    buffer_load_dwordx4 v0, s[40:43], s71 offen lds
    v_mbcnt_lo_u32_b32 v14, -1, 0
    v_mbcnt_hi_u32_b32 v14, -1, v14
    v_lshrrev_b32 v15, 5, v14
    v_lshlrev_b32 v15, 10, v15
    v_lshl_add_u32 v15, v14, 5, v15
    s_waitcnt lgkmcnt(2)
    v_mfma_f32_32x32x16_bf16 v[80:95], v[24:27], v[96:99], 0
    v_dot2c_f32_bf16 v5, s10, v20
    v_dot2c_f32_bf16 v5, s10, v21
    v_dot2c_f32_bf16 v5, s10, v22
    v_dot2c_f32_bf16 v5, s10, v23
    v_dot2c_f32_bf16 v6, s10, v24
    v_dot2c_f32_bf16 v6, s10, v25
    v_dot2c_f32_bf16 v6, s10, v26
    v_dot2c_f32_bf16 v6, s10, v27
    ds_read_b64_tr_b16 v[20:21], v17 offset:57344
    ds_read_b64_tr_b16 v[22:23], v17 offset:57856
    ds_read_b64_tr_b16 v[24:25], v18 offset:49152
    ds_read_b64_tr_b16 v[26:27], v18 offset:49664
    s_add_u32 m0, s101, 0xa000
    s_nop 0
    buffer_load_dwordx4 v0, s[44:47], s71 offen lds
    s_waitcnt lgkmcnt(4)
    v_mfma_f32_32x32x16_bf16 v[64:79], v[28:31], v[100:103], v[64:79]
    ds_read_b64_tr_b16 v[28:29], v18 offset:57344
    ds_read_b64_tr_b16 v[30:31], v18 offset:57856
    v_add_u32 v15, s13, v15
    ds_read_b128 v[10:13], v15
    v_lshl_add_u32 v14, v14, 2, s14
    s_waitcnt lgkmcnt(5)
    v_mfma_f32_32x32x16_bf16 v[80:95], v[20:23], v[100:103], v[80:95]
    ds_read_b64_tr_b16 v[20:21], v19 offset:49152
    ds_read_b64_tr_b16 v[22:23], v19 offset:49664
    s_waitcnt lgkmcnt(5)
    v_mfma_f32_32x32x16_bf16 v[64:79], v[24:27], v[104:107], v[64:79]
    ds_read_b64_tr_b16 v[24:25], v19 offset:57344
    ds_read_b64_tr_b16 v[26:27], v19 offset:57856
    s_waitcnt lgkmcnt(4)
    v_add_f32 v1, v10, v11
    v_add_f32 v12, v12, v13
    v_add_f32 v1, v1, v12
    ds_read_b128 v[10:13], v15 offset:16
    v_mfma_f32_32x32x16_bf16 v[80:95], v[28:31], v[104:107], v[80:95]
    ds_read_b64_tr_b16 v[28:29], v16
    ds_read_b64_tr_b16 v[30:31], v16 offset:512
    s_waitcnt lgkmcnt(5)
    v_mfma_f32_32x32x16_bf16 v[64:79], v[20:23], v[108:111], v[64:79]
    ds_read_b64_tr_b16 v[20:21], v16 offset:8192
    ds_read_b64_tr_b16 v[22:23], v16 offset:8704
    s_waitcnt lgkmcnt(4)
    v_add_f32 v10, v10, v11
    v_add_f32 v12, v12, v13
    v_add_f32 v1, v1, v10
    v_add_f32 v1, v1, v12
    ds_write_b32 v14, v1
    ds_read_b128 v[10:13], v7
    v_mfma_f32_32x32x16_bf16 v[80:95], v[24:27], v[108:111], v[80:95]
    ds_read_b64_tr_b16 v[24:25], v17
    ds_read_b64_tr_b16 v[26:27], v17 offset:512
    s_waitcnt vmcnt(2)
    s_waitcnt lgkmcnt(6)
    v_mfma_f32_32x32x16_bf16 v[64:79], v[28:31], v[112:115], v[64:79]
    s_barrier
    s_and_b32 s3, s2, 7
    s_lshl_b32 s3, s3, 4
    s_add_u32 s3, s3, 0
    s_add_u32 s28, s8, s3
    s_addc_u32 s29, s9, 0
    s_cmp_eq_u32 s98, 0
    s_cselect_b32 s30, 4, 0
    s_mov_b32 s31, 0x20000
    v_mbcnt_lo_u32_b32 v99, -1, 0
    v_mbcnt_hi_u32_b32 v99, -1, v99
    v_lshlrev_b32 v99, 2, v99
    v_mov_b32 v98, 1
    buffer_atomic_add v98, v99, s[28:31], 0 offen
    s_add_u32 m0, s101, 0xc000
    s_nop 0
    buffer_load_dwordx4 v0, s[40:43], s72 offen lds
    s_waitcnt lgkmcnt(2)
    v_fmac_f32 v32, v4, v10
    v_fmac_f32 v33, v4, v11
    v_fmac_f32 v34, v4, v12
    v_fmac_f32 v35, v4, v13
    ds_read_b128 v[10:13], v7 offset:32
    v_mul_f32 v32, v3, v32
    v_mul_f32 v33, v3, v33
    v_mul_f32 v34, v3, v34
    v_mul_f32 v35, v3, v35
    v_fmaak_f32 v14, v32, v32, 0x41b2e92f
    v_fmaak_f32 v15, v33, v33, 0x41b2e92f
    v_fmaak_f32 v9, v34, v34, 0x41b2e92f
    v_fmaak_f32 v1, v35, v35, 0x41b2e92f
    v_mul_f32 v14, v32, v14
    v_mul_f32 v15, v33, v15
    v_mul_f32 v9, v34, v9
    v_mul_f32 v1, v35, v1
    v_mul_f32 v14, 0xbdd2d3e8, v14
    v_mul_f32 v15, 0xbdd2d3e8, v15
    v_mul_f32 v9, 0xbdd2d3e8, v9
    v_mul_f32 v1, 0xbdd2d3e8, v1
    v_exp_f32 v14, v14
    v_exp_f32 v15, v15
    v_exp_f32 v9, v9
    v_exp_f32 v1, v1
    v_mfma_f32_32x32x16_bf16 v[80:95], v[20:23], v[112:115], v[80:95]
    v_dot2c_f32_bf16 v5, s10, v28
    v_dot2c_f32_bf16 v5, s10, v29
    v_dot2c_f32_bf16 v5, s10, v30
    v_dot2c_f32_bf16 v5, s10, v31
    v_dot2c_f32_bf16 v6, s10, v20
    v_dot2c_f32_bf16 v6, s10, v21
    v_dot2c_f32_bf16 v6, s10, v22
    v_dot2c_f32_bf16 v6, s10, v23
    ds_read_b64_tr_b16 v[28:29], v17 offset:8192
    ds_read_b64_tr_b16 v[30:31], v17 offset:8704
    ds_read_b64_tr_b16 v[20:21], v18
    ds_read_b64_tr_b16 v[22:23], v18 offset:512
    s_add_u32 m0, s101, 0xe000
    s_nop 0
    buffer_load_dwordx4 v0, s[44:47], s72 offen lds
    s_waitcnt lgkmcnt(5)
    v_mfma_f32_32x32x16_bf16 v[64:79], v[24:27], v[116:119], v[64:79]
    ds_read_b64_tr_b16 v[24:25], v18 offset:8192
    ds_read_b64_tr_b16 v[26:27], v18 offset:8704
    v_add_f32 v14, 1.0, v14
    v_add_f32 v15, 1.0, v15
    v_add_f32 v9, 1.0, v9
    v_add_f32 v1, 1.0, v1
    s_waitcnt lgkmcnt(4)
    v_mfma_f32_32x32x16_bf16 v[80:95], v[28:31], v[116:119], v[80:95]
    ds_read_b64_tr_b16 v[28:29], v19
    ds_read_b64_tr_b16 v[30:31], v19 offset:512
    v_rcp_f32 v14, v14
    v_rcp_f32 v15, v15
    v_rcp_f32 v9, v9
    s_waitcnt lgkmcnt(4)
    v_mfma_f32_32x32x16_bf16 v[64:79], v[20:23], v[120:123], v[64:79]
    ds_read_b64_tr_b16 v[20:21], v19 offset:8192
    ds_read_b64_tr_b16 v[22:23], v19 offset:8704
    v_rcp_f32 v1, v1
    v_mul_f32 v32, v32, v14
    v_mul_f32 v33, v33, v15
    v_mul_f32 v34, v34, v9
    v_mul_f32 v35, v35, v1
    s_waitcnt lgkmcnt(4)
    v_mfma_f32_32x32x16_bf16 v[80:95], v[24:27], v[120:123], v[80:95]
    ds_read_b64_tr_b16 v[24:25], v16 offset:16384
    ds_read_b64_tr_b16 v[26:27], v16 offset:16896
    v_fmac_f32 v36, v4, v10
    v_fmac_f32 v37, v4, v11
    v_fmac_f32 v38, v4, v12
    v_fmac_f32 v39, v4, v13
    ds_read_b128 v[10:13], v7 offset:64
    v_mul_f32 v36, v3, v36
    s_waitcnt lgkmcnt(5)
    v_mfma_f32_32x32x16_bf16 v[64:79], v[28:31], v[124:127], v[64:79]
    ds_read_b64_tr_b16 v[28:29], v16 offset:24576
    ds_read_b64_tr_b16 v[30:31], v16 offset:25088
    v_mul_f32 v37, v3, v37
    v_mul_f32 v38, v3, v38
    v_mul_f32 v39, v3, v39
    v_fmaak_f32 v14, v36, v36, 0x41b2e92f
    v_fmaak_f32 v15, v37, v37, 0x41b2e92f
    v_fmaak_f32 v9, v38, v38, 0x41b2e92f
    s_waitcnt lgkmcnt(5)
    v_mfma_f32_32x32x16_bf16 v[80:95], v[20:23], v[124:127], v[80:95]
    ds_read_b64_tr_b16 v[20:21], v17 offset:16384
    ds_read_b64_tr_b16 v[22:23], v17 offset:16896
    v_fmaak_f32 v1, v39, v39, 0x41b2e92f
    v_mul_f32 v14, v36, v14
    v_mul_f32 v15, v37, v15
    v_mul_f32 v9, v38, v9
    v_mul_f32 v1, v39, v1
    v_mul_f32 v14, 0xbdd2d3e8, v14
    s_waitcnt vmcnt(3)
    s_waitcnt lgkmcnt(5)
    v_mfma_f32_32x32x16_bf16 v[64:79], v[24:27], v[128:131], v[64:79]
    s_barrier
    s_add_u32 m0, s101, 0
    s_nop 0
    buffer_load_dwordx4 v0, s[40:43], s73 offen lds
    v_mul_f32 v15, 0xbdd2d3e8, v15
    v_mul_f32 v9, 0xbdd2d3e8, v9
    v_mul_f32 v1, 0xbdd2d3e8, v1
    v_exp_f32 v14, v14
    s_waitcnt lgkmcnt(2)
    v_mfma_f32_32x32x16_bf16 v[80:95], v[28:31], v[128:131], v[80:95]
    v_dot2c_f32_bf16 v5, s10, v24
    v_dot2c_f32_bf16 v5, s10, v25
    v_dot2c_f32_bf16 v5, s10, v26
    v_dot2c_f32_bf16 v5, s10, v27
    v_dot2c_f32_bf16 v6, s10, v28
    v_dot2c_f32_bf16 v6, s10, v29
    v_dot2c_f32_bf16 v6, s10, v30
    v_dot2c_f32_bf16 v6, s10, v31
    ds_read_b64_tr_b16 v[24:25], v17 offset:24576
    ds_read_b64_tr_b16 v[26:27], v17 offset:25088
    ds_read_b64_tr_b16 v[28:29], v18 offset:16384
    ds_read_b64_tr_b16 v[30:31], v18 offset:16896
    s_add_u32 m0, s101, 0x2000
    s_nop 0
    buffer_load_dwordx4 v0, s[44:47], s73 offen lds
    s_waitcnt lgkmcnt(4)
    v_mfma_f32_32x32x16_bf16 v[64:79], v[20:23], v[132:135], v[64:79]
    ds_read_b64_tr_b16 v[20:21], v18 offset:24576
    ds_read_b64_tr_b16 v[22:23], v18 offset:25088
    v_exp_f32 v15, v15
    v_exp_f32 v9, v9
    s_waitcnt lgkmcnt(4)
    v_mfma_f32_32x32x16_bf16 v[80:95], v[24:27], v[132:135], v[80:95]
    ds_read_b64_tr_b16 v[24:25], v19 offset:16384
    ds_read_b64_tr_b16 v[26:27], v19 offset:16896
    v_exp_f32 v1, v1
    v_add_f32 v14, 1.0, v14
    v_add_f32 v15, 1.0, v15
    v_add_f32 v9, 1.0, v9
    v_add_f32 v1, 1.0, v1
    s_waitcnt lgkmcnt(4)
    v_mfma_f32_32x32x16_bf16 v[64:79], v[28:31], v[136:139], v[64:79]
    ds_read_b64_tr_b16 v[28:29], v19 offset:24576
    ds_read_b64_tr_b16 v[30:31], v19 offset:25088
    v_rcp_f32 v14, v14
    v_rcp_f32 v15, v15
    v_rcp_f32 v9, v9
    s_waitcnt lgkmcnt(4)
    v_mfma_f32_32x32x16_bf16 v[80:95], v[20:23], v[136:139], v[80:95]
    ds_read_b64_tr_b16 v[20:21], v16 offset:32768
    ds_read_b64_tr_b16 v[22:23], v16 offset:33280
    v_rcp_f32 v1, v1
    v_mul_f32 v36, v36, v14
    v_mul_f32 v37, v37, v15
    v_mul_f32 v38, v38, v9
    v_mul_f32 v39, v39, v1
    s_waitcnt lgkmcnt(4)
    v_mfma_f32_32x32x16_bf16 v[64:79], v[24:27], v[140:143], v[64:79]
    ds_read_b64_tr_b16 v[24:25], v16 offset:40960
    ds_read_b64_tr_b16 v[26:27], v16 offset:41472
    v_fmac_f32 v40, v4, v10
    v_fmac_f32 v41, v4, v11
    v_fmac_f32 v42, v4, v12
    v_fmac_f32 v43, v4, v13
    ds_read_b128 v[10:13], v7 offset:96
    v_mul_f32 v40, v3, v40
    v_mul_f32 v41, v3, v41
    s_waitcnt lgkmcnt(5)
    v_mfma_f32_32x32x16_bf16 v[80:95], v[28:31], v[140:143], v[80:95]
    ds_read_b64_tr_b16 v[28:29], v17 offset:32768
    ds_read_b64_tr_b16 v[30:31], v17 offset:33280
    v_mul_f32 v42, v3, v42
    v_mul_f32 v43, v3, v43
    v_fmaak_f32 v14, v40, v40, 0x41b2e92f
    v_fmaak_f32 v15, v41, v41, 0x41b2e92f
    v_fmaak_f32 v9, v42, v42, 0x41b2e92f
    v_fmaak_f32 v1, v43, v43, 0x41b2e92f
    s_waitcnt vmcnt(2)
    s_waitcnt lgkmcnt(5)
    v_mfma_f32_32x32x16_bf16 v[64:79], v[20:23], v[144:147], v[64:79]
    s_barrier
    s_add_u32 m0, s101, 0x4000
    s_nop 0
    buffer_load_dwordx4 v0, s[40:43], s74 offen lds
    v_mul_f32 v14, v40, v14
    v_mul_f32 v15, v41, v15
    v_mul_f32 v9, v42, v9
    v_mul_f32 v1, v43, v1
    s_waitcnt lgkmcnt(3)
    v_mfma_f32_32x32x16_bf16 v[80:95], v[24:27], v[144:147], v[80:95]
    v_dot2c_f32_bf16 v5, s10, v20
    v_dot2c_f32_bf16 v5, s10, v21
    v_dot2c_f32_bf16 v5, s10, v22
    v_dot2c_f32_bf16 v5, s10, v23
    v_dot2c_f32_bf16 v6, s10, v24
    v_dot2c_f32_bf16 v6, s10, v25
    v_dot2c_f32_bf16 v6, s10, v26
    v_dot2c_f32_bf16 v6, s10, v27
    ds_read_b64_tr_b16 v[20:21], v17 offset:40960
    ds_read_b64_tr_b16 v[22:23], v17 offset:41472
    ds_read_b64_tr_b16 v[24:25], v18 offset:32768
    ds_read_b64_tr_b16 v[26:27], v18 offset:33280
    s_add_u32 m0, s101, 0x6000
    s_nop 0
    buffer_load_dwordx4 v0, s[44:47], s74 offen lds
    s_waitcnt lgkmcnt(4)
    v_mfma_f32_32x32x16_bf16 v[64:79], v[28:31], v[148:151], v[64:79]
    ds_read_b64_tr_b16 v[28:29], v18 offset:40960
    ds_read_b64_tr_b16 v[30:31], v18 offset:41472
    v_mul_f32 v14, 0xbdd2d3e8, v14
    v_mul_f32 v15, 0xbdd2d3e8, v15
    v_mul_f32 v9, 0xbdd2d3e8, v9
    v_mul_f32 v1, 0xbdd2d3e8, v1
    v_exp_f32 v14, v14
    s_waitcnt lgkmcnt(4)
    v_mfma_f32_32x32x16_bf16 v[80:95], v[20:23], v[148:151], v[80:95]
    ds_read_b64_tr_b16 v[20:21], v19 offset:32768
    ds_read_b64_tr_b16 v[22:23], v19 offset:33280
    v_exp_f32 v15, v15
    v_exp_f32 v9, v9
    v_exp_f32 v1, v1
    s_waitcnt lgkmcnt(4)
    v_mfma_f32_32x32x16_bf16 v[64:79], v[24:27], v[152:155], v[64:79]
    ds_read_b64_tr_b16 v[24:25], v19 offset:40960
    ds_read_b64_tr_b16 v[26:27], v19 offset:41472
    v_add_f32 v14, 1.0, v14
    v_add_f32 v15, 1.0, v15
    v_add_f32 v9, 1.0, v9
    v_add_f32 v1, 1.0, v1
    v_rcp_f32 v14, v14
    s_waitcnt lgkmcnt(4)
    v_mfma_f32_32x32x16_bf16 v[80:95], v[28:31], v[152:155], v[80:95]
    ds_read_b64_tr_b16 v[28:29], v16 offset:49152
    ds_read_b64_tr_b16 v[30:31], v16 offset:49664
    v_rcp_f32 v15, v15
    v_rcp_f32 v9, v9
    v_rcp_f32 v1, v1
    s_waitcnt lgkmcnt(4)
    v_mfma_f32_32x32x16_bf16 v[64:79], v[20:23], v[156:159], v[64:79]
    ds_read_b64_tr_b16 v[20:21], v16 offset:57344
    ds_read_b64_tr_b16 v[22:23], v16 offset:57856
    v_mul_f32 v40, v40, v14
    v_mul_f32 v41, v41, v15
    v_mul_f32 v42, v42, v9
    v_mul_f32 v43, v43, v1
    v_fmac_f32 v44, v4, v10
    s_waitcnt lgkmcnt(4)
    v_mfma_f32_32x32x16_bf16 v[80:95], v[24:27], v[156:159], v[80:95]
    ds_read_b64_tr_b16 v[24:25], v17 offset:49152
    ds_read_b64_tr_b16 v[26:27], v17 offset:49664
    v_fmac_f32 v45, v4, v11
    v_fmac_f32 v46, v4, v12
    v_fmac_f32 v47, v4, v13
    ds_read_b128 v[10:13], v7 offset:128
    v_mul_f32 v44, v3, v44
    v_mul_f32 v45, v3, v45
    s_waitcnt vmcnt(2)
    s_waitcnt lgkmcnt(5)
    v_mfma_f32_32x32x16_bf16 v[64:79], v[28:31], v[160:163], v[64:79]
    s_barrier
    s_add_u32 m0, s101, 0x8000
    s_nop 0
    buffer_load_dwordx4 v0, s[40:43], s75 offen lds
    v_mul_f32 v46, v3, v46
    v_mul_f32 v47, v3, v47
    v_fmaak_f32 v14, v44, v44, 0x41b2e92f
    v_fmaak_f32 v15, v45, v45, 0x41b2e92f
    v_fmaak_f32 v9, v46, v46, 0x41b2e92f
    s_waitcnt lgkmcnt(3)
    v_mfma_f32_32x32x16_bf16 v[80:95], v[20:23], v[160:163], v[80:95]
    v_dot2c_f32_bf16 v5, s10, v28
    v_dot2c_f32_bf16 v5, s10, v29
    v_dot2c_f32_bf16 v5, s10, v30
    v_dot2c_f32_bf16 v5, s10, v31
    v_dot2c_f32_bf16 v6, s10, v20
    v_dot2c_f32_bf16 v6, s10, v21
    v_dot2c_f32_bf16 v6, s10, v22
    v_dot2c_f32_bf16 v6, s10, v23
    ds_read_b64_tr_b16 v[28:29], v17 offset:57344
    ds_read_b64_tr_b16 v[30:31], v17 offset:57856
    ds_read_b64_tr_b16 v[20:21], v18 offset:49152
    ds_read_b64_tr_b16 v[22:23], v18 offset:49664
    s_add_u32 m0, s101, 0xa000
    s_nop 0
    buffer_load_dwordx4 v0, s[44:47], s75 offen lds
    s_waitcnt lgkmcnt(5)
    v_mfma_f32_32x32x16_bf16 v[64:79], v[24:27], v[164:167], v[64:79]
    ds_read_b64_tr_b16 v[24:25], v18 offset:57344
    ds_read_b64_tr_b16 v[26:27], v18 offset:57856
    v_fmaak_f32 v1, v47, v47, 0x41b2e92f
    v_mul_f32 v14, v44, v14
    v_mul_f32 v15, v45, v15
    v_mul_f32 v9, v46, v9
    s_waitcnt lgkmcnt(4)
    v_mfma_f32_32x32x16_bf16 v[80:95], v[28:31], v[164:167], v[80:95]
    ds_read_b64_tr_b16 v[28:29], v19 offset:49152
    ds_read_b64_tr_b16 v[30:31], v19 offset:49664
    v_mul_f32 v1, v47, v1
    v_mul_f32 v14, 0xbdd2d3e8, v14
    v_mul_f32 v15, 0xbdd2d3e8, v15
    v_mul_f32 v9, 0xbdd2d3e8, v9
    v_mul_f32 v1, 0xbdd2d3e8, v1
    v_exp_f32 v14, v14
    s_waitcnt lgkmcnt(4)
    v_mfma_f32_32x32x16_bf16 v[64:79], v[20:23], v[168:171], v[64:79]
    ds_read_b64_tr_b16 v[20:21], v19 offset:57344
    ds_read_b64_tr_b16 v[22:23], v19 offset:57856
    v_exp_f32 v15, v15
    v_exp_f32 v9, v9
    v_exp_f32 v1, v1
    s_waitcnt lgkmcnt(4)
    v_mfma_f32_32x32x16_bf16 v[80:95], v[24:27], v[168:171], v[80:95]
    ds_read_b64_tr_b16 v[24:25], v16
    ds_read_b64_tr_b16 v[26:27], v16 offset:512
    v_add_f32 v14, 1.0, v14
    v_add_f32 v15, 1.0, v15
    v_add_f32 v9, 1.0, v9
    v_add_f32 v1, 1.0, v1
    v_rcp_f32 v14, v14
    s_waitcnt lgkmcnt(4)
    v_mfma_f32_32x32x16_bf16 v[64:79], v[28:31], v[172:175], v[64:79]
    ds_read_b64_tr_b16 v[28:29], v16 offset:8192
    ds_read_b64_tr_b16 v[30:31], v16 offset:8704
    v_rcp_f32 v15, v15
    v_rcp_f32 v9, v9
    v_rcp_f32 v1, v1
    s_waitcnt lgkmcnt(4)
    v_mfma_f32_32x32x16_bf16 v[80:95], v[20:23], v[172:175], v[80:95]
    ds_read_b64_tr_b16 v[20:21], v17
    ds_read_b64_tr_b16 v[22:23], v17 offset:512
    v_mul_f32 v44, v44, v14
    v_mul_f32 v45, v45, v15
    v_mul_f32 v46, v46, v9
    v_mul_f32 v47, v47, v1
    v_fmac_f32 v48, v4, v10
    s_waitcnt vmcnt(2)
    s_waitcnt lgkmcnt(4)
    v_mfma_f32_32x32x16_bf16 v[64:79], v[24:27], v[176:179], v[64:79]
    s_barrier
    s_add_u32 m0, s101, 0xc000
    s_nop 0
    buffer_load_dwordx4 v0, s[40:43], s76 offen lds
    v_fmac_f32 v49, v4, v11
    v_fmac_f32 v50, v4, v12
    v_fmac_f32 v51, v4, v13
    ds_read_b128 v[10:13], v7 offset:160
    v_mul_f32 v48, v3, v48
    s_waitcnt lgkmcnt(3)
    v_mfma_f32_32x32x16_bf16 v[80:95], v[28:31], v[176:179], v[80:95]
    v_dot2c_f32_bf16 v5, s10, v24
    v_dot2c_f32_bf16 v5, s10, v25
    v_dot2c_f32_bf16 v5, s10, v26
    v_dot2c_f32_bf16 v5, s10, v27
    v_dot2c_f32_bf16 v6, s10, v28
    v_dot2c_f32_bf16 v6, s10, v29
    v_dot2c_f32_bf16 v6, s10, v30
    v_dot2c_f32_bf16 v6, s10, v31
    ds_read_b64_tr_b16 v[24:25], v17 offset:8192
    ds_read_b64_tr_b16 v[26:27], v17 offset:8704
    ds_read_b64_tr_b16 v[28:29], v18
    ds_read_b64_tr_b16 v[30:31], v18 offset:512
    s_add_u32 m0, s101, 0xe000
    s_nop 0
    buffer_load_dwordx4 v0, s[44:47], s76 offen lds
    s_waitcnt lgkmcnt(5)
    v_mfma_f32_32x32x16_bf16 v[64:79], v[20:23], v[180:183], v[64:79]
    ds_read_b64_tr_b16 v[20:21], v18 offset:8192
    ds_read_b64_tr_b16 v[22:23], v18 offset:8704
    v_mul_f32 v49, v3, v49
    v_mul_f32 v50, v3, v50
    v_mul_f32 v51, v3, v51
    v_fmaak_f32 v14, v48, v48, 0x41b2e92f
    v_fmaak_f32 v15, v49, v49, 0x41b2e92f
    s_waitcnt lgkmcnt(4)
    v_mfma_f32_32x32x16_bf16 v[80:95], v[24:27], v[180:183], v[80:95]
    ds_read_b64_tr_b16 v[24:25], v19
    ds_read_b64_tr_b16 v[26:27], v19 offset:512
    v_fmaak_f32 v9, v50, v50, 0x41b2e92f
    v_fmaak_f32 v1, v51, v51, 0x41b2e92f
    v_mul_f32 v14, v48, v14
    v_mul_f32 v15, v49, v15
    v_mul_f32 v9, v50, v9
    v_mul_f32 v1, v51, v1
    s_waitcnt lgkmcnt(4)
    v_mfma_f32_32x32x16_bf16 v[64:79], v[28:31], v[184:187], v[64:79]
    ds_read_b64_tr_b16 v[28:29], v19 offset:8192
    ds_read_b64_tr_b16 v[30:31], v19 offset:8704
    v_mul_f32 v14, 0xbdd2d3e8, v14
    v_mul_f32 v15, 0xbdd2d3e8, v15
    v_mul_f32 v9, 0xbdd2d3e8, v9
    v_mul_f32 v1, 0xbdd2d3e8, v1
    v_exp_f32 v14, v14
    s_waitcnt lgkmcnt(4)
    v_mfma_f32_32x32x16_bf16 v[80:95], v[20:23], v[184:187], v[80:95]
    ds_read_b64_tr_b16 v[20:21], v16 offset:16384
    ds_read_b64_tr_b16 v[22:23], v16 offset:16896
    v_exp_f32 v15, v15
    v_exp_f32 v9, v9
    v_exp_f32 v1, v1
    s_waitcnt lgkmcnt(4)
    v_mfma_f32_32x32x16_bf16 v[64:79], v[24:27], v[188:191], v[64:79]
    ds_read_b64_tr_b16 v[24:25], v16 offset:24576
    ds_read_b64_tr_b16 v[26:27], v16 offset:25088
    v_add_f32 v14, 1.0, v14
    v_add_f32 v15, 1.0, v15
    v_add_f32 v9, 1.0, v9
    v_add_f32 v1, 1.0, v1
    v_rcp_f32 v14, v14
    s_waitcnt lgkmcnt(4)
    v_mfma_f32_32x32x16_bf16 v[80:95], v[28:31], v[188:191], v[80:95]
    ds_read_b64_tr_b16 v[28:29], v17 offset:16384
    ds_read_b64_tr_b16 v[30:31], v17 offset:16896
    v_rcp_f32 v15, v15
    v_rcp_f32 v9, v9
    v_rcp_f32 v1, v1
    s_waitcnt vmcnt(2)
    s_waitcnt lgkmcnt(4)
    v_mfma_f32_32x32x16_bf16 v[64:79], v[20:23], v[192:195], v[64:79]
    s_barrier
    s_add_u32 m0, s101, 0
    s_nop 0
    buffer_load_dwordx4 v0, s[40:43], s77 offen lds
    v_mul_f32 v48, v48, v14
    v_mul_f32 v49, v49, v15
    v_mul_f32 v50, v50, v9
    v_mul_f32 v51, v51, v1
    s_waitcnt lgkmcnt(2)
    v_mfma_f32_32x32x16_bf16 v[80:95], v[24:27], v[192:195], v[80:95]
    v_dot2c_f32_bf16 v5, s10, v20
    v_dot2c_f32_bf16 v5, s10, v21
    v_dot2c_f32_bf16 v5, s10, v22
    v_dot2c_f32_bf16 v5, s10, v23
    v_dot2c_f32_bf16 v6, s10, v24
    v_dot2c_f32_bf16 v6, s10, v25
    v_dot2c_f32_bf16 v6, s10, v26
    v_dot2c_f32_bf16 v6, s10, v27
    ds_read_b64_tr_b16 v[20:21], v17 offset:24576
    ds_read_b64_tr_b16 v[22:23], v17 offset:25088
    ds_read_b64_tr_b16 v[24:25], v18 offset:16384
    ds_read_b64_tr_b16 v[26:27], v18 offset:16896
    s_add_u32 m0, s101, 0x2000
    s_nop 0
    buffer_load_dwordx4 v0, s[44:47], s77 offen lds
    s_waitcnt lgkmcnt(4)
    v_mfma_f32_32x32x16_bf16 v[64:79], v[28:31], v[196:199], v[64:79]
    ds_read_b64_tr_b16 v[28:29], v18 offset:24576
    ds_read_b64_tr_b16 v[30:31], v18 offset:25088
    v_fmac_f32 v52, v4, v10
    v_fmac_f32 v53, v4, v11
    v_fmac_f32 v54, v4, v12
    v_fmac_f32 v55, v4, v13
    ds_read_b128 v[10:13], v7 offset:192
    s_waitcnt lgkmcnt(5)
    v_mfma_f32_32x32x16_bf16 v[80:95], v[20:23], v[196:199], v[80:95]
    ds_read_b64_tr_b16 v[20:21], v19 offset:16384
    ds_read_b64_tr_b16 v[22:23], v19 offset:16896
    v_mul_f32 v52, v3, v52
    v_mul_f32 v53, v3, v53
    v_mul_f32 v54, v3, v54
    v_mul_f32 v55, v3, v55
    v_fmaak_f32 v14, v52, v52, 0x41b2e92f
    v_fmaak_f32 v15, v53, v53, 0x41b2e92f
    s_waitcnt lgkmcnt(5)
    v_mfma_f32_32x32x16_bf16 v[64:79], v[24:27], v[200:203], v[64:79]
    ds_read_b64_tr_b16 v[24:25], v19 offset:24576
    ds_read_b64_tr_b16 v[26:27], v19 offset:25088
    v_fmaak_f32 v9, v54, v54, 0x41b2e92f
    v_fmaak_f32 v1, v55, v55, 0x41b2e92f
    v_mul_f32 v14, v52, v14
    v_mul_f32 v15, v53, v15
    v_mul_f32 v9, v54, v9
    v_mul_f32 v1, v55, v1
    s_waitcnt lgkmcnt(5)
    v_mfma_f32_32x32x16_bf16 v[80:95], v[28:31], v[200:203], v[80:95]
    ds_read_b64_tr_b16 v[28:29], v16 offset:32768
    ds_read_b64_tr_b16 v[30:31], v16 offset:33280
    v_mul_f32 v14, 0xbdd2d3e8, v14
    v_mul_f32 v15, 0xbdd2d3e8, v15
    v_mul_f32 v9, 0xbdd2d3e8, v9
    v_mul_f32 v1, 0xbdd2d3e8, v1
    v_exp_f32 v14, v14
    s_waitcnt lgkmcnt(4)
    v_mfma_f32_32x32x16_bf16 v[64:79], v[20:23], v[204:207], v[64:79]
    ds_read_b64_tr_b16 v[20:21], v16 offset:40960
    ds_read_b64_tr_b16 v[22:23], v16 offset:41472
    v_exp_f32 v15, v15
    v_exp_f32 v9, v9
    v_exp_f32 v1, v1
    s_waitcnt lgkmcnt(4)
    v_mfma_f32_32x32x16_bf16 v[80:95], v[24:27], v[204:207], v[80:95]
    ds_read_b64_tr_b16 v[24:25], v17 offset:32768
    ds_read_b64_tr_b16 v[26:27], v17 offset:33280
    v_add_f32 v14, 1.0, v14
    v_add_f32 v15, 1.0, v15
    v_add_f32 v9, 1.0, v9
    v_add_f32 v1, 1.0, v1
    v_rcp_f32 v14, v14
    s_waitcnt vmcnt(2)
    s_waitcnt lgkmcnt(4)
    v_mfma_f32_32x32x16_bf16 v[64:79], v[28:31], v[208:211], v[64:79]
    s_barrier
    v_rcp_f32 v15, v15
    v_rcp_f32 v9, v9
    v_rcp_f32 v1, v1
    s_waitcnt lgkmcnt(2)
    v_mfma_f32_32x32x16_bf16 v[80:95], v[20:23], v[208:211], v[80:95]
    v_dot2c_f32_bf16 v5, s10, v28
    v_dot2c_f32_bf16 v5, s10, v29
    v_dot2c_f32_bf16 v5, s10, v30
    v_dot2c_f32_bf16 v5, s10, v31
    v_dot2c_f32_bf16 v6, s10, v20
    v_dot2c_f32_bf16 v6, s10, v21
    v_dot2c_f32_bf16 v6, s10, v22
    v_dot2c_f32_bf16 v6, s10, v23
    ds_read_b64_tr_b16 v[28:29], v17 offset:40960
    ds_read_b64_tr_b16 v[30:31], v17 offset:41472
    ds_read_b64_tr_b16 v[20:21], v18 offset:32768
    ds_read_b64_tr_b16 v[22:23], v18 offset:33280
    s_waitcnt lgkmcnt(4)
    v_mfma_f32_32x32x16_bf16 v[64:79], v[24:27], v[212:215], v[64:79]
    ds_read_b64_tr_b16 v[24:25], v18 offset:40960
    ds_read_b64_tr_b16 v[26:27], v18 offset:41472
    v_mul_f32 v52, v52, v14
    v_mul_f32 v53, v53, v15
    v_mul_f32 v54, v54, v9
    v_mul_f32 v55, v55, v1
    v_fmac_f32 v56, v4, v10
    v_fmac_f32 v57, v4, v11
    s_waitcnt lgkmcnt(4)
    v_mfma_f32_32x32x16_bf16 v[80:95], v[28:31], v[212:215], v[80:95]
    ds_read_b64_tr_b16 v[28:29], v19 offset:32768
    ds_read_b64_tr_b16 v[30:31], v19 offset:33280
    v_fmac_f32 v58, v4, v12
    v_fmac_f32 v59, v4, v13
    ds_read_b128 v[10:13], v7 offset:224
    v_mul_f32 v56, v3, v56
    v_mul_f32 v57, v3, v57
    v_mul_f32 v58, v3, v58
    v_mul_f32 v59, v3, v59
    s_waitcnt lgkmcnt(5)
    v_mfma_f32_32x32x16_bf16 v[64:79], v[20:23], v[216:219], v[64:79]
    ds_read_b64_tr_b16 v[20:21], v19 offset:40960
    ds_read_b64_tr_b16 v[22:23], v19 offset:41472
    v_fmaak_f32 v14, v56, v56, 0x41b2e92f
    v_fmaak_f32 v15, v57, v57, 0x41b2e92f
    v_fmaak_f32 v9, v58, v58, 0x41b2e92f
    v_fmaak_f32 v1, v59, v59, 0x41b2e92f
    v_mul_f32 v14, v56, v14
    v_mul_f32 v15, v57, v15
    s_waitcnt lgkmcnt(5)
    v_mfma_f32_32x32x16_bf16 v[80:95], v[24:27], v[216:219], v[80:95]
    ds_read_b64_tr_b16 v[24:25], v16 offset:49152
    ds_read_b64_tr_b16 v[26:27], v16 offset:49664
    v_mul_f32 v9, v58, v9
    v_mul_f32 v1, v59, v1
    v_mul_f32 v14, 0xbdd2d3e8, v14
    v_mul_f32 v15, 0xbdd2d3e8, v15
    v_mul_f32 v9, 0xbdd2d3e8, v9
    v_mul_f32 v1, 0xbdd2d3e8, v1
    s_waitcnt lgkmcnt(5)
    v_mfma_f32_32x32x16_bf16 v[64:79], v[28:31], v[220:223], v[64:79]
    ds_read_b64_tr_b16 v[28:29], v16 offset:57344
    ds_read_b64_tr_b16 v[30:31], v16 offset:57856
    v_exp_f32 v14, v14
    v_exp_f32 v15, v15
    v_exp_f32 v9, v9
    s_waitcnt lgkmcnt(4)
    v_mfma_f32_32x32x16_bf16 v[80:95], v[20:23], v[220:223], v[80:95]
    ds_read_b64_tr_b16 v[20:21], v17 offset:49152
    ds_read_b64_tr_b16 v[22:23], v17 offset:49664
    v_exp_f32 v1, v1
    v_add_f32 v14, 1.0, v14
    v_add_f32 v15, 1.0, v15
    v_add_f32 v9, 1.0, v9
    v_add_f32 v1, 1.0, v1
    s_waitcnt vmcnt(0)
    s_waitcnt lgkmcnt(4)
    v_mfma_f32_32x32x16_bf16 v[64:79], v[24:27], v[224:227], v[64:79]
    s_barrier
    v_rcp_f32 v14, v14
    v_rcp_f32 v15, v15
    v_rcp_f32 v9, v9
    s_waitcnt lgkmcnt(2)
    v_mfma_f32_32x32x16_bf16 v[80:95], v[28:31], v[224:227], v[80:95]
    v_dot2c_f32_bf16 v5, s10, v24
    v_dot2c_f32_bf16 v5, s10, v25
    v_dot2c_f32_bf16 v5, s10, v26
    v_dot2c_f32_bf16 v5, s10, v27
    v_dot2c_f32_bf16 v6, s10, v28
    v_dot2c_f32_bf16 v6, s10, v29
    v_dot2c_f32_bf16 v6, s10, v30
    v_dot2c_f32_bf16 v6, s10, v31
    ds_read_b64_tr_b16 v[24:25], v17 offset:57344
    ds_read_b64_tr_b16 v[26:27], v17 offset:57856
    ds_read_b64_tr_b16 v[28:29], v18 offset:49152
    ds_read_b64_tr_b16 v[30:31], v18 offset:49664
    s_waitcnt lgkmcnt(4)
    v_mfma_f32_32x32x16_bf16 v[64:79], v[20:23], v[228:231], v[64:79]
    ds_read_b64_tr_b16 v[20:21], v18 offset:57344
    ds_read_b64_tr_b16 v[22:23], v18 offset:57856
    v_rcp_f32 v1, v1
    v_mul_f32 v56, v56, v14
    v_mul_f32 v57, v57, v15
    v_mul_f32 v58, v58, v9
    v_mul_f32 v59, v59, v1
    s_waitcnt lgkmcnt(4)
    v_mfma_f32_32x32x16_bf16 v[80:95], v[24:27], v[228:231], v[80:95]
    ds_read_b64_tr_b16 v[24:25], v19 offset:49152
    ds_read_b64_tr_b16 v[26:27], v19 offset:49664
    v_fmac_f32 v60, v4, v10
    v_fmac_f32 v61, v4, v11
    v_fmac_f32 v62, v4, v12
    v_fmac_f32 v63, v4, v13
    v_mul_f32 v60, v3, v60
    v_mul_f32 v61, v3, v61
    s_waitcnt lgkmcnt(4)
    v_mfma_f32_32x32x16_bf16 v[64:79], v[28:31], v[232:235], v[64:79]
    ds_read_b64_tr_b16 v[28:29], v19 offset:57344
    ds_read_b64_tr_b16 v[30:31], v19 offset:57856
    v_mul_f32 v62, v3, v62
    v_mul_f32 v63, v3, v63
    v_fmaak_f32 v14, v60, v60, 0x41b2e92f
    v_fmaak_f32 v15, v61, v61, 0x41b2e92f
    v_fmaak_f32 v9, v62, v62, 0x41b2e92f
    v_fmaak_f32 v1, v63, v63, 0x41b2e92f
    s_waitcnt lgkmcnt(4)
    v_mfma_f32_32x32x16_bf16 v[80:95], v[20:23], v[232:235], v[80:95]
    ds_read_b64_tr_b16 v[20:21], v16
    ds_read_b64_tr_b16 v[22:23], v16 offset:512
    v_mul_f32 v14, v60, v14
    v_mul_f32 v15, v61, v15
    v_mul_f32 v9, v62, v9
    v_mul_f32 v1, v63, v1
    v_mul_f32 v14, 0xbdd2d3e8, v14
    v_mul_f32 v15, 0xbdd2d3e8, v15
    s_waitcnt lgkmcnt(4)
    v_mfma_f32_32x32x16_bf16 v[64:79], v[24:27], v[236:239], v[64:79]
    ds_read_b64_tr_b16 v[24:25], v16 offset:8192
    ds_read_b64_tr_b16 v[26:27], v16 offset:8704
    v_mul_f32 v9, 0xbdd2d3e8, v9
    v_mul_f32 v1, 0xbdd2d3e8, v1
    v_exp_f32 v14, v14
    v_exp_f32 v15, v15
    s_waitcnt lgkmcnt(4)
    v_mfma_f32_32x32x16_bf16 v[80:95], v[28:31], v[236:239], v[80:95]
    ds_read_b64_tr_b16 v[28:29], v17
    ds_read_b64_tr_b16 v[30:31], v17 offset:512
    v_exp_f32 v9, v9
    v_exp_f32 v1, v1
    v_add_f32 v14, 1.0, v14
    v_add_f32 v15, 1.0, v15
    s_waitcnt lgkmcnt(4)
    v_mfma_f32_32x32x16_bf16 v[64:79], v[20:23], v[240:243], v[64:79]
    s_barrier
    v_add_f32 v9, 1.0, v9
    v_add_f32 v1, 1.0, v1
    v_rcp_f32 v14, v14
    v_rcp_f32 v15, v15
    s_waitcnt lgkmcnt(2)
    v_mfma_f32_32x32x16_bf16 v[80:95], v[24:27], v[240:243], v[80:95]
    v_dot2c_f32_bf16 v5, s10, v20
    v_dot2c_f32_bf16 v5, s10, v21
    v_dot2c_f32_bf16 v5, s10, v22
    v_dot2c_f32_bf16 v5, s10, v23
    v_dot2c_f32_bf16 v6, s10, v24
    v_dot2c_f32_bf16 v6, s10, v25
    v_dot2c_f32_bf16 v6, s10, v26
    v_dot2c_f32_bf16 v6, s10, v27
    ds_read_b64_tr_b16 v[20:21], v17 offset:8192
    ds_read_b64_tr_b16 v[22:23], v17 offset:8704
    ds_read_b64_tr_b16 v[24:25], v18
    ds_read_b64_tr_b16 v[26:27], v18 offset:512
    s_waitcnt lgkmcnt(4)
    v_mfma_f32_32x32x16_bf16 v[64:79], v[28:31], v[244:247], v[64:79]
    ds_read_b64_tr_b16 v[28:29], v18 offset:8192
    ds_read_b64_tr_b16 v[30:31], v18 offset:8704
    v_rcp_f32 v9, v9
    v_rcp_f32 v1, v1
    v_mul_f32 v60, v60, v14
    v_mul_f32 v61, v61, v15
    s_waitcnt lgkmcnt(4)
    v_mfma_f32_32x32x16_bf16 v[80:95], v[20:23], v[244:247], v[80:95]
    ds_read_b64_tr_b16 v[20:21], v19
    ds_read_b64_tr_b16 v[22:23], v19 offset:512
    v_mul_f32 v62, v62, v9
    v_mul_f32 v63, v63, v1
    ds_write_b32 v8, v5
    v_mov_b32 v5, 0
    ds_write_b32 v8, v6 offset:2048
    v_mov_b32 v6, 0
    s_waitcnt lgkmcnt(6)
    v_mfma_f32_32x32x16_bf16 v[64:79], v[24:27], v[248:251], v[64:79]
    ds_read_b64_tr_b16 v[24:25], v19 offset:8192
    ds_read_b64_tr_b16 v[26:27], v19 offset:8704
    s_waitcnt lgkmcnt(6)
    v_mfma_f32_32x32x16_bf16 v[80:95], v[28:31], v[248:251], v[80:95]
    s_waitcnt lgkmcnt(4)
    v_mfma_f32_32x32x16_bf16 v[64:79], v[20:23], v[252:255], v[64:79]
    s_waitcnt lgkmcnt(0)
    v_mfma_f32_32x32x16_bf16 v[80:95], v[24:27], v[252:255], v[80:95]
    s_barrier
    v_mbcnt_lo_u32_b32 v14, -1, 0
    v_mbcnt_hi_u32_b32 v14, -1, v14
    v_lshrrev_b32 v15, 5, v14
    v_lshlrev_b32 v15, 10, v15
    v_lshl_add_u32 v15, v14, 5, v15
    v_add_u32 v15, s13, v15
    ds_read_b128 v[10:13], v15
    v_lshl_add_u32 v14, v14, 2, s14
    s_waitcnt lgkmcnt(0)
    v_add_f32 v1, v10, v11
    v_add_f32 v12, v12, v13
    v_add_f32 v1, v1, v12
    ds_read_b128 v[10:13], v15 offset:16
    s_waitcnt lgkmcnt(0)
    v_add_f32 v10, v10, v11
    v_add_f32 v12, v12, v13
    v_add_f32 v1, v1, v10
    v_add_f32 v1, v1, v12
    ds_write_b32 v14, v1
    ds_read_b128 v[10:13], v7
    s_waitcnt lgkmcnt(0)
    v_fmac_f32 v64, v4, v10
    v_fmac_f32 v65, v4, v11
    v_fmac_f32 v66, v4, v12
    v_fmac_f32 v67, v4, v13
    ds_read_b128 v[10:13], v7 offset:32
    v_mul_f32 v64, v3, v64
    v_mul_f32 v65, v3, v65
    v_mul_f32 v66, v3, v66
    v_mul_f32 v67, v3, v67
    v_mul_f32 v64, v32, v64
    v_mul_f32 v65, v33, v65
    v_mul_f32 v66, v34, v66
    v_mul_f32 v67, v35, v67
    v_cvt_pk_bf16_f32 v32, v64, v65
    v_cvt_pk_bf16_f32 v33, v66, v67
    s_waitcnt lgkmcnt(0)
    v_fmac_f32 v68, v4, v10
    v_fmac_f32 v69, v4, v11
    v_fmac_f32 v70, v4, v12
    v_fmac_f32 v71, v4, v13
    ds_read_b128 v[10:13], v7 offset:64
    v_mul_f32 v68, v3, v68
    v_mul_f32 v69, v3, v69
    v_mul_f32 v70, v3, v70
    v_mul_f32 v71, v3, v71
    v_mul_f32 v68, v36, v68
    v_mul_f32 v69, v37, v69
    v_mul_f32 v70, v38, v70
    v_mul_f32 v71, v39, v71
    v_cvt_pk_bf16_f32 v34, v68, v69
    v_cvt_pk_bf16_f32 v35, v70, v71
    buffer_store_dwordx4 v[32:35], v2, s[52:55], 0 offen sc1
    s_waitcnt lgkmcnt(0)
    v_fmac_f32 v72, v4, v10
    v_fmac_f32 v73, v4, v11
    v_fmac_f32 v74, v4, v12
    v_fmac_f32 v75, v4, v13
    ds_read_b128 v[10:13], v7 offset:96
    v_mul_f32 v72, v3, v72
    v_mul_f32 v73, v3, v73
    v_mul_f32 v74, v3, v74
    v_mul_f32 v75, v3, v75
    v_mul_f32 v72, v40, v72
    v_mul_f32 v73, v41, v73
    v_mul_f32 v74, v42, v74
    v_mul_f32 v75, v43, v75
    v_cvt_pk_bf16_f32 v40, v72, v73
    v_cvt_pk_bf16_f32 v41, v74, v75
    s_waitcnt lgkmcnt(0)
    v_fmac_f32 v76, v4, v10
    v_fmac_f32 v77, v4, v11
    v_fmac_f32 v78, v4, v12
    v_fmac_f32 v79, v4, v13
    ds_read_b128 v[10:13], v7 offset:128
    v_mul_f32 v76, v3, v76
    v_mul_f32 v77, v3, v77
    v_mul_f32 v78, v3, v78
    v_mul_f32 v79, v3, v79
    v_mul_f32 v76, v44, v76
    v_mul_f32 v77, v45, v77
    v_mul_f32 v78, v46, v78
    v_mul_f32 v79, v47, v79
    v_cvt_pk_bf16_f32 v42, v76, v77
    v_cvt_pk_bf16_f32 v43, v78, v79
    buffer_store_dwordx4 v[40:43], v2, s[52:55], 0 offen offset:512 sc1
    s_waitcnt lgkmcnt(0)
    v_fmac_f32 v80, v4, v10
    v_fmac_f32 v81, v4, v11
    v_fmac_f32 v82, v4, v12
    v_fmac_f32 v83, v4, v13
    ds_read_b128 v[10:13], v7 offset:160
    v_mul_f32 v80, v3, v80
    v_mul_f32 v81, v3, v81
    v_mul_f32 v82, v3, v82
    v_mul_f32 v83, v3, v83
    v_mul_f32 v80, v48, v80
    v_mul_f32 v81, v49, v81
    v_mul_f32 v82, v50, v82
    v_mul_f32 v83, v51, v83
    v_cvt_pk_bf16_f32 v48, v80, v81
    v_cvt_pk_bf16_f32 v49, v82, v83
    s_waitcnt lgkmcnt(0)
    v_fmac_f32 v84, v4, v10
    v_fmac_f32 v85, v4, v11
    v_fmac_f32 v86, v4, v12
    v_fmac_f32 v87, v4, v13
    ds_read_b128 v[10:13], v7 offset:192
    v_mul_f32 v84, v3, v84
    v_mul_f32 v85, v3, v85
    v_mul_f32 v86, v3, v86
    v_mul_f32 v87, v3, v87
    v_mul_f32 v84, v52, v84
    v_mul_f32 v85, v53, v85
    v_mul_f32 v86, v54, v86
    v_mul_f32 v87, v55, v87
    v_cvt_pk_bf16_f32 v50, v84, v85
    v_cvt_pk_bf16_f32 v51, v86, v87
    buffer_store_dwordx4 v[48:51], v2, s[52:55], 0 offen offset:2048 sc1
    s_waitcnt lgkmcnt(0)
    v_fmac_f32 v88, v4, v10
    v_fmac_f32 v89, v4, v11
    v_fmac_f32 v90, v4, v12
    v_fmac_f32 v91, v4, v13
    ds_read_b128 v[10:13], v7 offset:224
    v_mul_f32 v88, v3, v88
    v_mul_f32 v89, v3, v89
    v_mul_f32 v90, v3, v90
    v_mul_f32 v91, v3, v91
    v_mul_f32 v88, v56, v88
    v_mul_f32 v89, v57, v89
    v_mul_f32 v90, v58, v90
    v_mul_f32 v91, v59, v91
    v_cvt_pk_bf16_f32 v56, v88, v89
    v_cvt_pk_bf16_f32 v57, v90, v91
    s_waitcnt lgkmcnt(0)
    v_fmac_f32 v92, v4, v10
    v_fmac_f32 v93, v4, v11
    v_fmac_f32 v94, v4, v12
    v_fmac_f32 v95, v4, v13
    v_mul_f32 v92, v3, v92
    v_mul_f32 v93, v3, v93
    v_mul_f32 v94, v3, v94
    v_mul_f32 v95, v3, v95
    v_mul_f32 v92, v60, v92
    v_mul_f32 v93, v61, v93
    v_mul_f32 v94, v62, v94
    v_mul_f32 v95, v63, v95
    v_cvt_pk_bf16_f32 v58, v92, v93
    v_cvt_pk_bf16_f32 v59, v94, v95
    buffer_store_dwordx4 v[56:59], v2, s[52:55], 0 offen offset:2560 sc1
    s_mov_b32 s28, s8
    s_mov_b32 s29, s9
    s_mov_b32 s30, 0x100
    s_mov_b32 s31, 0x20000
    v_mbcnt_lo_u32_b32 v20, -1, 0
    v_mbcnt_hi_u32_b32 v20, -1, v20
    v_and_b32 v20, 7, v20
    v_lshlrev_b32 v20, 4, v20
    s_mov_b32 s3, 0
    s_waitcnt vmcnt(0)
    s_cmp_lg_u32 s98, 0
    s_cbranch_scc1 K1GQ_ce
K1GQ_cl:
    buffer_load_dword v21, v20, s[28:31], 0 offen sc1
    s_add_u32 s3, s3, 1
    s_waitcnt vmcnt(0)
    v_cmp_ne_u32 vcc, 32, v21
    s_nop 4
    s_cbranch_vccz K1GQ_ce
    s_cmp_gt_u32 s3, 0x4000
    s_cbranch_scc1 K1GQ_ce
    s_sleep 4
    s_branch K1GQ_cl
K1GQ_ce:
    s_barrier
    s_lshl_b32 s3, s20, 5
    s_add_u32 s3, s3, s21
    s_lshl_b32 s3, s3, 2
    s_add_u32 s24, s22, s3
    s_addc_u32 s25, s23, 0
    s_add_u32 s24, s24, 0x9c0000
    s_addc_u32 s25, s25, 0
    s_sub_u32 s26, 0x800, s3
    s_mov_b32 s27, 0x20000
    s_cmp_eq_u32 s98, 0
    s_cselect_b32 s26, 4, 0
    v_mbcnt_lo_u32_b32 v15, -1, 0
    v_mbcnt_hi_u32_b32 v15, -1, v15
    v_lshlrev_b32 v15, 2, v15
    v_mov_b32 v14, 1
    buffer_store_dword v14, v15, s[24:27], 0 offen sc1
    s_setprio 0
    s_branch P2
K1GQ_end:
.p2align 6
K1_nq:
    s_cmp_ge_u32 s2, 256
    s_cbranch_scc0 K1KV
    s_endpgm
K1KV:
    s_load_dwordx16 s[4:19], s[0:1], 0
    s_load_dwordx2 s[22:23], s[0:1], 72
    s_getpc_b64 s[96:97]
    v_lshlrev_b32 v32, 7, v0
    v_min_u32 v32, (P2_end-K1KV-64), v32
    global_load_dword v33, v32, s[96:97]
    v_lshrrev_b32 v39, 6, v0
    v_and_b32 v34, 63, v0
    v_lshrrev_b32 v40, 3, v0
    v_readfirstlane_b32 s98, v39
    v_and_b32 v36, 7, v0
    s_and_b32 s3, s2, 7
    s_lshr_b32 s68, s2, 3
    s_lshr_b32 s20, s3, 2
    s_lshl_b32 s20, s20, 3
    s_and_b32 s69, s68, 7
    s_add_u32 s20, s20, s69
    s_lshr_b32 s70, s68, 3
    s_lshl_b32 s21, s70, 2
    s_and_b32 s3, s3, 3
    s_add_u32 s21, s21, s3
    s_mul_i32 s70, s70, 3
    s_add_u32 s99, s69, s70
    s_cmp_ge_u32 s99, 10
    s_cselect_b32 s70, 10, 0
    s_sub_u32 s99, s99, s70
    s_lshl_b32 s101, s98, 10
    s_lshl_b32 s88, s99, 7
    s_mul_i32 s78, s99, 0x3c000
    s_add_u32 s99, s99, 1
    s_cmp_eq_u32 s99, 10
    s_cselect_b32 s99, 0, s99
    s_lshl_b32 s89, s99, 7
    s_mul_i32 s79, s99, 0x3c000
    s_add_u32 s99, s99, 1
    s_cmp_eq_u32 s99, 10
    s_cselect_b32 s99, 0, s99
    v_and_b32 v39, 2, v40
    v_lshlrev_b32 v39, 1, v39
    v_xor_b32 v39, v39, v36
    v_bfe_u32 v41, v40, 1, 3
    v_xor_b32 v41, v41, v36
    v_mul_u32_u24 v60, 0x500, v40
    v_lshl_add_u32 v60, v41, 4, v60
    v_mul_u32_u24 v61, 0xf00, v40
    v_lshl_add_u32 v61, v39, 4, v61
    v_lshrrev_b32 v41, 2, v39
    v_mul_u32_u24 v41, 0x4c0, v41
    v_add_u32 v61, v61, v41
    s_waitcnt lgkmcnt(0)
    s_sub_u32 s11, s21, 12
    s_mul_i32 s10, s11, 0x140
    s_add_u32 s10, s10, 0x500
    s_and_b32 s11, s11, 1
    s_lshl_b32 s3, s11, 8
    s_sub_u32 s3, 0x100, s3
    s_add_u32 s3, s3, s10
    s_add_u32 s48, s6, s3
    s_addc_u32 s49, s7, 0
    s_sub_u32 s50, 0x258000, s3
    s_mov_b32 s51, 0x20000
    s_mul_i32 s3, s20, 0x28000
    s_add_u32 s24, s4, s3
    s_addc_u32 s25, s5, 0
    s_sub_u32 s26, 0x280000, s3
    s_mov_b32 s27, 0x20000
    s_add_u32 s3, s3, 0x14000
    s_add_u32 s28, s4, s3
    s_addc_u32 s29, s5, 0
    s_sub_u32 s30, 0x280000, s3
    s_mov_b32 s31, 0x20000
    s_add_u32 m0, s101, 0
    s_nop 0
    buffer_load_dwordx4 v61, s[48:51], s78 offen lds
    s_add_u32 m0, s101, 0x10000
    s_nop 0
    buffer_load_dwordx4 v60, s[24:27], s88 offen lds
    s_add_u32 m0, s101, 0x12000
    s_nop 0
    buffer_load_dwordx4 v60, s[28:31], s88 offen lds
    s_add_u32 m0, s101, 0x2000
    s_nop 0
    buffer_load_dwordx4 v61, s[48:51], s79 offen lds
    s_add_u32 m0, s101, 0x14000
    s_nop 0
    buffer_load_dwordx4 v60, s[24:27], s89 offen lds
    s_add_u32 m0, s101, 0x16000
    s_nop 0
    buffer_load_dwordx4 v60, s[28:31], s89 offen lds
    s_lshl_b32 s90, s99, 7
    s_mul_i32 s80, s99, 0x3c000
    s_add_u32 s99, s99, 1
    s_cmp_eq_u32 s99, 10
    s_cselect_b32 s99, 0, s99
    s_lshl_b32 s91, s99, 7
    s_mul_i32 s81, s99, 0x3c000
    s_add_u32 s99, s99, 1
    s_cmp_eq_u32 s99, 10
    s_cselect_b32 s99, 0, s99
    s_lshl_b32 s92, s99, 7
    s_mul_i32 s82, s99, 0x3c000
    s_add_u32 s99, s99, 1
    s_cmp_eq_u32 s99, 10
    s_cselect_b32 s99, 0, s99
    s_lshl_b32 s93, s99, 7
    s_mul_i32 s83, s99, 0x3c000
    s_add_u32 s99, s99, 1
    s_cmp_eq_u32 s99, 10
    s_cselect_b32 s99, 0, s99
    s_lshl_b32 s94, s99, 7
    s_mul_i32 s84, s99, 0x3c000
    s_add_u32 s99, s99, 1
    s_cmp_eq_u32 s99, 10
    s_cselect_b32 s99, 0, s99
    s_lshl_b32 s95, s99, 7
    s_mul_i32 s85, s99, 0x3c000
    s_add_u32 s99, s99, 1
    s_cmp_eq_u32 s99, 10
    s_cselect_b32 s99, 0, s99
    s_lshl_b32 s96, s99, 7
    s_mul_i32 s86, s99, 0x3c000
    s_add_u32 s99, s99, 1
    s_cmp_eq_u32 s99, 10
    s_cselect_b32 s99, 0, s99
    s_lshl_b32 s97, s99, 7
    s_mul_i32 s87, s99, 0x3c000
    s_mul_i32 s68, s88, 0x600
    s_mul_i32 s69, s89, 0x600
    s_mul_i32 s70, s90, 0x600
    s_mul_i32 s71, s91, 0x600
    s_mul_i32 s72, s92, 0x600
    s_mul_i32 s73, s93, 0x600
    s_mul_i32 s74, s94, 0x600
    s_mul_i32 s75, s95, 0x600
    s_mul_i32 s76, s96, 0x600
    s_mul_i32 s77, s97, 0x600
    s_and_b32 s99, s98, 3
    s_lshr_b32 s100, s98, 2
    v_lshrrev_b32 v37, 5, v34
    v_and_b32 v38, 31, v34
    v_mul_u32_u24 v0, 0xf00, v40
    v_lshl_add_u32 v0, v39, 4, v0
    s_lshl_b32 s3, s11, 6
    s_add_u32 s3, s3, s10
    s_add_u32 s32, s6, s3
    s_addc_u32 s33, s7, 0
    s_sub_u32 s34, 0x258000, s3
    s_mov_b32 s35, 0x20000
    s_add_u32 s3, s3, 0x80
    s_add_u32 s36, s6, s3
    s_addc_u32 s37, s7, 0
    s_sub_u32 s38, 0x258000, s3
    s_mov_b32 s39, 0x20000
    s_add_u32 s3, s3, 0x500
    s_add_u32 s44, s6, s3
    s_addc_u32 s45, s7, 0
    s_sub_u32 s46, 0x258000, s3
    s_mov_b32 s47, 0x20000
    s_sub_u32 s3, s3, 0x80
    s_add_u32 s40, s6, s3
    s_addc_u32 s41, s7, 0
    s_sub_u32 s42, 0x258000, s3
    s_mov_b32 s43, 0x20000
    s_lshl_b32 s3, s20, 5
    s_sub_u32 s10, s21, 12
    s_lshl_b32 s10, s10, 3
    s_add_u32 s3, s3, s10
    s_add_u32 s3, s3, s98
    s_mul_i32 s3, s3, 0x700
    s_add_u32 s56, s22, s3
    s_addc_u32 s57, s23, 0
    s_add_u32 s56, s56, 0x880000
    s_addc_u32 s57, s57, 0
    s_sub_u32 s58, 0xe0000, s3
    s_mov_b32 s59, 0x20000
    s_mov_b32 s58, 0x700
    s_cmp_lg_u32 s100, 0
    s_cselect_b64 s[52:53], -1, 0
    s_mov_b32 s10, 0x3f803f80
    v_and_b32 v39, 3, v34
    v_bfe_u32 v40, v34, 2, 2
    v_bfe_u32 v41, v34, 4, 1
    v_lshrrev_b32 v43, 1, v39
    v_lshl_add_u32 v43, v41, 1, v43
    s_lshl_b32 s3, s100, 2
    v_add_u32 v43, s3, v43
    v_lshrrev_b32 v44, 1, v40
    v_lshlrev_b32 v44, 2, v44
    v_xor_b32 v43, v43, v44
    v_lshl_add_u32 v44, v37, 3, v40
    v_lshlrev_b32 v44, 7, v44
    v_lshl_add_u32 v44, v43, 4, v44
    v_and_b32 v43, 1, v39
    v_lshl_add_u32 v44, v43, 3, v44
    s_lshl_b32 s5, s100, 1
    s_xor_b32 s5, s5, s99
    s_xor_b32 s3, s5, 0
    s_lshl_b32 s3, s3, 11
    v_add_u32 v16, s3, v44
    s_xor_b32 s3, s5, 1
    s_lshl_b32 s3, s3, 11
    v_add_u32 v17, s3, v44
    s_xor_b32 s3, s5, 2
    s_lshl_b32 s3, s3, 11
    v_add_u32 v18, s3, v44
    s_xor_b32 s3, s5, 3
    s_lshl_b32 s3, s3, 11
    v_add_u32 v19, s3, v44
    s_lshl_b32 s3, s99, 5
    v_add_u32 v43, s3, v38
    v_lshrrev_b32 v44, 1, v43
    v_and_b32 v44, 7, v44
    v_xor_b32 v44, v44, v37
    v_lshlrev_b32 v44, 4, v44
    v_lshl_add_u32 v44, v43, 7, v44
    s_xor_b32 s3, s5, 0
    s_lshl_b32 s3, s3, 5
    v_xor_b32 v48, s3, v44
    v_add_u32 v48, 0x18000, v48
    v_subrev_u32 v52, 0x8000, v48
    s_xor_b32 s3, s5, 1
    s_lshl_b32 s3, s3, 5
    v_xor_b32 v49, s3, v44
    v_add_u32 v49, 0x18000, v49
    v_subrev_u32 v53, 0x8000, v49
    s_xor_b32 s3, s5, 2
    s_lshl_b32 s3, s3, 5
    v_xor_b32 v50, s3, v44
    v_add_u32 v50, 0x18000, v50
    v_subrev_u32 v54, 0x8000, v50
    s_xor_b32 s3, s5, 3
    s_lshl_b32 s3, s3, 5
    v_xor_b32 v51, s3, v44
    v_add_u32 v51, 0x18000, v51
    v_subrev_u32 v55, 0x8000, v51
    v_lshlrev_b32 v56, 5, v43
    s_lshl_b32 s3, s100, 4
    s_add_u32 s3, s3, 0x25800
    v_lshl_add_u32 v56, v37, 3, v56
    v_add_u32 v56, s3, v56
    s_lshl_b32 s3, s98, 8
    s_add_u32 s3, s3, 0x25000
    v_lshl_add_u32 v7, v37, 4, s3
    s_lshl_b32 s3, s100, 7
    s_add_u32 s3, s3, s99
    s_lshl_b32 s3, s3, 3
    s_add_u32 s3, s3, 0x26800
    v_lshl_add_u32 v8, v37, 2, s3
    v_lshl_add_u32 v8, v38, 5, v8
    v_mul_u32_u24 v2, 0x148, v43
    v_lshl_add_u32 v2, v37, 3, v2
    s_mul_i32 s3, s100, 0xa400
    s_add_u32 s3, s3, 0x10100
    v_add_u32 v2, s3, v2
    s_lshl_b32 s3, s11, 8
    v_subrev_u32 v2, s3, v2
    v_mov_b32 v5, 0
    v_mov_b32 v6, 0
    v_mov_b32 v58, 0
    v_mov_b32 v59, 0
    s_lshl_b32 s12, s99, 10
    s_add_u32 s12, s12, 0x25800
    s_lshl_b32 s13, s100, 10
    s_add_u32 s13, s13, 0x26800
    s_lshl_b32 s14, s98, 8
    s_add_u32 s14, s14, 0x25000
    s_add_u32 m0, s101, 0x4000
    s_nop 0
    buffer_load_dwordx4 v61, s[48:51], s80 offen lds
    s_add_u32 m0, s101, 0x18000
    s_nop 0
    buffer_load_dwordx4 v60, s[24:27], s90 offen lds
    s_add_u32 m0, s101, 0x1a000
    s_nop 0
    buffer_load_dwordx4 v60, s[28:31], s90 offen lds
    s_sub_u32 s3, s2, 0xc0
    s_lshl_b32 s3, s3, 3
    s_add_u32 s3, s3, s98
    s_mul_i32 s19, s3, 0x97c
    s_lshr_b32 s19, s19, 16
    s_mul_i32 s19, s19, 27
    s_sub_u32 s4, s3, s19
    s_lshl_b32 s3, s3, 10
    s_add_u32 s64, s22, s3
    s_addc_u32 s65, s23, 0
    s_add_u32 s64, s64, 0x980000
    s_addc_u32 s65, s65, 0
    s_sub_u32 s66, 0x1b000, s3
    s_mov_b32 s67, 0x20000
    s_cmp_lt_u32 s3, 0x1b000
    s_cselect_b32 s66, s66, 0
    s_add_u32 s3, s4, 1
    s_lshr_b32 s19, s3, 1
    s_and_b32 s3, s3, 1
    s_sub_u32 s15, s19, 1
    s_ashr_i32 s15, s15, 1
    s_add_u32 s15, s15, s3
    s_cmp_ge_u32 s4, 21
    s_cselect_b32 s3, 1, 0
    s_cmp_ge_u32 s4, 25
    s_cselect_b32 s18, 1, 0
    s_add_u32 s3, s3, s18
    s_lshl_b32 s18, s3, 1
    s_sub_u32 s18, s4, s18
    s_sub_u32 s18, s18, 18
    s_cmp_ge_u32 s4, 18
    s_cselect_b32 s19, s3, s19
    s_cselect_b32 s15, s18, s15
    s_cselect_b64 s[60:61], -1, 0
    v_mbcnt_lo_u32_b32 v64, -1, 0
    v_mbcnt_hi_u32_b32 v64, -1, v64
    v_and_b32 v65, 15, v64
    v_lshrrev_b32 v66, 4, v64
    s_lshl_b32 s3, s19, 4
    v_add_u32 v67, s3, v65
    v_mul_u32_u24 v68, 0xccd, v67
    v_lshrrev_b32 v68, 16, v68
    v_and_b32 v70, 3, v65
    s_lshl_b32 s3, s19, 2
    v_add_u32 v70, s3, v70
    v_lshrrev_b32 v71, 2, v65
    v_lshl_add_u32 v71, v70, 2, v71
    v_mul_u32_u24 v71, 0x3334, v71
    v_lshrrev_b32 v71, 16, v71
    v_cndmask_b32 v68, v68, v71, s[60:61]
    v_lshrrev_b32 v70, 1, v66
    v_lshlrev_b32 v69, 4, v70
    v_and_b32 v70, 1, v66
    v_lshl_add_u32 v69, v70, 2, v69
    s_lshl_b32 s3, s15, 5
    v_add_u32 v69, s3, v69
    v_mul_u32_u24 v68, 20, v68
    v_sub_u32 v69, v69, v68
    v_cmp_gt_u32 vcc, 20, v69
    v_mov_b32 v70, -1
    v_add_u32 v69, 8, v69
    v_cndmask_b32 v72, 0, v70, vcc
    v_cndmask_b32 v73, 0, v70, vcc
    v_cmp_gt_u32 vcc, 20, v69
    v_lshlrev_b32 v64, 4, v64
    s_nop 0
    v_cndmask_b32 v74, 0, v70, vcc
    v_cndmask_b32 v75, 0, v70, vcc
    buffer_store_dwordx4 v[72:75], v64, s[64:67], 0 offen sc1
    s_load_dwordx2 s[8:9], s[0:1], 64
    v_mbcnt_lo_u32_b32 v84, -1, 0
    v_mbcnt_hi_u32_b32 v84, -1, v84
    v_lshlrev_b32 v84, 4, v84
    v_mov_b32 v80, -1
    v_mov_b32 v81, -1
    v_mov_b32 v82, -1
    v_mov_b32 v83, -1
    buffer_store_dwordx4 v[80:83], v84, s[56:59], 0 offen sc1
    buffer_store_dwordx4 v[80:83], v84, s[56:59], 0 offen offset:1024 sc1
    s_waitcnt lgkmcnt(0)
    s_waitcnt vmcnt(9)
    s_barrier
    ds_read_b128 v[96:99], v52
    ds_read_b64_tr_b16 v[20:21], v16
    ds_read_b64_tr_b16 v[22:23], v16 offset:512
    ds_read_b128 v[100:103], v53
    ds_read_b64_tr_b16 v[24:25], v17
    ds_read_b64_tr_b16 v[26:27], v17 offset:512
    ds_read_b128 v[104:107], v54
    ds_read_b64_tr_b16 v[28:29], v18
    ds_read_b64_tr_b16 v[30:31], v18 offset:512
    s_waitcnt vmcnt(6)
    s_waitcnt lgkmcnt(6)
    v_mfma_f32_32x32x16_bf16 v[64:79], v[20:23], v[96:99], 0
    s_barrier
    v_dot2c_f32_bf16 v5, s10, v20
    v_dot2c_f32_bf16 v5, s10, v21
    v_dot2c_f32_bf16 v5, s10, v22
    v_dot2c_f32_bf16 v5, s10, v23
    ds_read_b128 v[108:111], v55
    ds_read_b64_tr_b16 v[20:21], v19
    ds_read_b64_tr_b16 v[22:23], v19 offset:512
    v_dot2c_f32_bf16 v58, s10, v96
    v_dot2c_f32_bf16 v59, v96, v96
    v_dot2c_f32_bf16 v58, s10, v97
    v_dot2c_f32_bf16 v59, v97, v97
    v_dot2c_f32_bf16 v58, s10, v98
    v_dot2c_f32_bf16 v59, v98, v98
    v_dot2c_f32_bf16 v58, s10, v99
    v_dot2c_f32_bf16 v59, v99, v99
    s_add_u32 m0, s101, 0x6000
    s_nop 0
    buffer_load_dwordx4 v61, s[48:51], s81 offen lds
    s_waitcnt lgkmcnt(6)
    v_mfma_f32_32x32x16_bf16 v[64:79], v[24:27], v[100:103], v[64:79]
    ds_read_b128 v[112:115], v52 offset:16384
    ds_read_b64_tr_b16 v[24:25], v16 offset:8192
    ds_read_b64_tr_b16 v[26:27], v16 offset:8704
    s_add_u32 m0, s101, 0x1c000
    s_nop 0
    buffer_load_dwordx4 v60, s[24:27], s91 offen lds
    s_waitcnt lgkmcnt(6)
    v_mfma_f32_32x32x16_bf16 v[64:79], v[28:31], v[104:107], v[64:79]
    ds_read_b128 v[116:119], v53 offset:16384
    ds_read_b64_tr_b16 v[28:29], v17 offset:8192
    ds_read_b64_tr_b16 v[30:31], v17 offset:8704
    s_add_u32 m0, s101, 0x1e000
    s_nop 0
    buffer_load_dwordx4 v60, s[28:31], s91 offen lds
    s_waitcnt lgkmcnt(6)
    v_mfma_f32_32x32x16_bf16 v[64:79], v[20:23], v[108:111], v[64:79]
    ds_read_b128 v[120:123], v54 offset:16384
    ds_read_b64_tr_b16 v[20:21], v18 offset:8192
    ds_read_b64_tr_b16 v[22:23], v18 offset:8704
    s_add_u32 m0, s101, 0x8000
    s_nop 0
    buffer_load_dwordx4 v61, s[48:51], s82 offen lds
    s_waitcnt vmcnt(7)
    s_waitcnt lgkmcnt(6)
    v_mfma_f32_32x32x16_bf16 v[64:79], v[24:27], v[112:115], v[64:79]
    s_barrier
    v_dot2c_f32_bf16 v5, s10, v24
    v_dot2c_f32_bf16 v5, s10, v25
    v_dot2c_f32_bf16 v5, s10, v26
    v_dot2c_f32_bf16 v5, s10, v27
    ds_read_b128 v[124:127], v55 offset:16384
    ds_read_b64_tr_b16 v[24:25], v19 offset:8192
    ds_read_b64_tr_b16 v[26:27], v19 offset:8704
    v_dot2c_f32_bf16 v58, s10, v100
    v_dot2c_f32_bf16 v59, v100, v100
    v_dot2c_f32_bf16 v58, s10, v101
    v_dot2c_f32_bf16 v59, v101, v101
    v_dot2c_f32_bf16 v58, s10, v102
    v_dot2c_f32_bf16 v59, v102, v102
    v_dot2c_f32_bf16 v58, s10, v103
    v_dot2c_f32_bf16 v59, v103, v103
    v_dot2c_f32_bf16 v58, s10, v112
    v_dot2c_f32_bf16 v59, v112, v112
    v_dot2c_f32_bf16 v58, s10, v113
    v_dot2c_f32_bf16 v59, v113, v113
    v_dot2c_f32_bf16 v58, s10, v114
    v_dot2c_f32_bf16 v59, v114, v114
    v_dot2c_f32_bf16 v58, s10, v115
    v_dot2c_f32_bf16 v59, v115, v115
    s_add_u32 m0, s101, 0x20000
    s_nop 0
    buffer_load_dwordx4 v60, s[24:27], s92 offen lds
    s_waitcnt lgkmcnt(6)
    v_mfma_f32_32x32x16_bf16 v[64:79], v[28:31], v[116:119], v[64:79]
    ds_read_b128 v[128:131], v48
    ds_read_b64_tr_b16 v[28:29], v16 offset:16384
    ds_read_b64_tr_b16 v[30:31], v16 offset:16896
    s_add_u32 m0, s101, 0x22000
    s_nop 0
    buffer_load_dwordx4 v60, s[28:31], s92 offen lds
    s_waitcnt lgkmcnt(6)
    v_mfma_f32_32x32x16_bf16 v[64:79], v[20:23], v[120:123], v[64:79]
    ds_read_b128 v[132:135], v49
    ds_read_b64_tr_b16 v[20:21], v17 offset:16384
    ds_read_b64_tr_b16 v[22:23], v17 offset:16896
    s_add_u32 m0, s101, 0xa000
    s_nop 0
    buffer_load_dwordx4 v61, s[48:51], s83 offen lds
    s_waitcnt lgkmcnt(6)
    v_mfma_f32_32x32x16_bf16 v[64:79], v[24:27], v[124:127], v[64:79]
    ds_read_b128 v[136:139], v50
    ds_read_b64_tr_b16 v[24:25], v18 offset:16384
    ds_read_b64_tr_b16 v[26:27], v18 offset:16896
    s_add_u32 m0, s101, 0x10000
    s_nop 0
    buffer_load_dwordx4 v60, s[24:27], s93 offen lds
    s_waitcnt vmcnt(5)
    s_waitcnt lgkmcnt(6)
    v_mfma_f32_32x32x16_bf16 v[64:79], v[28:31], v[128:131], v[64:79]
    s_barrier
    v_dot2c_f32_bf16 v5, s10, v28
    v_dot2c_f32_bf16 v5, s10, v29
    v_dot2c_f32_bf16 v5, s10, v30
    v_dot2c_f32_bf16 v5, s10, v31
    ds_read_b128 v[140:143], v51
    ds_read_b64_tr_b16 v[28:29], v19 offset:16384
    ds_read_b64_tr_b16 v[30:31], v19 offset:16896
    v_dot2c_f32_bf16 v58, s10, v116
    v_dot2c_f32_bf16 v59, v116, v116
    v_dot2c_f32_bf16 v58, s10, v117
    v_dot2c_f32_bf16 v59, v117, v117
    v_dot2c_f32_bf16 v58, s10, v118
    v_dot2c_f32_bf16 v59, v118, v118
    v_dot2c_f32_bf16 v58, s10, v119
    v_dot2c_f32_bf16 v59, v119, v119
    v_dot2c_f32_bf16 v58, s10, v128
    v_dot2c_f32_bf16 v59, v128, v128
    v_dot2c_f32_bf16 v58, s10, v129
    v_dot2c_f32_bf16 v59, v129, v129
    v_dot2c_f32_bf16 v58, s10, v130
    v_dot2c_f32_bf16 v59, v130, v130
    v_dot2c_f32_bf16 v58, s10, v131
    v_dot2c_f32_bf16 v59, v131, v131
    s_add_u32 m0, s101, 0x12000
    s_nop 0
    buffer_load_dwordx4 v60, s[28:31], s93 offen lds
    s_waitcnt lgkmcnt(6)
    v_mfma_f32_32x32x16_bf16 v[64:79], v[20:23], v[132:135], v[64:79]
    ds_read_b128 v[144:147], v48 offset:16384
    ds_read_b64_tr_b16 v[20:21], v16 offset:24576
    ds_read_b64_tr_b16 v[22:23], v16 offset:25088
    s_add_u32 m0, s101, 0xc000
    s_nop 0
    buffer_load_dwordx4 v61, s[48:51], s84 offen lds
    s_waitcnt lgkmcnt(6)
    v_mfma_f32_32x32x16_bf16 v[64:79], v[24:27], v[136:139], v[64:79]
    ds_read_b128 v[148:151], v49 offset:16384
    ds_read_b64_tr_b16 v[24:25], v17 offset:24576
    ds_read_b64_tr_b16 v[26:27], v17 offset:25088
    s_add_u32 m0, s101, 0x14000
    s_nop 0
    buffer_load_dwordx4 v60, s[24:27], s94 offen lds
    s_waitcnt lgkmcnt(6)
    v_mfma_f32_32x32x16_bf16 v[64:79], v[28:31], v[140:143], v[64:79]
    ds_read_b128 v[152:155], v50 offset:16384
    ds_read_b64_tr_b16 v[28:29], v18 offset:24576
    ds_read_b64_tr_b16 v[30:31], v18 offset:25088
    s_add_u32 m0, s101, 0x16000
    s_nop 0
    buffer_load_dwordx4 v60, s[28:31], s94 offen lds
    s_waitcnt vmcnt(6)
    s_waitcnt lgkmcnt(6)
    v_mfma_f32_32x32x16_bf16 v[64:79], v[20:23], v[144:147], v[64:79]
    s_barrier
    v_dot2c_f32_bf16 v5, s10, v20
    v_dot2c_f32_bf16 v5, s10, v21
    v_dot2c_f32_bf16 v5, s10, v22
    v_dot2c_f32_bf16 v5, s10, v23
    ds_read_b128 v[156:159], v51 offset:16384
    ds_read_b64_tr_b16 v[20:21], v19 offset:24576
    ds_read_b64_tr_b16 v[22:23], v19 offset:25088
    v_dot2c_f32_bf16 v58, s10, v132
    v_dot2c_f32_bf16 v59, v132, v132
    v_dot2c_f32_bf16 v58, s10, v133
    v_dot2c_f32_bf16 v59, v133, v133
    v_dot2c_f32_bf16 v58, s10, v134
    v_dot2c_f32_bf16 v59, v134, v134
    v_dot2c_f32_bf16 v58, s10, v135
    v_dot2c_f32_bf16 v59, v135, v135
    v_dot2c_f32_bf16 v58, s10, v144
    v_dot2c_f32_bf16 v59, v144, v144
    v_dot2c_f32_bf16 v58, s10, v145
    v_dot2c_f32_bf16 v59, v145, v145
    v_dot2c_f32_bf16 v58, s10, v146
    v_dot2c_f32_bf16 v59, v146, v146
    v_dot2c_f32_bf16 v58, s10, v147
    v_dot2c_f32_bf16 v59, v147, v147
    s_add_u32 m0, s101, 0xe000
    s_nop 0
    buffer_load_dwordx4 v61, s[48:51], s85 offen lds
    s_waitcnt lgkmcnt(6)
    v_mfma_f32_32x32x16_bf16 v[64:79], v[24:27], v[148:151], v[64:79]
    ds_read_b128 v[160:163], v48 offset:32768
    ds_read_b64_tr_b16 v[24:25], v16 offset:32768
    ds_read_b64_tr_b16 v[26:27], v16 offset:33280
    s_add_u32 m0, s101, 0x18000
    s_nop 0
    buffer_load_dwordx4 v60, s[24:27], s95 offen lds
    s_waitcnt lgkmcnt(6)
    v_mfma_f32_32x32x16_bf16 v[64:79], v[28:31], v[152:155], v[64:79]
    ds_read_b128 v[164:167], v49 offset:32768
    ds_read_b64_tr_b16 v[28:29], v17 offset:32768
    ds_read_b64_tr_b16 v[30:31], v17 offset:33280
    s_add_u32 m0, s101, 0x1a000
    s_nop 0
    buffer_load_dwordx4 v60, s[28:31], s95 offen lds
    s_waitcnt lgkmcnt(6)
    v_mfma_f32_32x32x16_bf16 v[64:79], v[20:23], v[156:159], v[64:79]
    ds_read_b128 v[168:171], v50 offset:32768
    ds_read_b64_tr_b16 v[20:21], v18 offset:32768
    ds_read_b64_tr_b16 v[22:23], v18 offset:33280
    s_add_u32 m0, s101, 0
    s_nop 0
    buffer_load_dwordx4 v61, s[48:51], s86 offen lds
    s_waitcnt vmcnt(7)
    s_waitcnt lgkmcnt(6)
    v_mfma_f32_32x32x16_bf16 v[64:79], v[24:27], v[160:163], v[64:79]
    s_barrier
    v_dot2c_f32_bf16 v5, s10, v24
    v_dot2c_f32_bf16 v5, s10, v25
    v_dot2c_f32_bf16 v5, s10, v26
    v_dot2c_f32_bf16 v5, s10, v27
    ds_read_b128 v[172:175], v51 offset:32768
    ds_read_b64_tr_b16 v[24:25], v19 offset:32768
    ds_read_b64_tr_b16 v[26:27], v19 offset:33280
    v_dot2c_f32_bf16 v58, s10, v148
    v_dot2c_f32_bf16 v59, v148, v148
    v_dot2c_f32_bf16 v58, s10, v149
    v_dot2c_f32_bf16 v59, v149, v149
    v_dot2c_f32_bf16 v58, s10, v150
    v_dot2c_f32_bf16 v59, v150, v150
    v_dot2c_f32_bf16 v58, s10, v151
    v_dot2c_f32_bf16 v59, v151, v151
    v_dot2c_f32_bf16 v58, s10, v160
    v_dot2c_f32_bf16 v59, v160, v160
    v_dot2c_f32_bf16 v58, s10, v161
    v_dot2c_f32_bf16 v59, v161, v161
    v_dot2c_f32_bf16 v58, s10, v162
    v_dot2c_f32_bf16 v59, v162, v162
    v_dot2c_f32_bf16 v58, s10, v163
    v_dot2c_f32_bf16 v59, v163, v163
    s_add_u32 m0, s101, 0x1c000
    s_nop 0
    buffer_load_dwordx4 v60, s[24:27], s96 offen lds
    s_waitcnt lgkmcnt(6)
    v_mfma_f32_32x32x16_bf16 v[64:79], v[28:31], v[164:167], v[64:79]
    ds_read_b128 v[176:179], v52
    ds_read_b64_tr_b16 v[28:29], v16 offset:40960
    ds_read_b64_tr_b16 v[30:31], v16 offset:41472
    s_add_u32 m0, s101, 0x1e000
    s_nop 0
    buffer_load_dwordx4 v60, s[28:31], s96 offen lds
    s_waitcnt lgkmcnt(6)
    v_mfma_f32_32x32x16_bf16 v[64:79], v[20:23], v[168:171], v[64:79]
    ds_read_b128 v[180:183], v53
    ds_read_b64_tr_b16 v[20:21], v17 offset:40960
    ds_read_b64_tr_b16 v[22:23], v17 offset:41472
    s_add_u32 m0, s101, 0x2000
    s_nop 0
    buffer_load_dwordx4 v61, s[48:51], s87 offen lds
    s_waitcnt lgkmcnt(6)
    v_mfma_f32_32x32x16_bf16 v[64:79], v[24:27], v[172:175], v[64:79]
    ds_read_b128 v[184:187], v54
    ds_read_b64_tr_b16 v[24:25], v18 offset:40960
    ds_read_b64_tr_b16 v[26:27], v18 offset:41472
    s_add_u32 m0, s101, 0x4000
    s_nop 0
    buffer_load_dwordx4 v0, s[32:35], s78 offen lds
    s_waitcnt vmcnt(8)
    s_waitcnt lgkmcnt(6)
    v_mfma_f32_32x32x16_bf16 v[64:79], v[28:31], v[176:179], v[64:79]
    s_barrier
    v_dot2c_f32_bf16 v5, s10, v28
    v_dot2c_f32_bf16 v5, s10, v29
    v_dot2c_f32_bf16 v5, s10, v30
    v_dot2c_f32_bf16 v5, s10, v31
    ds_read_b128 v[188:191], v55
    ds_read_b64_tr_b16 v[28:29], v19 offset:40960
    ds_read_b64_tr_b16 v[30:31], v19 offset:41472
    v_dot2c_f32_bf16 v58, s10, v164
    v_dot2c_f32_bf16 v59, v164, v164
    v_dot2c_f32_bf16 v58, s10, v165
    v_dot2c_f32_bf16 v59, v165, v165
    v_dot2c_f32_bf16 v58, s10, v166
    v_dot2c_f32_bf16 v59, v166, v166
    v_dot2c_f32_bf16 v58, s10, v167
    v_dot2c_f32_bf16 v59, v167, v167
    v_dot2c_f32_bf16 v58, s10, v176
    v_dot2c_f32_bf16 v59, v176, v176
    v_dot2c_f32_bf16 v58, s10, v177
    v_dot2c_f32_bf16 v59, v177, v177
    v_dot2c_f32_bf16 v58, s10, v178
    v_dot2c_f32_bf16 v59, v178, v178
    v_dot2c_f32_bf16 v58, s10, v179
    v_dot2c_f32_bf16 v59, v179, v179
    s_add_u32 m0, s101, 0x20000
    s_nop 0
    buffer_load_dwordx4 v60, s[24:27], s97 offen lds
    s_waitcnt lgkmcnt(6)
    v_mfma_f32_32x32x16_bf16 v[64:79], v[20:23], v[180:183], v[64:79]
    ds_read_b128 v[192:195], v52 offset:16384
    ds_read_b64_tr_b16 v[20:21], v16 offset:49152
    ds_read_b64_tr_b16 v[22:23], v16 offset:49664
    s_add_u32 m0, s101, 0x22000
    s_nop 0
    buffer_load_dwordx4 v60, s[28:31], s97 offen lds
    s_waitcnt lgkmcnt(6)
    v_mfma_f32_32x32x16_bf16 v[64:79], v[24:27], v[184:187], v[64:79]
    ds_read_b128 v[196:199], v53 offset:16384
    ds_read_b64_tr_b16 v[24:25], v17 offset:49152
    ds_read_b64_tr_b16 v[26:27], v17 offset:49664
    s_add_u32 m0, s101, 0x6000
    s_nop 0
    buffer_load_dwordx4 v0, s[36:39], s78 offen lds
    s_waitcnt lgkmcnt(6)
    v_mfma_f32_32x32x16_bf16 v[64:79], v[28:31], v[188:191], v[64:79]
    ds_read_b128 v[200:203], v54 offset:16384
    ds_read_b64_tr_b16 v[28:29], v18 offset:49152
    ds_read_b64_tr_b16 v[30:31], v18 offset:49664
    s_add_u32 m0, s101, 0x8000
    s_nop 0
    buffer_load_dwordx4 v0, s[32:35], s79 offen lds
    s_waitcnt vmcnt(9)
    s_waitcnt lgkmcnt(6)
    v_mfma_f32_32x32x16_bf16 v[64:79], v[20:23], v[192:195], v[64:79]
    s_barrier
    v_dot2c_f32_bf16 v5, s10, v20
    v_dot2c_f32_bf16 v5, s10, v21
    v_dot2c_f32_bf16 v5, s10, v22
    v_dot2c_f32_bf16 v5, s10, v23
    ds_read_b128 v[204:207], v55 offset:16384
    ds_read_b64_tr_b16 v[20:21], v19 offset:49152
    ds_read_b64_tr_b16 v[22:23], v19 offset:49664
    v_dot2c_f32_bf16 v58, s10, v180
    v_dot2c_f32_bf16 v59, v180, v180
    v_dot2c_f32_bf16 v58, s10, v181
    v_dot2c_f32_bf16 v59, v181, v181
    v_dot2c_f32_bf16 v58, s10, v182
    v_dot2c_f32_bf16 v59, v182, v182
    v_dot2c_f32_bf16 v58, s10, v183
    v_dot2c_f32_bf16 v59, v183, v183
    v_dot2c_f32_bf16 v58, s10, v192
    v_dot2c_f32_bf16 v59, v192, v192
    v_dot2c_f32_bf16 v58, s10, v193
    v_dot2c_f32_bf16 v59, v193, v193
    v_dot2c_f32_bf16 v58, s10, v194
    v_dot2c_f32_bf16 v59, v194, v194
    v_dot2c_f32_bf16 v58, s10, v195
    v_dot2c_f32_bf16 v59, v195, v195
    s_add_u32 m0, s101, 0xa000
    s_nop 0
    buffer_load_dwordx4 v0, s[36:39], s79 offen lds
    s_waitcnt lgkmcnt(6)
    v_mfma_f32_32x32x16_bf16 v[64:79], v[24:27], v[196:199], v[64:79]
    ds_read_b128 v[208:211], v48
    ds_read_b64_tr_b16 v[24:25], v16 offset:57344
    ds_read_b64_tr_b16 v[26:27], v16 offset:57856
    s_waitcnt lgkmcnt(6)
    v_mfma_f32_32x32x16_bf16 v[64:79], v[28:31], v[200:203], v[64:79]
    ds_read_b128 v[212:215], v49
    ds_read_b64_tr_b16 v[28:29], v17 offset:57344
    ds_read_b64_tr_b16 v[30:31], v17 offset:57856
    s_waitcnt lgkmcnt(6)
    v_mfma_f32_32x32x16_bf16 v[64:79], v[20:23], v[204:207], v[64:79]
    ds_read_b128 v[216:219], v50
    ds_read_b64_tr_b16 v[20:21], v18 offset:57344
    ds_read_b64_tr_b16 v[22:23], v18 offset:57856
    s_waitcnt vmcnt(7)
    s_waitcnt lgkmcnt(6)
    v_mfma_f32_32x32x16_bf16 v[64:79], v[24:27], v[208:211], v[64:79]
    s_barrier
    v_dot2c_f32_bf16 v5, s10, v24
    v_dot2c_f32_bf16 v5, s10, v25
    v_dot2c_f32_bf16 v5, s10, v26
    v_dot2c_f32_bf16 v5, s10, v27
    ds_read_b128 v[220:223], v51
    ds_read_b64_tr_b16 v[24:25], v19 offset:57344
    ds_read_b64_tr_b16 v[26:27], v19 offset:57856
    v_dot2c_f32_bf16 v58, s10, v196
    v_dot2c_f32_bf16 v59, v196, v196
    v_dot2c_f32_bf16 v58, s10, v197
    v_dot2c_f32_bf16 v59, v197, v197
    v_dot2c_f32_bf16 v58, s10, v198
    v_dot2c_f32_bf16 v59, v198, v198
    v_dot2c_f32_bf16 v58, s10, v199
    v_dot2c_f32_bf16 v59, v199, v199
    v_dot2c_f32_bf16 v58, s10, v208
    v_dot2c_f32_bf16 v59, v208, v208
    v_dot2c_f32_bf16 v58, s10, v209
    v_dot2c_f32_bf16 v59, v209, v209
    v_dot2c_f32_bf16 v58, s10, v210
    v_dot2c_f32_bf16 v59, v210, v210
    v_dot2c_f32_bf16 v58, s10, v211
    v_dot2c_f32_bf16 v59, v211, v211
    s_add_u32 m0, s101, 0xc000
    s_nop 0
    buffer_load_dwordx4 v0, s[32:35], s80 offen lds
    s_waitcnt lgkmcnt(6)
    v_mfma_f32_32x32x16_bf16 v[64:79], v[28:31], v[212:215], v[64:79]
    ds_read_b128 v[224:227], v48 offset:16384
    ds_read_b64_tr_b16 v[28:29], v16
    ds_read_b64_tr_b16 v[30:31], v16 offset:512
    s_waitcnt lgkmcnt(6)
    v_mfma_f32_32x32x16_bf16 v[64:79], v[20:23], v[216:219], v[64:79]
    ds_read_b128 v[228:231], v49 offset:16384
    ds_read_b64_tr_b16 v[20:21], v17
    ds_read_b64_tr_b16 v[22:23], v17 offset:512
    s_waitcnt lgkmcnt(6)
    v_mfma_f32_32x32x16_bf16 v[64:79], v[24:27], v[220:223], v[64:79]
    ds_read_b128 v[232:235], v50 offset:16384
    ds_read_b64_tr_b16 v[24:25], v18
    ds_read_b64_tr_b16 v[26:27], v18 offset:512
    s_waitcnt vmcnt(4)
    s_waitcnt lgkmcnt(6)
    v_mfma_f32_32x32x16_bf16 v[64:79], v[28:31], v[224:227], v[64:79]
    s_barrier
    v_dot2c_f32_bf16 v5, s10, v28
    v_dot2c_f32_bf16 v5, s10, v29
    v_dot2c_f32_bf16 v5, s10, v30
    v_dot2c_f32_bf16 v5, s10, v31
    ds_read_b128 v[236:239], v51 offset:16384
    ds_read_b64_tr_b16 v[28:29], v19
    ds_read_b64_tr_b16 v[30:31], v19 offset:512
    v_dot2c_f32_bf16 v58, s10, v212
    v_dot2c_f32_bf16 v59, v212, v212
    v_dot2c_f32_bf16 v58, s10, v213
    v_dot2c_f32_bf16 v59, v213, v213
    v_dot2c_f32_bf16 v58, s10, v214
    v_dot2c_f32_bf16 v59, v214, v214
    v_dot2c_f32_bf16 v58, s10, v215
    v_dot2c_f32_bf16 v59, v215, v215
    v_dot2c_f32_bf16 v58, s10, v224
    v_dot2c_f32_bf16 v59, v224, v224
    v_dot2c_f32_bf16 v58, s10, v225
    v_dot2c_f32_bf16 v59, v225, v225
    v_dot2c_f32_bf16 v58, s10, v226
    v_dot2c_f32_bf16 v59, v226, v226
    v_dot2c_f32_bf16 v58, s10, v227
    v_dot2c_f32_bf16 v59, v227, v227
    s_add_u32 m0, s101, 0xe000
    s_nop 0
    buffer_load_dwordx4 v0, s[36:39], s80 offen lds
    s_waitcnt lgkmcnt(6)
    v_mfma_f32_32x32x16_bf16 v[64:79], v[20:23], v[228:231], v[64:79]
    ds_read_b128 v[240:243], v48 offset:32768
    ds_read_b64_tr_b16 v[20:21], v16 offset:8192
    ds_read_b64_tr_b16 v[22:23], v16 offset:8704
    s_waitcnt lgkmcnt(6)
    v_mfma_f32_32x32x16_bf16 v[64:79], v[24:27], v[232:235], v[64:79]
    ds_read_b128 v[244:247], v49 offset:32768
    ds_read_b64_tr_b16 v[24:25], v17 offset:8192
    ds_read_b64_tr_b16 v[26:27], v17 offset:8704
    s_waitcnt lgkmcnt(6)
    v_mfma_f32_32x32x16_bf16 v[64:79], v[28:31], v[236:239], v[64:79]
    ds_read_b128 v[248:251], v50 offset:32768
    ds_read_b64_tr_b16 v[28:29], v18 offset:8192
    ds_read_b64_tr_b16 v[30:31], v18 offset:8704
    s_waitcnt vmcnt(4)
    s_waitcnt lgkmcnt(6)
    v_mfma_f32_32x32x16_bf16 v[64:79], v[20:23], v[240:243], v[64:79]
    s_barrier
    v_dot2c_f32_bf16 v5, s10, v20
    v_dot2c_f32_bf16 v5, s10, v21
    v_dot2c_f32_bf16 v5, s10, v22
    v_dot2c_f32_bf16 v5, s10, v23
    ds_read_b128 v[252:255], v51 offset:32768
    ds_read_b64_tr_b16 v[20:21], v19 offset:8192
    ds_read_b64_tr_b16 v[22:23], v19 offset:8704
    v_dot2c_f32_bf16 v58, s10, v228
    v_dot2c_f32_bf16 v59, v228, v228
    v_dot2c_f32_bf16 v58, s10, v229
    v_dot2c_f32_bf16 v59, v229, v229
    v_dot2c_f32_bf16 v58, s10, v230
    v_dot2c_f32_bf16 v59, v230, v230
    v_dot2c_f32_bf16 v58, s10, v231
    v_dot2c_f32_bf16 v59, v231, v231
    v_dot2c_f32_bf16 v58, s10, v240
    v_dot2c_f32_bf16 v59, v240, v240
    v_dot2c_f32_bf16 v58, s10, v241
    v_dot2c_f32_bf16 v59, v241, v241
    v_dot2c_f32_bf16 v58, s10, v242
    v_dot2c_f32_bf16 v59, v242, v242
    v_dot2c_f32_bf16 v58, s10, v243
    v_dot2c_f32_bf16 v59, v243, v243
    s_waitcnt lgkmcnt(8)
    v_dot2c_f32_bf16 v58, s10, v244
    v_dot2c_f32_bf16 v59, v244, v244
    v_dot2c_f32_bf16 v58, s10, v245
    v_dot2c_f32_bf16 v59, v245, v245
    v_dot2c_f32_bf16 v58, s10, v246
    v_dot2c_f32_bf16 v59, v246, v246
    v_dot2c_f32_bf16 v58, s10, v247
    v_dot2c_f32_bf16 v59, v247, v247
    s_add_u32 m0, s101, 0
    s_nop 0
    buffer_load_dwordx4 v0, s[32:35], s81 offen lds
    s_waitcnt lgkmcnt(6)
    v_mfma_f32_32x32x16_bf16 v[64:79], v[24:27], v[244:247], v[64:79]
    ds_read_b64_tr_b16 v[24:25], v16 offset:16384
    ds_read_b64_tr_b16 v[26:27], v16 offset:16896
    ds_write_b32 v8, v5
    v_mov_b32 v5, 0
    ds_write_b64 v56, v[58:59]
    s_waitcnt lgkmcnt(7)
    v_mfma_f32_32x32x16_bf16 v[64:79], v[28:31], v[248:251], v[64:79]
    ds_read_b64_tr_b16 v[28:29], v16 offset:24576
    ds_read_b64_tr_b16 v[30:31], v16 offset:25088
    s_waitcnt lgkmcnt(6)
    v_mfma_f32_32x32x16_bf16 v[32:47], v[20:23], v[252:255], v[64:79]
    ds_read_b64_tr_b16 v[20:21], v17 offset:16384
    ds_read_b64_tr_b16 v[22:23], v17 offset:16896
    s_waitcnt vmcnt(3)
    s_waitcnt lgkmcnt(4)
    v_mfma_f32_32x32x16_bf16 v[64:79], v[24:27], v[96:99], 0
    s_barrier
    s_add_u32 m0, s101, 0x2000
    s_nop 0
    buffer_load_dwordx4 v0, s[36:39], s81 offen lds
    v_mbcnt_lo_u32_b32 v9, -1, 0
    v_mbcnt_hi_u32_b32 v9, -1, v9
    v_and_b32 v9, 31, v9
    s_waitcnt lgkmcnt(2)
    v_mfma_f32_32x32x16_bf16 v[80:95], v[28:31], v[96:99], 0
    v_dot2c_f32_bf16 v5, s10, v24
    v_dot2c_f32_bf16 v5, s10, v25
    v_dot2c_f32_bf16 v5, s10, v26
    v_dot2c_f32_bf16 v5, s10, v27
    v_dot2c_f32_bf16 v6, s10, v28
    v_dot2c_f32_bf16 v6, s10, v29
    v_dot2c_f32_bf16 v6, s10, v30
    v_dot2c_f32_bf16 v6, s10, v31
    ds_read_b64_tr_b16 v[24:25], v17 offset:24576
    ds_read_b64_tr_b16 v[26:27], v17 offset:25088
    ds_read_b64_tr_b16 v[28:29], v18 offset:16384
    ds_read_b64_tr_b16 v[30:31], v18 offset:16896
    s_waitcnt lgkmcnt(4)
    v_mfma_f32_32x32x16_bf16 v[64:79], v[20:23], v[100:103], v[64:79]
    ds_read_b64_tr_b16 v[20:21], v18 offset:24576
    ds_read_b64_tr_b16 v[22:23], v18 offset:25088
    v_lshl_add_u32 v9, v9, 5, s12
    ds_read_b128 v[48:51], v9
    ds_read_b128 v[52:55], v9 offset:16
    v_mbcnt_lo_u32_b32 v14, -1, 0
    v_mbcnt_hi_u32_b32 v14, -1, v14
    s_waitcnt lgkmcnt(6)
    v_mfma_f32_32x32x16_bf16 v[80:95], v[24:27], v[100:103], v[80:95]
    ds_read_b64_tr_b16 v[24:25], v19 offset:16384
    ds_read_b64_tr_b16 v[26:27], v19 offset:16896
    v_lshrrev_b32 v15, 5, v14
    v_lshlrev_b32 v15, 10, v15
    v_lshl_add_u32 v15, v14, 5, v15
    v_add_u32 v15, s13, v15
    s_waitcnt lgkmcnt(6)
    v_mfma_f32_32x32x16_bf16 v[64:79], v[28:31], v[104:107], v[64:79]
    ds_read_b64_tr_b16 v[28:29], v19 offset:24576
    ds_read_b64_tr_b16 v[30:31], v19 offset:25088
    ds_read_b128 v[10:13], v15
    v_lshl_add_u32 v14, v14, 2, s14
    s_waitcnt lgkmcnt(6)
    v_add_f32 v4, v48, v50
    v_add_f32 v3, v49, v51
    s_waitcnt lgkmcnt(5)
    v_add_f32 v52, v52, v54
    v_mfma_f32_32x32x16_bf16 v[80:95], v[20:23], v[104:107], v[80:95]
    ds_read_b64_tr_b16 v[20:21], v16 offset:32768
    ds_read_b64_tr_b16 v[22:23], v16 offset:33280
    v_add_f32 v53, v53, v55
    v_add_f32 v4, v4, v52
    v_add_f32 v3, v3, v53
    v_mul_f32 v4, 0x3acccccd, v4
    s_waitcnt lgkmcnt(5)
    v_mfma_f32_32x32x16_bf16 v[64:79], v[24:27], v[108:111], v[64:79]
    ds_read_b64_tr_b16 v[24:25], v16 offset:40960
    ds_read_b64_tr_b16 v[26:27], v16 offset:41472
    v_mul_f32 v3, 0x3acccccd, v3
    v_fma_f32 v3, -v4, v4, v3
    v_max_f32 v3, 0, v3
    s_waitcnt lgkmcnt(5)
    v_mfma_f32_32x32x16_bf16 v[80:95], v[28:31], v[108:111], v[80:95]
    ds_read_b64_tr_b16 v[28:29], v17 offset:32768
    ds_read_b64_tr_b16 v[30:31], v17 offset:33280
    s_waitcnt vmcnt(2)
    s_waitcnt lgkmcnt(4)
    v_mfma_f32_32x32x16_bf16 v[64:79], v[20:23], v[112:115], v[64:79]
    s_barrier
    s_add_u32 m0, s101, 0x4000
    s_nop 0
    buffer_load_dwordx4 v0, s[32:35], s82 offen lds
    v_add_f32 v1, v10, v11
    v_add_f32 v12, v12, v13
    v_add_f32 v1, v1, v12
    ds_read_b128 v[10:13], v15 offset:16
    v_cvt_pk_bf16_f32 v48, v4, v3
    v_lshlrev_b32 v4, 16, v48
    v_and_b32 v3, 0xffff0000, v48
    v_add_f32 v3, 0x3727c5ac, v3
    s_waitcnt lgkmcnt(3)
    v_mfma_f32_32x32x16_bf16 v[80:95], v[24:27], v[112:115], v[80:95]
    v_dot2c_f32_bf16 v5, s10, v20
    v_dot2c_f32_bf16 v5, s10, v21
    v_dot2c_f32_bf16 v5, s10, v22
    v_dot2c_f32_bf16 v5, s10, v23
    v_dot2c_f32_bf16 v6, s10, v24
    v_dot2c_f32_bf16 v6, s10, v25
    v_dot2c_f32_bf16 v6, s10, v26
    v_dot2c_f32_bf16 v6, s10, v27
    ds_read_b64_tr_b16 v[20:21], v17 offset:40960
    ds_read_b64_tr_b16 v[22:23], v17 offset:41472
    ds_read_b64_tr_b16 v[24:25], v18 offset:32768
    ds_read_b64_tr_b16 v[26:27], v18 offset:33280
    s_add_u32 m0, s101, 0x6000
    s_nop 0
    buffer_load_dwordx4 v0, s[36:39], s82 offen lds
    s_waitcnt lgkmcnt(5)
    v_mfma_f32_32x32x16_bf16 v[64:79], v[28:31], v[116:119], v[64:79]
    ds_read_b64_tr_b16 v[28:29], v18 offset:40960
    ds_read_b64_tr_b16 v[30:31], v18 offset:41472
    v_cvt_pk_bf16_f32 v48, v3, v3
    v_lshlrev_b32 v3, 16, v48
    v_sqrt_f32 v3, v3
    s_waitcnt lgkmcnt(4)
    v_mfma_f32_32x32x16_bf16 v[80:95], v[20:23], v[116:119], v[80:95]
    ds_read_b64_tr_b16 v[20:21], v19 offset:32768
    ds_read_b64_tr_b16 v[22:23], v19 offset:33280
    v_sub_f32 v4, 0, v4
    v_cvt_pk_bf16_f32 v48, v3, v3
    v_lshlrev_b32 v3, 16, v48
    s_waitcnt lgkmcnt(4)
    v_mfma_f32_32x32x16_bf16 v[64:79], v[24:27], v[120:123], v[64:79]
    ds_read_b64_tr_b16 v[24:25], v19 offset:40960
    ds_read_b64_tr_b16 v[26:27], v19 offset:41472
    v_rcp_f32 v3, v3
    s_waitcnt lgkmcnt(4)
    v_mfma_f32_32x32x16_bf16 v[80:95], v[28:31], v[120:123], v[80:95]
    ds_read_b64_tr_b16 v[28:29], v16 offset:49152
    ds_read_b64_tr_b16 v[30:31], v16 offset:49664
    s_waitcnt lgkmcnt(4)
    v_mfma_f32_32x32x16_bf16 v[64:79], v[20:23], v[124:127], v[64:79]
    ds_read_b64_tr_b16 v[20:21], v16 offset:57344
    ds_read_b64_tr_b16 v[22:23], v16 offset:57856
    v_add_f32 v10, v10, v11
    v_add_f32 v12, v12, v13
    v_add_f32 v1, v1, v10
    v_add_f32 v1, v1, v12
    ds_write_b32 v14, v1
    ds_read_b128 v[10:13], v7
    s_waitcnt lgkmcnt(6)
    v_mfma_f32_32x32x16_bf16 v[80:95], v[24:27], v[124:127], v[80:95]
    ds_read_b64_tr_b16 v[24:25], v17 offset:49152
    ds_read_b64_tr_b16 v[26:27], v17 offset:49664
    s_waitcnt vmcnt(2)
    s_waitcnt lgkmcnt(6)
    v_mfma_f32_32x32x16_bf16 v[64:79], v[28:31], v[128:131], v[64:79]
    s_barrier
    s_add_u32 m0, s101, 0x8000
    s_nop 0
    buffer_load_dwordx4 v0, s[32:35], s83 offen lds
    s_waitcnt lgkmcnt(2)
    v_fmac_f32 v32, v4, v10
    v_fmac_f32 v33, v4, v11
    v_fmac_f32 v34, v4, v12
    v_fmac_f32 v35, v4, v13
    v_mul_f32 v32, v3, v32
    v_mul_f32 v33, v3, v33
    v_mul_f32 v34, v3, v34
    v_mul_f32 v35, v3, v35
    v_mul_f32 v14, 0x3fb8aa3b, v32
    v_mul_f32 v15, 0x3fb8aa3b, v33
    v_mul_f32 v9, 0x3fb8aa3b, v34
    v_mul_f32 v1, 0x3fb8aa3b, v35
    v_mfma_f32_32x32x16_bf16 v[80:95], v[20:23], v[128:131], v[80:95]
    v_dot2c_f32_bf16 v5, s10, v28
    v_dot2c_f32_bf16 v5, s10, v29
    v_dot2c_f32_bf16 v5, s10, v30
    v_dot2c_f32_bf16 v5, s10, v31
    v_dot2c_f32_bf16 v6, s10, v20
    v_dot2c_f32_bf16 v6, s10, v21
    v_dot2c_f32_bf16 v6, s10, v22
    v_dot2c_f32_bf16 v6, s10, v23
    ds_read_b64_tr_b16 v[28:29], v17 offset:57344
    ds_read_b64_tr_b16 v[30:31], v17 offset:57856
    ds_read_b64_tr_b16 v[20:21], v18 offset:49152
    ds_read_b64_tr_b16 v[22:23], v18 offset:49664
    s_add_u32 m0, s101, 0xa000
    s_nop 0
    buffer_load_dwordx4 v0, s[36:39], s83 offen lds
    s_waitcnt lgkmcnt(4)
    v_mfma_f32_32x32x16_bf16 v[64:79], v[24:27], v[132:135], v[64:79]
    ds_read_b64_tr_b16 v[24:25], v18 offset:57344
    ds_read_b64_tr_b16 v[26:27], v18 offset:57856
    v_min_f32 v14, 0, v14
    v_min_f32 v15, 0, v15
    v_min_f32 v9, 0, v9
    s_waitcnt lgkmcnt(4)
    v_mfma_f32_32x32x16_bf16 v[80:95], v[28:31], v[132:135], v[80:95]
    ds_read_b64_tr_b16 v[28:29], v19 offset:49152
    ds_read_b64_tr_b16 v[30:31], v19 offset:49664
    v_min_f32 v1, 0, v1
    v_exp_f32 v14, v14
    v_exp_f32 v15, v15
    s_waitcnt lgkmcnt(4)
    v_mfma_f32_32x32x16_bf16 v[64:79], v[20:23], v[136:139], v[64:79]
    ds_read_b64_tr_b16 v[20:21], v19 offset:57344
    ds_read_b64_tr_b16 v[22:23], v19 offset:57856
    v_exp_f32 v9, v9
    v_exp_f32 v1, v1
    s_waitcnt lgkmcnt(4)
    v_mfma_f32_32x32x16_bf16 v[80:95], v[24:27], v[136:139], v[80:95]
    ds_read_b64_tr_b16 v[24:25], v16
    ds_read_b64_tr_b16 v[26:27], v16 offset:512
    v_max_f32 v10, 0x358637bd, v32
    v_max_f32 v11, 0x358637bd, v33
    v_max_f32 v12, 0x358637bd, v34
    v_max_f32 v13, 0x358637bd, v35
    s_waitcnt lgkmcnt(4)
    v_mfma_f32_32x32x16_bf16 v[64:79], v[28:31], v[140:143], v[64:79]
    ds_read_b64_tr_b16 v[28:29], v16 offset:8192
    ds_read_b64_tr_b16 v[30:31], v16 offset:8704
    v_add_f32 v14, v10, v14
    v_add_f32 v15, v11, v15
    v_add_f32 v9, v12, v9
    v_add_f32 v1, v13, v1
    s_waitcnt lgkmcnt(4)
    v_mfma_f32_32x32x16_bf16 v[80:95], v[20:23], v[140:143], v[80:95]
    ds_read_b64_tr_b16 v[20:21], v17
    ds_read_b64_tr_b16 v[22:23], v17 offset:512
    v_cndmask_b32 v32, v14, v32, s[52:53]
    v_cndmask_b32 v33, v15, v33, s[52:53]
    v_cndmask_b32 v34, v9, v34, s[52:53]
    v_cndmask_b32 v35, v1, v35, s[52:53]
    s_waitcnt vmcnt(2)
    s_waitcnt lgkmcnt(4)
    v_mfma_f32_32x32x16_bf16 v[64:79], v[24:27], v[144:147], v[64:79]
    s_barrier
    s_add_u32 m0, s101, 0xc000
    s_nop 0
    buffer_load_dwordx4 v0, s[32:35], s84 offen lds
    v_cvt_pk_bf16_f32 v32, v32, v33
    v_cvt_pk_bf16_f32 v33, v34, v35
    ds_write_b64 v2, v[32:33]
    s_waitcnt lgkmcnt(3)
    v_mfma_f32_32x32x16_bf16 v[80:95], v[28:31], v[144:147], v[80:95]
    v_dot2c_f32_bf16 v5, s10, v24
    v_dot2c_f32_bf16 v5, s10, v25
    v_dot2c_f32_bf16 v5, s10, v26
    v_dot2c_f32_bf16 v5, s10, v27
    v_dot2c_f32_bf16 v6, s10, v28
    v_dot2c_f32_bf16 v6, s10, v29
    v_dot2c_f32_bf16 v6, s10, v30
    v_dot2c_f32_bf16 v6, s10, v31
    ds_read_b64_tr_b16 v[24:25], v17 offset:8192
    ds_read_b64_tr_b16 v[26:27], v17 offset:8704
    ds_read_b64_tr_b16 v[28:29], v18
    ds_read_b64_tr_b16 v[30:31], v18 offset:512
    s_add_u32 m0, s101, 0xe000
    s_nop 0
    buffer_load_dwordx4 v0, s[36:39], s84 offen lds
    s_waitcnt lgkmcnt(5)
    v_mfma_f32_32x32x16_bf16 v[64:79], v[20:23], v[148:151], v[64:79]
    ds_read_b64_tr_b16 v[20:21], v18 offset:8192
    ds_read_b64_tr_b16 v[22:23], v18 offset:8704
    ds_read_b128 v[10:13], v7 offset:32
    s_waitcnt lgkmcnt(5)
    v_mfma_f32_32x32x16_bf16 v[80:95], v[24:27], v[148:151], v[80:95]
    ds_read_b64_tr_b16 v[24:25], v19
    ds_read_b64_tr_b16 v[26:27], v19 offset:512
    s_waitcnt lgkmcnt(5)
    v_mfma_f32_32x32x16_bf16 v[64:79], v[28:31], v[152:155], v[64:79]
    ds_read_b64_tr_b16 v[28:29], v19 offset:8192
    ds_read_b64_tr_b16 v[30:31], v19 offset:8704
    s_waitcnt lgkmcnt(4)
    v_fmac_f32 v36, v4, v10
    v_fmac_f32 v37, v4, v11
    v_fmac_f32 v38, v4, v12
    v_fmac_f32 v39, v4, v13
    v_mul_f32 v36, v3, v36
    v_mul_f32 v37, v3, v37
    v_mul_f32 v38, v3, v38
    v_mul_f32 v39, v3, v39
    v_mul_f32 v14, 0x3fb8aa3b, v36
    v_mul_f32 v15, 0x3fb8aa3b, v37
    v_mul_f32 v9, 0x3fb8aa3b, v38
    v_mfma_f32_32x32x16_bf16 v[80:95], v[20:23], v[152:155], v[80:95]
    ds_read_b64_tr_b16 v[20:21], v16 offset:16384
    ds_read_b64_tr_b16 v[22:23], v16 offset:16896
    v_mul_f32 v1, 0x3fb8aa3b, v39
    v_min_f32 v14, 0, v14
    v_min_f32 v15, 0, v15
    v_min_f32 v9, 0, v9
    s_waitcnt lgkmcnt(4)
    v_mfma_f32_32x32x16_bf16 v[64:79], v[24:27], v[156:159], v[64:79]
    ds_read_b64_tr_b16 v[24:25], v16 offset:24576
    ds_read_b64_tr_b16 v[26:27], v16 offset:25088
    v_min_f32 v1, 0, v1
    v_exp_f32 v14, v14
    v_exp_f32 v15, v15
    s_waitcnt lgkmcnt(4)
    v_mfma_f32_32x32x16_bf16 v[80:95], v[28:31], v[156:159], v[80:95]
    ds_read_b64_tr_b16 v[28:29], v17 offset:16384
    ds_read_b64_tr_b16 v[30:31], v17 offset:16896
    v_exp_f32 v9, v9
    v_exp_f32 v1, v1
    s_waitcnt vmcnt(2)
    s_waitcnt lgkmcnt(4)
    v_mfma_f32_32x32x16_bf16 v[64:79], v[20:23], v[160:163], v[64:79]
    s_barrier
    s_add_u32 m0, s101, 0
    s_nop 0
    buffer_load_dwordx4 v0, s[32:35], s85 offen lds
    v_max_f32 v10, 0x358637bd, v36
    v_max_f32 v11, 0x358637bd, v37
    s_waitcnt lgkmcnt(2)
    v_mfma_f32_32x32x16_bf16 v[80:95], v[24:27], v[160:163], v[80:95]
    v_dot2c_f32_bf16 v5, s10, v20
    v_dot2c_f32_bf16 v5, s10, v21
    v_dot2c_f32_bf16 v5, s10, v22
    v_dot2c_f32_bf16 v5, s10, v23
    v_dot2c_f32_bf16 v6, s10, v24
    v_dot2c_f32_bf16 v6, s10, v25
    v_dot2c_f32_bf16 v6, s10, v26
    v_dot2c_f32_bf16 v6, s10, v27
    ds_read_b64_tr_b16 v[20:21], v17 offset:24576
    ds_read_b64_tr_b16 v[22:23], v17 offset:25088
    ds_read_b64_tr_b16 v[24:25], v18 offset:16384
    ds_read_b64_tr_b16 v[26:27], v18 offset:16896
    s_add_u32 m0, s101, 0x2000
    s_nop 0
    buffer_load_dwordx4 v0, s[36:39], s85 offen lds
    s_waitcnt lgkmcnt(4)
    v_mfma_f32_32x32x16_bf16 v[64:79], v[28:31], v[164:167], v[64:79]
    ds_read_b64_tr_b16 v[28:29], v18 offset:24576
    ds_read_b64_tr_b16 v[30:31], v18 offset:25088
    v_max_f32 v12, 0x358637bd, v38
    v_max_f32 v13, 0x358637bd, v39
    s_waitcnt lgkmcnt(4)
    v_mfma_f32_32x32x16_bf16 v[80:95], v[20:23], v[164:167], v[80:95]
    ds_read_b64_tr_b16 v[20:21], v19 offset:16384
    ds_read_b64_tr_b16 v[22:23], v19 offset:16896
    v_add_f32 v14, v10, v14
    v_add_f32 v15, v11, v15
    v_add_f32 v9, v12, v9
    v_add_f32 v1, v13, v1
    s_waitcnt lgkmcnt(4)
    v_mfma_f32_32x32x16_bf16 v[64:79], v[24:27], v[168:171], v[64:79]
    ds_read_b64_tr_b16 v[24:25], v19 offset:24576
    ds_read_b64_tr_b16 v[26:27], v19 offset:25088
    v_cndmask_b32 v36, v14, v36, s[52:53]
    v_cndmask_b32 v37, v15, v37, s[52:53]
    v_cndmask_b32 v38, v9, v38, s[52:53]
    v_cndmask_b32 v39, v1, v39, s[52:53]
    v_cvt_pk_bf16_f32 v36, v36, v37
    s_waitcnt lgkmcnt(4)
    v_mfma_f32_32x32x16_bf16 v[80:95], v[28:31], v[168:171], v[80:95]
    ds_read_b64_tr_b16 v[28:29], v16 offset:32768
    ds_read_b64_tr_b16 v[30:31], v16 offset:33280
    v_cvt_pk_bf16_f32 v37, v38, v39
    ds_write_b64 v2, v[36:37] offset:16
    ds_read_b128 v[10:13], v7 offset:64
    s_waitcnt lgkmcnt(6)
    v_mfma_f32_32x32x16_bf16 v[64:79], v[20:23], v[172:175], v[64:79]
    ds_read_b64_tr_b16 v[20:21], v16 offset:40960
    ds_read_b64_tr_b16 v[22:23], v16 offset:41472
    s_waitcnt lgkmcnt(6)
    v_mfma_f32_32x32x16_bf16 v[80:95], v[24:27], v[172:175], v[80:95]
    ds_read_b64_tr_b16 v[24:25], v17 offset:32768
    ds_read_b64_tr_b16 v[26:27], v17 offset:33280
    s_waitcnt lgkmcnt(4)
    v_fmac_f32 v40, v4, v10
    v_fmac_f32 v41, v4, v11
    v_fmac_f32 v42, v4, v12
    v_fmac_f32 v43, v4, v13
    v_mul_f32 v40, v3, v40
    v_mul_f32 v41, v3, v41
    v_mul_f32 v42, v3, v42
    v_mul_f32 v43, v3, v43
    v_mul_f32 v14, 0x3fb8aa3b, v40
    v_mul_f32 v15, 0x3fb8aa3b, v41
    s_waitcnt vmcnt(2)
    v_mfma_f32_32x32x16_bf16 v[64:79], v[28:31], v[176:179], v[64:79]
    s_barrier
    s_add_u32 m0, s101, 0x4000
    s_nop 0
    buffer_load_dwordx4 v0, s[32:35], s86 offen lds
    v_mul_f32 v9, 0x3fb8aa3b, v42
    v_mul_f32 v1, 0x3fb8aa3b, v43
    v_min_f32 v14, 0, v14
    s_waitcnt lgkmcnt(2)
    v_mfma_f32_32x32x16_bf16 v[80:95], v[20:23], v[176:179], v[80:95]
    v_dot2c_f32_bf16 v5, s10, v28
    v_dot2c_f32_bf16 v5, s10, v29
    v_dot2c_f32_bf16 v5, s10, v30
    v_dot2c_f32_bf16 v5, s10, v31
    v_dot2c_f32_bf16 v6, s10, v20
    v_dot2c_f32_bf16 v6, s10, v21
    v_dot2c_f32_bf16 v6, s10, v22
    v_dot2c_f32_bf16 v6, s10, v23
    ds_read_b64_tr_b16 v[28:29], v17 offset:40960
    ds_read_b64_tr_b16 v[30:31], v17 offset:41472
    ds_read_b64_tr_b16 v[20:21], v18 offset:32768
    ds_read_b64_tr_b16 v[22:23], v18 offset:33280
    s_add_u32 m0, s101, 0x6000
    s_nop 0
    buffer_load_dwordx4 v0, s[36:39], s86 offen lds
    s_waitcnt lgkmcnt(4)
    v_mfma_f32_32x32x16_bf16 v[64:79], v[24:27], v[180:183], v[64:79]
    ds_read_b64_tr_b16 v[24:25], v18 offset:40960
    ds_read_b64_tr_b16 v[26:27], v18 offset:41472
    v_min_f32 v15, 0, v15
    v_min_f32 v9, 0, v9
    s_waitcnt lgkmcnt(4)
    v_mfma_f32_32x32x16_bf16 v[80:95], v[28:31], v[180:183], v[80:95]
    ds_read_b64_tr_b16 v[28:29], v19 offset:32768
    ds_read_b64_tr_b16 v[30:31], v19 offset:33280
    v_min_f32 v1, 0, v1
    v_exp_f32 v14, v14
    v_exp_f32 v15, v15
    s_waitcnt lgkmcnt(4)
    v_mfma_f32_32x32x16_bf16 v[64:79], v[20:23], v[184:187], v[64:79]
    ds_read_b64_tr_b16 v[20:21], v19 offset:40960
    ds_read_b64_tr_b16 v[22:23], v19 offset:41472
    v_exp_f32 v9, v9
    v_exp_f32 v1, v1
    s_waitcnt lgkmcnt(4)
    v_mfma_f32_32x32x16_bf16 v[80:95], v[24:27], v[184:187], v[80:95]
    ds_read_b64_tr_b16 v[24:25], v16 offset:49152
    ds_read_b64_tr_b16 v[26:27], v16 offset:49664
    v_max_f32 v10, 0x358637bd, v40
    v_max_f32 v11, 0x358637bd, v41
    v_max_f32 v12, 0x358637bd, v42
    v_max_f32 v13, 0x358637bd, v43
    s_waitcnt lgkmcnt(4)
    v_mfma_f32_32x32x16_bf16 v[64:79], v[28:31], v[188:191], v[64:79]
    ds_read_b64_tr_b16 v[28:29], v16 offset:57344
    ds_read_b64_tr_b16 v[30:31], v16 offset:57856
    v_add_f32 v14, v10, v14
    v_add_f32 v15, v11, v15
    v_add_f32 v9, v12, v9
    v_add_f32 v1, v13, v1
    s_waitcnt lgkmcnt(4)
    v_mfma_f32_32x32x16_bf16 v[80:95], v[20:23], v[188:191], v[80:95]
    ds_read_b64_tr_b16 v[20:21], v17 offset:49152
    ds_read_b64_tr_b16 v[22:23], v17 offset:49664
    v_cndmask_b32 v40, v14, v40, s[52:53]
    v_cndmask_b32 v41, v15, v41, s[52:53]
    v_cndmask_b32 v42, v9, v42, s[52:53]
    v_cndmask_b32 v43, v1, v43, s[52:53]
    s_waitcnt vmcnt(2)
    s_waitcnt lgkmcnt(4)
    v_mfma_f32_32x32x16_bf16 v[64:79], v[24:27], v[192:195], v[64:79]
    s_barrier
    s_add_u32 m0, s101, 0x8000
    s_nop 0
    buffer_load_dwordx4 v0, s[32:35], s87 offen lds
    v_cvt_pk_bf16_f32 v40, v40, v41
    v_cvt_pk_bf16_f32 v41, v42, v43
    ds_write_b64 v2, v[40:41] offset:32
    s_waitcnt lgkmcnt(3)
    v_mfma_f32_32x32x16_bf16 v[80:95], v[28:31], v[192:195], v[80:95]
    v_dot2c_f32_bf16 v5, s10, v24
    v_dot2c_f32_bf16 v5, s10, v25
    v_dot2c_f32_bf16 v5, s10, v26
    v_dot2c_f32_bf16 v5, s10, v27
    v_dot2c_f32_bf16 v6, s10, v28
    v_dot2c_f32_bf16 v6, s10, v29
    v_dot2c_f32_bf16 v6, s10, v30
    v_dot2c_f32_bf16 v6, s10, v31
    ds_read_b64_tr_b16 v[24:25], v17 offset:57344
    ds_read_b64_tr_b16 v[26:27], v17 offset:57856
    ds_read_b64_tr_b16 v[28:29], v18 offset:49152
    ds_read_b64_tr_b16 v[30:31], v18 offset:49664
    s_add_u32 m0, s101, 0xa000
    s_nop 0
    buffer_load_dwordx4 v0, s[36:39], s87 offen lds
    s_waitcnt lgkmcnt(5)
    v_mfma_f32_32x32x16_bf16 v[64:79], v[20:23], v[196:199], v[64:79]
    ds_read_b64_tr_b16 v[20:21], v18 offset:57344
    ds_read_b64_tr_b16 v[22:23], v18 offset:57856
    ds_read_b128 v[10:13], v7 offset:96
    s_waitcnt lgkmcnt(5)
    v_mfma_f32_32x32x16_bf16 v[80:95], v[24:27], v[196:199], v[80:95]
    ds_read_b64_tr_b16 v[24:25], v19 offset:49152
    ds_read_b64_tr_b16 v[26:27], v19 offset:49664
    s_waitcnt lgkmcnt(5)
    v_mfma_f32_32x32x16_bf16 v[64:79], v[28:31], v[200:203], v[64:79]
    ds_read_b64_tr_b16 v[28:29], v19 offset:57344
    ds_read_b64_tr_b16 v[30:31], v19 offset:57856
    s_waitcnt lgkmcnt(4)
    v_fmac_f32 v44, v4, v10
    v_fmac_f32 v45, v4, v11
    v_fmac_f32 v46, v4, v12
    v_fmac_f32 v47, v4, v13
    v_mul_f32 v44, v3, v44
    v_mul_f32 v45, v3, v45
    v_mul_f32 v46, v3, v46
    v_mul_f32 v47, v3, v47
    v_mul_f32 v14, 0x3fb8aa3b, v44
    v_mul_f32 v15, 0x3fb8aa3b, v45
    v_mul_f32 v9, 0x3fb8aa3b, v46
    v_mfma_f32_32x32x16_bf16 v[80:95], v[20:23], v[200:203], v[80:95]
    ds_read_b64_tr_b16 v[20:21], v16
    ds_read_b64_tr_b16 v[22:23], v16 offset:512
    v_mul_f32 v1, 0x3fb8aa3b, v47
    v_min_f32 v14, 0, v14
    v_min_f32 v15, 0, v15
    v_min_f32 v9, 0, v9
    s_waitcnt lgkmcnt(4)
    v_mfma_f32_32x32x16_bf16 v[64:79], v[24:27], v[204:207], v[64:79]
    ds_read_b64_tr_b16 v[24:25], v16 offset:8192
    ds_read_b64_tr_b16 v[26:27], v16 offset:8704
    v_min_f32 v1, 0, v1
    v_exp_f32 v14, v14
    v_exp_f32 v15, v15
    s_waitcnt lgkmcnt(4)
    v_mfma_f32_32x32x16_bf16 v[80:95], v[28:31], v[204:207], v[80:95]
    ds_read_b64_tr_b16 v[28:29], v17
    ds_read_b64_tr_b16 v[30:31], v17 offset:512
    v_exp_f32 v9, v9
    v_exp_f32 v1, v1
    s_waitcnt vmcnt(2)
    s_waitcnt lgkmcnt(4)
    v_mfma_f32_32x32x16_bf16 v[64:79], v[20:23], v[208:211], v[64:79]
    s_barrier
    s_add_u32 m0, s101, 0xc000
    s_nop 0
    buffer_load_dwordx4 v0, s[40:43], s78 offen lds
    v_max_f32 v10, 0x358637bd, v44
    v_max_f32 v11, 0x358637bd, v45
    s_waitcnt lgkmcnt(2)
    v_mfma_f32_32x32x16_bf16 v[80:95], v[24:27], v[208:211], v[80:95]
    v_dot2c_f32_bf16 v5, s10, v20
    v_dot2c_f32_bf16 v5, s10, v21
    v_dot2c_f32_bf16 v5, s10, v22
    v_dot2c_f32_bf16 v5, s10, v23
    v_dot2c_f32_bf16 v6, s10, v24
    v_dot2c_f32_bf16 v6, s10, v25
    v_dot2c_f32_bf16 v6, s10, v26
    v_dot2c_f32_bf16 v6, s10, v27
    ds_read_b64_tr_b16 v[20:21], v17 offset:8192
    ds_read_b64_tr_b16 v[22:23], v17 offset:8704
    ds_read_b64_tr_b16 v[24:25], v18
    ds_read_b64_tr_b16 v[26:27], v18 offset:512
    s_add_u32 m0, s101, 0xe000
    s_nop 0
    buffer_load_dwordx4 v0, s[44:47], s78 offen lds
    s_waitcnt lgkmcnt(4)
    v_mfma_f32_32x32x16_bf16 v[64:79], v[28:31], v[212:215], v[64:79]
    ds_read_b64_tr_b16 v[28:29], v18 offset:8192
    ds_read_b64_tr_b16 v[30:31], v18 offset:8704
    v_max_f32 v12, 0x358637bd, v46
    v_max_f32 v13, 0x358637bd, v47
    v_add_f32 v14, v10, v14
    s_waitcnt lgkmcnt(4)
    v_mfma_f32_32x32x16_bf16 v[80:95], v[20:23], v[212:215], v[80:95]
    ds_read_b64_tr_b16 v[20:21], v19
    ds_read_b64_tr_b16 v[22:23], v19 offset:512
    v_add_f32 v15, v11, v15
    v_add_f32 v9, v12, v9
    v_add_f32 v1, v13, v1
    v_cndmask_b32 v44, v14, v44, s[52:53]
    s_waitcnt lgkmcnt(4)
    v_mfma_f32_32x32x16_bf16 v[64:79], v[24:27], v[216:219], v[64:79]
    ds_read_b64_tr_b16 v[24:25], v19 offset:8192
    ds_read_b64_tr_b16 v[26:27], v19 offset:8704
    v_cndmask_b32 v45, v15, v45, s[52:53]
    v_cndmask_b32 v46, v9, v46, s[52:53]
    v_cndmask_b32 v47, v1, v47, s[52:53]
    v_cvt_pk_bf16_f32 v44, v44, v45
    s_waitcnt lgkmcnt(4)
    v_mfma_f32_32x32x16_bf16 v[80:95], v[28:31], v[216:219], v[80:95]
    ds_read_b64_tr_b16 v[28:29], v16 offset:16384
    ds_read_b64_tr_b16 v[30:31], v16 offset:16896
    v_cvt_pk_bf16_f32 v45, v46, v47
    ds_write_b64 v2, v[44:45] offset:48
    s_mul_i32 s3, s11, 0x140
    v_add_u32 v2, s3, v2
    s_mul_i32 s3, s100, 0xa3c0
    s_add_u32 s3, s3, 0x100
    v_subrev_u32 v2, s3, v2
    s_waitcnt lgkmcnt(5)
    v_mfma_f32_32x32x16_bf16 v[64:79], v[20:23], v[220:223], v[64:79]
    ds_read_b64_tr_b16 v[20:21], v16 offset:24576
    ds_read_b64_tr_b16 v[22:23], v16 offset:25088
    s_waitcnt lgkmcnt(5)
    v_mfma_f32_32x32x16_bf16 v[80:95], v[24:27], v[220:223], v[80:95]
    ds_read_b64_tr_b16 v[24:25], v17 offset:16384
    ds_read_b64_tr_b16 v[26:27], v17 offset:16896
    s_waitcnt vmcnt(2)
    s_waitcnt lgkmcnt(5)
    v_mfma_f32_32x32x16_bf16 v[64:79], v[28:31], v[224:227], v[64:79]
    s_barrier
    s_add_u32 m0, s101, 0
    s_nop 0
    buffer_load_dwordx4 v0, s[40:43], s79 offen lds
    s_waitcnt lgkmcnt(2)
    v_mfma_f32_32x32x16_bf16 v[80:95], v[20:23], v[224:227], v[80:95]
    v_dot2c_f32_bf16 v5, s10, v28
    v_dot2c_f32_bf16 v5, s10, v29
    v_dot2c_f32_bf16 v5, s10, v30
    v_dot2c_f32_bf16 v5, s10, v31
    v_dot2c_f32_bf16 v6, s10, v20
    v_dot2c_f32_bf16 v6, s10, v21
    v_dot2c_f32_bf16 v6, s10, v22
    v_dot2c_f32_bf16 v6, s10, v23
    ds_read_b64_tr_b16 v[28:29], v17 offset:24576
    ds_read_b64_tr_b16 v[30:31], v17 offset:25088
    ds_read_b64_tr_b16 v[20:21], v18 offset:16384
    ds_read_b64_tr_b16 v[22:23], v18 offset:16896
    s_add_u32 m0, s101, 0x2000
    s_nop 0
    buffer_load_dwordx4 v0, s[44:47], s79 offen lds
    s_waitcnt lgkmcnt(4)
    v_mfma_f32_32x32x16_bf16 v[64:79], v[24:27], v[228:231], v[64:79]
    ds_read_b64_tr_b16 v[24:25], v18 offset:24576
    ds_read_b64_tr_b16 v[26:27], v18 offset:25088
    s_waitcnt lgkmcnt(4)
    v_mfma_f32_32x32x16_bf16 v[80:95], v[28:31], v[228:231], v[80:95]
    ds_read_b64_tr_b16 v[28:29], v19 offset:16384
    ds_read_b64_tr_b16 v[30:31], v19 offset:16896
    s_waitcnt lgkmcnt(4)
    v_mfma_f32_32x32x16_bf16 v[64:79], v[20:23], v[232:235], v[64:79]
    ds_read_b64_tr_b16 v[20:21], v19 offset:24576
    ds_read_b64_tr_b16 v[22:23], v19 offset:25088
    s_waitcnt lgkmcnt(4)
    v_mfma_f32_32x32x16_bf16 v[80:95], v[24:27], v[232:235], v[80:95]
    ds_read_b64_tr_b16 v[24:25], v16 offset:32768
    ds_read_b64_tr_b16 v[26:27], v16 offset:33280
    s_waitcnt lgkmcnt(4)
    v_mfma_f32_32x32x16_bf16 v[64:79], v[28:31], v[236:239], v[64:79]
    ds_read_b64_tr_b16 v[28:29], v16 offset:40960
    ds_read_b64_tr_b16 v[30:31], v16 offset:41472
    s_waitcnt lgkmcnt(4)
    v_mfma_f32_32x32x16_bf16 v[80:95], v[20:23], v[236:239], v[80:95]
    ds_read_b64_tr_b16 v[20:21], v17 offset:32768
    ds_read_b64_tr_b16 v[22:23], v17 offset:33280
    s_waitcnt vmcnt(2)
    s_waitcnt lgkmcnt(4)
    v_mfma_f32_32x32x16_bf16 v[64:79], v[24:27], v[240:243], v[64:79]
    s_barrier
    s_add_u32 m0, s101, 0x4000
    s_nop 0
    buffer_load_dwordx4 v0, s[40:43], s80 offen lds
    s_waitcnt lgkmcnt(2)
    v_mfma_f32_32x32x16_bf16 v[80:95], v[28:31], v[240:243], v[80:95]
    v_dot2c_f32_bf16 v5, s10, v24
    v_dot2c_f32_bf16 v5, s10, v25
    v_dot2c_f32_bf16 v5, s10, v26
    v_dot2c_f32_bf16 v5, s10, v27
    v_dot2c_f32_bf16 v6, s10, v28
    v_dot2c_f32_bf16 v6, s10, v29
    v_dot2c_f32_bf16 v6, s10, v30
    v_dot2c_f32_bf16 v6, s10, v31
    ds_read_b64_tr_b16 v[24:25], v17 offset:40960
    ds_read_b64_tr_b16 v[26:27], v17 offset:41472
    ds_read_b64_tr_b16 v[28:29], v18 offset:32768
    ds_read_b64_tr_b16 v[30:31], v18 offset:33280
    s_add_u32 m0, s101, 0x6000
    s_nop 0
    buffer_load_dwordx4 v0, s[44:47], s80 offen lds
    s_waitcnt lgkmcnt(4)
    v_mfma_f32_32x32x16_bf16 v[64:79], v[20:23], v[244:247], v[64:79]
    ds_read_b64_tr_b16 v[20:21], v18 offset:40960
    ds_read_b64_tr_b16 v[22:23], v18 offset:41472
    s_waitcnt lgkmcnt(4)
    v_mfma_f32_32x32x16_bf16 v[80:95], v[24:27], v[244:247], v[80:95]
    ds_read_b64_tr_b16 v[24:25], v19 offset:32768
    ds_read_b64_tr_b16 v[26:27], v19 offset:33280
    ds_write_b32 v8, v5
    v_mov_b32 v5, 0
    ds_write_b32 v8, v6 offset:2048
    v_mov_b32 v6, 0
    s_waitcnt lgkmcnt(6)
    v_mfma_f32_32x32x16_bf16 v[64:79], v[28:31], v[248:251], v[64:79]
    ds_read_b64_tr_b16 v[28:29], v19 offset:40960
    ds_read_b64_tr_b16 v[30:31], v19 offset:41472
    s_waitcnt lgkmcnt(6)
    v_mfma_f32_32x32x16_bf16 v[80:95], v[20:23], v[248:251], v[80:95]
    ds_read_b64_tr_b16 v[20:21], v16 offset:49152
    ds_read_b64_tr_b16 v[22:23], v16 offset:49664
    s_waitcnt lgkmcnt(6)
    v_mfma_f32_32x32x16_bf16 v[32:47], v[24:27], v[252:255], v[64:79]
    ds_read_b64_tr_b16 v[24:25], v16 offset:57344
    ds_read_b64_tr_b16 v[26:27], v16 offset:57856
    s_waitcnt lgkmcnt(4)
    v_mfma_f32_32x32x16_bf16 v[48:63], v[28:31], v[252:255], v[80:95]
    ds_read_b64_tr_b16 v[28:29], v17 offset:49152
    ds_read_b64_tr_b16 v[30:31], v17 offset:49664
    s_waitcnt vmcnt(2)
    s_waitcnt lgkmcnt(4)
    v_mfma_f32_32x32x16_bf16 v[64:79], v[20:23], v[96:99], 0
    s_barrier
    s_add_u32 m0, s101, 0x8000
    s_nop 0
    buffer_load_dwordx4 v0, s[40:43], s81 offen lds
    v_mbcnt_lo_u32_b32 v14, -1, 0
    v_mbcnt_hi_u32_b32 v14, -1, v14
    v_lshrrev_b32 v15, 5, v14
    v_lshlrev_b32 v15, 10, v15
    s_waitcnt lgkmcnt(2)
    v_mfma_f32_32x32x16_bf16 v[80:95], v[24:27], v[96:99], 0
    v_dot2c_f32_bf16 v5, s10, v20
    v_dot2c_f32_bf16 v5, s10, v21
    v_dot2c_f32_bf16 v5, s10, v22
    v_dot2c_f32_bf16 v5, s10, v23
    v_dot2c_f32_bf16 v6, s10, v24
    v_dot2c_f32_bf16 v6, s10, v25
    v_dot2c_f32_bf16 v6, s10, v26
    v_dot2c_f32_bf16 v6, s10, v27
    ds_read_b64_tr_b16 v[20:21], v17 offset:57344
    ds_read_b64_tr_b16 v[22:23], v17 offset:57856
    ds_read_b64_tr_b16 v[24:25], v18 offset:49152
    ds_read_b64_tr_b16 v[26:27], v18 offset:49664
    s_add_u32 m0, s101, 0xa000
    s_nop 0
    buffer_load_dwordx4 v0, s[44:47], s81 offen lds
    s_waitcnt lgkmcnt(4)
    v_mfma_f32_32x32x16_bf16 v[64:79], v[28:31], v[100:103], v[64:79]
    ds_read_b64_tr_b16 v[28:29], v18 offset:57344
    ds_read_b64_tr_b16 v[30:31], v18 offset:57856
    v_lshl_add_u32 v15, v14, 5, v15
    v_add_u32 v15, s13, v15
    ds_read_b128 v[10:13], v15
    v_lshl_add_u32 v14, v14, 2, s14
    s_waitcnt lgkmcnt(5)
    v_mfma_f32_32x32x16_bf16 v[80:95], v[20:23], v[100:103], v[80:95]
    ds_read_b64_tr_b16 v[20:21], v19 offset:49152
    ds_read_b64_tr_b16 v[22:23], v19 offset:49664
    s_waitcnt lgkmcnt(5)
    v_mfma_f32_32x32x16_bf16 v[64:79], v[24:27], v[104:107], v[64:79]
    ds_read_b64_tr_b16 v[24:25], v19 offset:57344
    ds_read_b64_tr_b16 v[26:27], v19 offset:57856
    s_waitcnt lgkmcnt(5)
    v_mfma_f32_32x32x16_bf16 v[80:95], v[28:31], v[104:107], v[80:95]
    ds_read_b64_tr_b16 v[28:29], v16
    ds_read_b64_tr_b16 v[30:31], v16 offset:512
    s_waitcnt lgkmcnt(6)
    v_add_f32 v1, v10, v11
    v_add_f32 v12, v12, v13
    v_add_f32 v1, v1, v12
    ds_read_b128 v[10:13], v15 offset:16
    s_waitcnt lgkmcnt(5)
    v_mfma_f32_32x32x16_bf16 v[64:79], v[20:23], v[108:111], v[64:79]
    ds_read_b64_tr_b16 v[20:21], v16 offset:8192
    ds_read_b64_tr_b16 v[22:23], v16 offset:8704
    s_waitcnt lgkmcnt(5)
    v_mfma_f32_32x32x16_bf16 v[80:95], v[24:27], v[108:111], v[80:95]
    ds_read_b64_tr_b16 v[24:25], v17
    ds_read_b64_tr_b16 v[26:27], v17 offset:512
    s_waitcnt lgkmcnt(4)
    v_add_f32 v10, v10, v11
    v_add_f32 v12, v12, v13
    v_add_f32 v1, v1, v10
    v_add_f32 v1, v1, v12
    ds_write_b32 v14, v1
    ds_read_b128 v[10:13], v7
    s_waitcnt vmcnt(2)
    v_mfma_f32_32x32x16_bf16 v[64:79], v[28:31], v[112:115], v[64:79]
    s_barrier
    s_and_b32 s3, s2, 7
    s_lshl_b32 s3, s3, 4
    s_add_u32 s3, s3, 0
    s_add_u32 s28, s8, s3
    s_addc_u32 s29, s9, 0
    s_cmp_eq_u32 s98, 0
    s_cselect_b32 s30, 4, 0
    s_mov_b32 s31, 0x20000
    v_mbcnt_lo_u32_b32 v99, -1, 0
    v_mbcnt_hi_u32_b32 v99, -1, v99
    v_lshlrev_b32 v99, 2, v99
    v_mov_b32 v98, 1
    buffer_atomic_add v98, v99, s[28:31], 0 offen
    s_add_u32 m0, s101, 0xc000
    s_nop 0
    buffer_load_dwordx4 v0, s[40:43], s82 offen lds
    s_waitcnt lgkmcnt(4)
    v_mfma_f32_32x32x16_bf16 v[80:95], v[20:23], v[112:115], v[80:95]
    v_dot2c_f32_bf16 v5, s10, v28
    v_dot2c_f32_bf16 v5, s10, v29
    v_dot2c_f32_bf16 v5, s10, v30
    v_dot2c_f32_bf16 v5, s10, v31
    v_dot2c_f32_bf16 v6, s10, v20
    v_dot2c_f32_bf16 v6, s10, v21
    v_dot2c_f32_bf16 v6, s10, v22
    v_dot2c_f32_bf16 v6, s10, v23
    ds_read_b64_tr_b16 v[28:29], v17 offset:8192
    ds_read_b64_tr_b16 v[30:31], v17 offset:8704
    ds_read_b64_tr_b16 v[20:21], v18
    ds_read_b64_tr_b16 v[22:23], v18 offset:512
    s_add_u32 m0, s101, 0xe000
    s_nop 0
    buffer_load_dwordx4 v0, s[44:47], s82 offen lds
    s_waitcnt lgkmcnt(4)
    v_fmac_f32 v32, v4, v10
    v_fmac_f32 v33, v4, v11
    v_fmac_f32 v34, v4, v12
    v_fmac_f32 v35, v4, v13
    ds_read_b128 v[10:13], v7 offset:32
    v_mul_f32 v32, v3, v32
    v_mul_f32 v33, v3, v33
    v_mul_f32 v34, v3, v34
    v_mul_f32 v35, v3, v35
    v_mul_f32 v14, 0x3fb8aa3b, v32
    v_mul_f32 v15, 0x3fb8aa3b, v33
    v_mul_f32 v9, 0x3fb8aa3b, v34
    v_mul_f32 v1, 0x3fb8aa3b, v35
    v_min_f32 v14, 0, v14
    v_min_f32 v15, 0, v15
    v_min_f32 v9, 0, v9
    v_min_f32 v1, 0, v1
    v_exp_f32 v14, v14
    v_mfma_f32_32x32x16_bf16 v[64:79], v[24:27], v[116:119], v[64:79]
    ds_read_b64_tr_b16 v[24:25], v18 offset:8192
    ds_read_b64_tr_b16 v[26:27], v18 offset:8704
    v_exp_f32 v15, v15
    v_exp_f32 v9, v9
    v_exp_f32 v1, v1
    s_waitcnt lgkmcnt(5)
    v_mfma_f32_32x32x16_bf16 v[80:95], v[28:31], v[116:119], v[80:95]
    ds_read_b64_tr_b16 v[28:29], v19
    ds_read_b64_tr_b16 v[30:31], v19 offset:512
    v_max_f32 v32, 0x358637bd, v32
    v_max_f32 v33, 0x358637bd, v33
    v_max_f32 v34, 0x358637bd, v34
    v_max_f32 v35, 0x358637bd, v35
    s_waitcnt lgkmcnt(5)
    v_mfma_f32_32x32x16_bf16 v[64:79], v[20:23], v[120:123], v[64:79]
    ds_read_b64_tr_b16 v[20:21], v19 offset:8192
    ds_read_b64_tr_b16 v[22:23], v19 offset:8704
    v_add_f32 v32, v32, v14
    v_add_f32 v33, v33, v15
    v_add_f32 v34, v34, v9
    v_add_f32 v35, v35, v1
    v_cvt_pk_bf16_f32 v32, v32, v33
    s_waitcnt lgkmcnt(4)
    v_mfma_f32_32x32x16_bf16 v[80:95], v[24:27], v[120:123], v[80:95]
    ds_read_b64_tr_b16 v[24:25], v16 offset:16384
    ds_read_b64_tr_b16 v[26:27], v16 offset:16896
    v_cvt_pk_bf16_f32 v33, v34, v35
    ds_write_b64 v2, v[32:33]
    v_fmac_f32 v36, v4, v10
    v_fmac_f32 v37, v4, v11
    v_fmac_f32 v38, v4, v12
    v_fmac_f32 v39, v4, v13
    s_waitcnt lgkmcnt(5)
    v_mfma_f32_32x32x16_bf16 v[64:79], v[28:31], v[124:127], v[64:79]
    ds_read_b64_tr_b16 v[28:29], v16 offset:24576
    ds_read_b64_tr_b16 v[30:31], v16 offset:25088
    ds_read_b128 v[10:13], v7 offset:64
    v_mul_f32 v36, v3, v36
    v_mul_f32 v37, v3, v37
    v_mul_f32 v38, v3, v38
    v_mul_f32 v39, v3, v39
    v_mul_f32 v14, 0x3fb8aa3b, v36
    s_waitcnt lgkmcnt(6)
    v_mfma_f32_32x32x16_bf16 v[80:95], v[20:23], v[124:127], v[80:95]
    ds_read_b64_tr_b16 v[20:21], v17 offset:16384
    ds_read_b64_tr_b16 v[22:23], v17 offset:16896
    v_mul_f32 v15, 0x3fb8aa3b, v37
    v_mul_f32 v9, 0x3fb8aa3b, v38
    v_mul_f32 v1, 0x3fb8aa3b, v39
    v_min_f32 v14, 0, v14
    v_min_f32 v15, 0, v15
    s_waitcnt vmcnt(3)
    s_waitcnt lgkmcnt(6)
    v_mfma_f32_32x32x16_bf16 v[64:79], v[24:27], v[128:131], v[64:79]
    s_barrier
    s_add_u32 m0, s101, 0
    s_nop 0
    buffer_load_dwordx4 v0, s[40:43], s83 offen lds
    v_min_f32 v9, 0, v9
    v_min_f32 v1, 0, v1
    v_exp_f32 v14, v14
    s_waitcnt lgkmcnt(3)
    v_mfma_f32_32x32x16_bf16 v[80:95], v[28:31], v[128:131], v[80:95]
    v_dot2c_f32_bf16 v5, s10, v24
    v_dot2c_f32_bf16 v5, s10, v25
    v_dot2c_f32_bf16 v5, s10, v26
    v_dot2c_f32_bf16 v5, s10, v27
    v_dot2c_f32_bf16 v6, s10, v28
    v_dot2c_f32_bf16 v6, s10, v29
    v_dot2c_f32_bf16 v6, s10, v30
    v_dot2c_f32_bf16 v6, s10, v31
    ds_read_b64_tr_b16 v[24:25], v17 offset:24576
    ds_read_b64_tr_b16 v[26:27], v17 offset:25088
    ds_read_b64_tr_b16 v[28:29], v18 offset:16384
    ds_read_b64_tr_b16 v[30:31], v18 offset:16896
    s_add_u32 m0, s101, 0x2000
    s_nop 0
    buffer_load_dwordx4 v0, s[44:47], s83 offen lds
    s_waitcnt lgkmcnt(4)
    v_mfma_f32_32x32x16_bf16 v[64:79], v[20:23], v[132:135], v[64:79]
    ds_read_b64_tr_b16 v[20:21], v18 offset:24576
    ds_read_b64_tr_b16 v[22:23], v18 offset:25088
    v_exp_f32 v15, v15
    v_exp_f32 v9, v9
    s_waitcnt lgkmcnt(4)
    v_mfma_f32_32x32x16_bf16 v[80:95], v[24:27], v[132:135], v[80:95]
    ds_read_b64_tr_b16 v[24:25], v19 offset:16384
    ds_read_b64_tr_b16 v[26:27], v19 offset:16896
    v_exp_f32 v1, v1
    v_max_f32 v36, 0x358637bd, v36
    v_max_f32 v37, 0x358637bd, v37
    s_waitcnt lgkmcnt(4)
    v_mfma_f32_32x32x16_bf16 v[64:79], v[28:31], v[136:139], v[64:79]
    ds_read_b64_tr_b16 v[28:29], v19 offset:24576
    ds_read_b64_tr_b16 v[30:31], v19 offset:25088
    v_max_f32 v38, 0x358637bd, v38
    v_max_f32 v39, 0x358637bd, v39
    v_add_f32 v36, v36, v14
    v_add_f32 v37, v37, v15
    v_add_f32 v38, v38, v9
    s_waitcnt lgkmcnt(4)
    v_mfma_f32_32x32x16_bf16 v[80:95], v[20:23], v[136:139], v[80:95]
    ds_read_b64_tr_b16 v[20:21], v16 offset:32768
    ds_read_b64_tr_b16 v[22:23], v16 offset:33280
    v_add_f32 v39, v39, v1
    v_cvt_pk_bf16_f32 v36, v36, v37
    v_cvt_pk_bf16_f32 v37, v38, v39
    ds_write_b64 v2, v[36:37] offset:16
    v_fmac_f32 v40, v4, v10
    v_fmac_f32 v41, v4, v11
    s_waitcnt lgkmcnt(5)
    v_mfma_f32_32x32x16_bf16 v[64:79], v[24:27], v[140:143], v[64:79]
    ds_read_b64_tr_b16 v[24:25], v16 offset:40960
    ds_read_b64_tr_b16 v[26:27], v16 offset:41472
    v_fmac_f32 v42, v4, v12
    v_fmac_f32 v43, v4, v13
    ds_read_b128 v[10:13], v7 offset:96
    v_mul_f32 v40, v3, v40
    v_mul_f32 v41, v3, v41
    s_waitcnt lgkmcnt(6)
    v_mfma_f32_32x32x16_bf16 v[80:95], v[28:31], v[140:143], v[80:95]
    ds_read_b64_tr_b16 v[28:29], v17 offset:32768
    ds_read_b64_tr_b16 v[30:31], v17 offset:33280
    v_mul_f32 v42, v3, v42
    v_mul_f32 v43, v3, v43
    v_mul_f32 v14, 0x3fb8aa3b, v40
    v_mul_f32 v15, 0x3fb8aa3b, v41
    v_mul_f32 v9, 0x3fb8aa3b, v42
    s_waitcnt vmcnt(2)
    s_waitcnt lgkmcnt(6)
    v_mfma_f32_32x32x16_bf16 v[64:79], v[20:23], v[144:147], v[64:79]
    s_barrier
    s_add_u32 m0, s101, 0x4000
    s_nop 0
    buffer_load_dwordx4 v0, s[40:43], s84 offen lds
    v_mul_f32 v1, 0x3fb8aa3b, v43
    v_min_f32 v14, 0, v14
    v_min_f32 v15, 0, v15
    v_min_f32 v9, 0, v9
    s_waitcnt lgkmcnt(3)
    v_mfma_f32_32x32x16_bf16 v[80:95], v[24:27], v[144:147], v[80:95]
    v_dot2c_f32_bf16 v5, s10, v20
    v_dot2c_f32_bf16 v5, s10, v21
    v_dot2c_f32_bf16 v5, s10, v22
    v_dot2c_f32_bf16 v5, s10, v23
    v_dot2c_f32_bf16 v6, s10, v24
    v_dot2c_f32_bf16 v6, s10, v25
    v_dot2c_f32_bf16 v6, s10, v26
    v_dot2c_f32_bf16 v6, s10, v27
    ds_read_b64_tr_b16 v[20:21], v17 offset:40960
    ds_read_b64_tr_b16 v[22:23], v17 offset:41472
    ds_read_b64_tr_b16 v[24:25], v18 offset:32768
    ds_read_b64_tr_b16 v[26:27], v18 offset:33280
    s_add_u32 m0, s101, 0x6000
    s_nop 0
    buffer_load_dwordx4 v0, s[44:47], s84 offen lds
    s_waitcnt lgkmcnt(4)
    v_mfma_f32_32x32x16_bf16 v[64:79], v[28:31], v[148:151], v[64:79]
    ds_read_b64_tr_b16 v[28:29], v18 offset:40960
    ds_read_b64_tr_b16 v[30:31], v18 offset:41472
    v_min_f32 v1, 0, v1
    v_exp_f32 v14, v14
    s_waitcnt lgkmcnt(4)
    v_mfma_f32_32x32x16_bf16 v[80:95], v[20:23], v[148:151], v[80:95]
    ds_read_b64_tr_b16 v[20:21], v19 offset:32768
    ds_read_b64_tr_b16 v[22:23], v19 offset:33280
    v_exp_f32 v15, v15
    v_exp_f32 v9, v9
    v_exp_f32 v1, v1
    s_waitcnt lgkmcnt(4)
    v_mfma_f32_32x32x16_bf16 v[64:79], v[24:27], v[152:155], v[64:79]
    ds_read_b64_tr_b16 v[24:25], v19 offset:40960
    ds_read_b64_tr_b16 v[26:27], v19 offset:41472
    v_max_f32 v40, 0x358637bd, v40
    v_max_f32 v41, 0x358637bd, v41
    v_max_f32 v42, 0x358637bd, v42
    v_max_f32 v43, 0x358637bd, v43
    v_add_f32 v40, v40, v14
    s_waitcnt lgkmcnt(4)
    v_mfma_f32_32x32x16_bf16 v[80:95], v[28:31], v[152:155], v[80:95]
    ds_read_b64_tr_b16 v[28:29], v16 offset:49152
    ds_read_b64_tr_b16 v[30:31], v16 offset:49664
    v_add_f32 v41, v41, v15
    v_add_f32 v42, v42, v9
    v_add_f32 v43, v43, v1
    v_cvt_pk_bf16_f32 v40, v40, v41
    v_cvt_pk_bf16_f32 v41, v42, v43
    s_waitcnt lgkmcnt(4)
    v_mfma_f32_32x32x16_bf16 v[64:79], v[20:23], v[156:159], v[64:79]
    ds_read_b64_tr_b16 v[20:21], v16 offset:57344
    ds_read_b64_tr_b16 v[22:23], v16 offset:57856
    ds_write_b64 v2, v[40:41] offset:32
    v_fmac_f32 v44, v4, v10
    v_fmac_f32 v45, v4, v11
    v_fmac_f32 v46, v4, v12
    v_fmac_f32 v47, v4, v13
    s_waitcnt lgkmcnt(5)
    v_mfma_f32_32x32x16_bf16 v[80:95], v[24:27], v[156:159], v[80:95]
    ds_read_b64_tr_b16 v[24:25], v17 offset:49152
    ds_read_b64_tr_b16 v[26:27], v17 offset:49664
    ds_read_b128 v[10:13], v7 offset:128
    v_mul_f32 v44, v3, v44
    v_mul_f32 v45, v3, v45
    v_mul_f32 v46, v3, v46
    v_mul_f32 v47, v3, v47
    v_mul_f32 v14, 0x3fb8aa3b, v44
    s_waitcnt vmcnt(2)
    s_waitcnt lgkmcnt(6)
    v_mfma_f32_32x32x16_bf16 v[64:79], v[28:31], v[160:163], v[64:79]
    s_barrier
    s_add_u32 m0, s101, 0x8000
    s_nop 0
    buffer_load_dwordx4 v0, s[40:43], s85 offen lds
    v_mul_f32 v15, 0x3fb8aa3b, v45
    v_mul_f32 v9, 0x3fb8aa3b, v46
    v_mul_f32 v1, 0x3fb8aa3b, v47
    s_waitcnt lgkmcnt(4)
    v_mfma_f32_32x32x16_bf16 v[80:95], v[20:23], v[160:163], v[80:95]
    v_dot2c_f32_bf16 v5, s10, v28
    v_dot2c_f32_bf16 v5, s10, v29
    v_dot2c_f32_bf16 v5, s10, v30
    v_dot2c_f32_bf16 v5, s10, v31
    v_dot2c_f32_bf16 v6, s10, v20
    v_dot2c_f32_bf16 v6, s10, v21
    v_dot2c_f32_bf16 v6, s10, v22
    v_dot2c_f32_bf16 v6, s10, v23
    ds_read_b64_tr_b16 v[28:29], v17 offset:57344
    ds_read_b64_tr_b16 v[30:31], v17 offset:57856
    ds_read_b64_tr_b16 v[20:21], v18 offset:49152
    ds_read_b64_tr_b16 v[22:23], v18 offset:49664
    s_add_u32 m0, s101, 0xa000
    s_nop 0
    buffer_load_dwordx4 v0, s[44:47], s85 offen lds
    s_waitcnt lgkmcnt(5)
    v_mfma_f32_32x32x16_bf16 v[64:79], v[24:27], v[164:167], v[64:79]
    ds_read_b64_tr_b16 v[24:25], v18 offset:57344
    ds_read_b64_tr_b16 v[26:27], v18 offset:57856
    v_min_f32 v14, 0, v14
    v_min_f32 v15, 0, v15
    v_min_f32 v9, 0, v9
    v_min_f32 v1, 0, v1
    s_waitcnt lgkmcnt(4)
    v_mfma_f32_32x32x16_bf16 v[80:95], v[28:31], v[164:167], v[80:95]
    ds_read_b64_tr_b16 v[28:29], v19 offset:49152
    ds_read_b64_tr_b16 v[30:31], v19 offset:49664
    v_exp_f32 v14, v14
    v_exp_f32 v15, v15
    v_exp_f32 v9, v9
    s_waitcnt lgkmcnt(4)
    v_mfma_f32_32x32x16_bf16 v[64:79], v[20:23], v[168:171], v[64:79]
    ds_read_b64_tr_b16 v[20:21], v19 offset:57344
    ds_read_b64_tr_b16 v[22:23], v19 offset:57856
    v_exp_f32 v1, v1
    v_max_f32 v44, 0x358637bd, v44
    v_max_f32 v45, 0x358637bd, v45
    s_waitcnt lgkmcnt(4)
    v_mfma_f32_32x32x16_bf16 v[80:95], v[24:27], v[168:171], v[80:95]
    ds_read_b64_tr_b16 v[24:25], v16
    ds_read_b64_tr_b16 v[26:27], v16 offset:512
    v_max_f32 v46, 0x358637bd, v46
    v_max_f32 v47, 0x358637bd, v47
    v_add_f32 v44, v44, v14
    v_add_f32 v45, v45, v15
    v_add_f32 v46, v46, v9
    s_waitcnt lgkmcnt(4)
    v_mfma_f32_32x32x16_bf16 v[64:79], v[28:31], v[172:175], v[64:79]
    ds_read_b64_tr_b16 v[28:29], v16 offset:8192
    ds_read_b64_tr_b16 v[30:31], v16 offset:8704
    v_add_f32 v47, v47, v1
    v_cvt_pk_bf16_f32 v44, v44, v45
    v_cvt_pk_bf16_f32 v45, v46, v47
    ds_write_b64 v2, v[44:45] offset:48
    v_fmac_f32 v48, v4, v10
    v_fmac_f32 v49, v4, v11
    s_waitcnt lgkmcnt(5)
    v_mfma_f32_32x32x16_bf16 v[80:95], v[20:23], v[172:175], v[80:95]
    ds_read_b64_tr_b16 v[20:21], v17
    ds_read_b64_tr_b16 v[22:23], v17 offset:512
    v_fmac_f32 v50, v4, v12
    v_fmac_f32 v51, v4, v13
    ds_read_b128 v[10:13], v7 offset:160
    v_mul_f32 v48, v3, v48
    v_mul_f32 v49, v3, v49
    v_mul_f32 v50, v3, v50
    s_waitcnt vmcnt(2)
    s_waitcnt lgkmcnt(6)
    v_mfma_f32_32x32x16_bf16 v[64:79], v[24:27], v[176:179], v[64:79]
    s_barrier
    s_add_u32 m0, s101, 0xc000
    s_nop 0
    buffer_load_dwordx4 v0, s[40:43], s86 offen lds
    v_mul_f32 v51, v3, v51
    v_mul_f32 v14, 0x3fb8aa3b, v48
    v_mul_f32 v15, 0x3fb8aa3b, v49
    s_waitcnt lgkmcnt(4)
    v_mfma_f32_32x32x16_bf16 v[80:95], v[28:31], v[176:179], v[80:95]
    v_dot2c_f32_bf16 v5, s10, v24
    v_dot2c_f32_bf16 v5, s10, v25
    v_dot2c_f32_bf16 v5, s10, v26
    v_dot2c_f32_bf16 v5, s10, v27
    v_dot2c_f32_bf16 v6, s10, v28
    v_dot2c_f32_bf16 v6, s10, v29
    v_dot2c_f32_bf16 v6, s10, v30
    v_dot2c_f32_bf16 v6, s10, v31
    ds_read_b64_tr_b16 v[24:25], v17 offset:8192
    ds_read_b64_tr_b16 v[26:27], v17 offset:8704
    ds_read_b64_tr_b16 v[28:29], v18
    ds_read_b64_tr_b16 v[30:31], v18 offset:512
    s_add_u32 m0, s101, 0xe000
    s_nop 0
    buffer_load_dwordx4 v0, s[44:47], s86 offen lds
    s_waitcnt lgkmcnt(5)
    v_mfma_f32_32x32x16_bf16 v[64:79], v[20:23], v[180:183], v[64:79]
    ds_read_b64_tr_b16 v[20:21], v18 offset:8192
    ds_read_b64_tr_b16 v[22:23], v18 offset:8704
    v_mul_f32 v9, 0x3fb8aa3b, v50
    v_mul_f32 v1, 0x3fb8aa3b, v51
    v_min_f32 v14, 0, v14
    v_min_f32 v15, 0, v15
    s_waitcnt lgkmcnt(4)
    v_mfma_f32_32x32x16_bf16 v[80:95], v[24:27], v[180:183], v[80:95]
    ds_read_b64_tr_b16 v[24:25], v19
    ds_read_b64_tr_b16 v[26:27], v19 offset:512
    v_min_f32 v9, 0, v9
    v_min_f32 v1, 0, v1
    v_exp_f32 v14, v14
    v_exp_f32 v15, v15
    s_waitcnt lgkmcnt(4)
    v_mfma_f32_32x32x16_bf16 v[64:79], v[28:31], v[184:187], v[64:79]
    ds_read_b64_tr_b16 v[28:29], v19 offset:8192
    ds_read_b64_tr_b16 v[30:31], v19 offset:8704
    v_exp_f32 v9, v9
    v_exp_f32 v1, v1
    s_waitcnt lgkmcnt(4)
    v_mfma_f32_32x32x16_bf16 v[80:95], v[20:23], v[184:187], v[80:95]
    ds_read_b64_tr_b16 v[20:21], v16 offset:16384
    ds_read_b64_tr_b16 v[22:23], v16 offset:16896
    v_max_f32 v48, 0x358637bd, v48
    v_max_f32 v49, 0x358637bd, v49
    v_max_f32 v50, 0x358637bd, v50
    v_max_f32 v51, 0x358637bd, v51
    v_add_f32 v48, v48, v14
    s_waitcnt lgkmcnt(4)
    v_mfma_f32_32x32x16_bf16 v[64:79], v[24:27], v[188:191], v[64:79]
    ds_read_b64_tr_b16 v[24:25], v16 offset:24576
    ds_read_b64_tr_b16 v[26:27], v16 offset:25088
    v_add_f32 v49, v49, v15
    v_add_f32 v50, v50, v9
    v_add_f32 v51, v51, v1
    v_cvt_pk_bf16_f32 v48, v48, v49
    v_cvt_pk_bf16_f32 v49, v50, v51
    s_waitcnt lgkmcnt(4)
    v_mfma_f32_32x32x16_bf16 v[80:95], v[28:31], v[188:191], v[80:95]
    ds_read_b64_tr_b16 v[28:29], v17 offset:16384
    ds_read_b64_tr_b16 v[30:31], v17 offset:16896
    ds_write_b64 v2, v[48:49] offset:128
    v_fmac_f32 v52, v4, v10
    v_fmac_f32 v53, v4, v11
    v_fmac_f32 v54, v4, v12
    v_fmac_f32 v55, v4, v13
    ds_read_b128 v[10:13], v7 offset:192
    s_waitcnt vmcnt(2)
    s_waitcnt lgkmcnt(6)
    v_mfma_f32_32x32x16_bf16 v[64:79], v[20:23], v[192:195], v[64:79]
    s_barrier
    s_add_u32 m0, s101, 0
    s_nop 0
    buffer_load_dwordx4 v0, s[40:43], s87 offen lds
    v_mul_f32 v52, v3, v52
    v_mul_f32 v53, v3, v53
    v_mul_f32 v54, v3, v54
    v_mul_f32 v55, v3, v55
    s_waitcnt lgkmcnt(4)
    v_mfma_f32_32x32x16_bf16 v[80:95], v[24:27], v[192:195], v[80:95]
    v_dot2c_f32_bf16 v5, s10, v20
    v_dot2c_f32_bf16 v5, s10, v21
    v_dot2c_f32_bf16 v5, s10, v22
    v_dot2c_f32_bf16 v5, s10, v23
    v_dot2c_f32_bf16 v6, s10, v24
    v_dot2c_f32_bf16 v6, s10, v25
    v_dot2c_f32_bf16 v6, s10, v26
    v_dot2c_f32_bf16 v6, s10, v27
    ds_read_b64_tr_b16 v[20:21], v17 offset:24576
    ds_read_b64_tr_b16 v[22:23], v17 offset:25088
    ds_read_b64_tr_b16 v[24:25], v18 offset:16384
    ds_read_b64_tr_b16 v[26:27], v18 offset:16896
    s_add_u32 m0, s101, 0x2000
    s_nop 0
    buffer_load_dwordx4 v0, s[44:47], s87 offen lds
    s_waitcnt lgkmcnt(6)
    v_mfma_f32_32x32x16_bf16 v[64:79], v[28:31], v[196:199], v[64:79]
    ds_read_b64_tr_b16 v[28:29], v18 offset:24576
    ds_read_b64_tr_b16 v[30:31], v18 offset:25088
    v_mul_f32 v14, 0x3fb8aa3b, v52
    v_mul_f32 v15, 0x3fb8aa3b, v53
    v_mul_f32 v9, 0x3fb8aa3b, v54
    s_waitcnt lgkmcnt(4)
    v_mfma_f32_32x32x16_bf16 v[80:95], v[20:23], v[196:199], v[80:95]
    ds_read_b64_tr_b16 v[20:21], v19 offset:16384
    ds_read_b64_tr_b16 v[22:23], v19 offset:16896
    v_mul_f32 v1, 0x3fb8aa3b, v55
    v_min_f32 v14, 0, v14
    v_min_f32 v15, 0, v15
    v_min_f32 v9, 0, v9
    v_min_f32 v1, 0, v1
    s_waitcnt lgkmcnt(4)
    v_mfma_f32_32x32x16_bf16 v[64:79], v[24:27], v[200:203], v[64:79]
    ds_read_b64_tr_b16 v[24:25], v19 offset:24576
    ds_read_b64_tr_b16 v[26:27], v19 offset:25088
    v_exp_f32 v14, v14
    v_exp_f32 v15, v15
    v_exp_f32 v9, v9
    s_waitcnt lgkmcnt(4)
    v_mfma_f32_32x32x16_bf16 v[80:95], v[28:31], v[200:203], v[80:95]
    ds_read_b64_tr_b16 v[28:29], v16 offset:32768
    ds_read_b64_tr_b16 v[30:31], v16 offset:33280
    v_exp_f32 v1, v1
    v_max_f32 v52, 0x358637bd, v52
    v_max_f32 v53, 0x358637bd, v53
    v_max_f32 v54, 0x358637bd, v54
    s_waitcnt lgkmcnt(4)
    v_mfma_f32_32x32x16_bf16 v[64:79], v[20:23], v[204:207], v[64:79]
    ds_read_b64_tr_b16 v[20:21], v16 offset:40960
    ds_read_b64_tr_b16 v[22:23], v16 offset:41472
    v_max_f32 v55, 0x358637bd, v55
    v_add_f32 v52, v52, v14
    v_add_f32 v53, v53, v15
    v_add_f32 v54, v54, v9
    v_add_f32 v55, v55, v1
    s_waitcnt lgkmcnt(4)
    v_mfma_f32_32x32x16_bf16 v[80:95], v[24:27], v[204:207], v[80:95]
    ds_read_b64_tr_b16 v[24:25], v17 offset:32768
    ds_read_b64_tr_b16 v[26:27], v17 offset:33280
    v_cvt_pk_bf16_f32 v52, v52, v53
    v_cvt_pk_bf16_f32 v53, v54, v55
    ds_write_b64 v2, v[52:53] offset:144
    v_fmac_f32 v56, v4, v10
    v_fmac_f32 v57, v4, v11
    s_waitcnt vmcnt(2)
    s_waitcnt lgkmcnt(5)
    v_mfma_f32_32x32x16_bf16 v[64:79], v[28:31], v[208:211], v[64:79]
    s_barrier
    v_fmac_f32 v58, v4, v12
    v_fmac_f32 v59, v4, v13
    ds_read_b128 v[10:13], v7 offset:224
    v_mul_f32 v56, v3, v56
    v_mul_f32 v57, v3, v57
    v_mul_f32 v58, v3, v58
    s_waitcnt lgkmcnt(4)
    v_mfma_f32_32x32x16_bf16 v[80:95], v[20:23], v[208:211], v[80:95]
    v_dot2c_f32_bf16 v5, s10, v28
    v_dot2c_f32_bf16 v5, s10, v29
    v_dot2c_f32_bf16 v5, s10, v30
    v_dot2c_f32_bf16 v5, s10, v31
    v_dot2c_f32_bf16 v6, s10, v20
    v_dot2c_f32_bf16 v6, s10, v21
    v_dot2c_f32_bf16 v6, s10, v22
    v_dot2c_f32_bf16 v6, s10, v23
    ds_read_b64_tr_b16 v[28:29], v17 offset:40960
    ds_read_b64_tr_b16 v[30:31], v17 offset:41472
    ds_read_b64_tr_b16 v[20:21], v18 offset:32768
    ds_read_b64_tr_b16 v[22:23], v18 offset:33280
    s_waitcnt lgkmcnt(6)
    v_mfma_f32_32x32x16_bf16 v[64:79], v[24:27], v[212:215], v[64:79]
    ds_read_b64_tr_b16 v[24:25], v18 offset:40960
    ds_read_b64_tr_b16 v[26:27], v18 offset:41472
    v_mul_f32 v59, v3, v59
    v_mul_f32 v14, 0x3fb8aa3b, v56
    v_mul_f32 v15, 0x3fb8aa3b, v57
    v_mul_f32 v9, 0x3fb8aa3b, v58
    v_mul_f32 v1, 0x3fb8aa3b, v59
    s_waitcnt lgkmcnt(4)
    v_mfma_f32_32x32x16_bf16 v[80:95], v[28:31], v[212:215], v[80:95]
    ds_read_b64_tr_b16 v[28:29], v19 offset:32768
    ds_read_b64_tr_b16 v[30:31], v19 offset:33280
    v_min_f32 v14, 0, v14
    v_min_f32 v15, 0, v15
    v_min_f32 v9, 0, v9
    v_min_f32 v1, 0, v1
    v_exp_f32 v14, v14
    s_waitcnt lgkmcnt(4)
    v_mfma_f32_32x32x16_bf16 v[64:79], v[20:23], v[216:219], v[64:79]
    ds_read_b64_tr_b16 v[20:21], v19 offset:40960
    ds_read_b64_tr_b16 v[22:23], v19 offset:41472
    v_exp_f32 v15, v15
    v_exp_f32 v9, v9
    s_waitcnt lgkmcnt(4)
    v_mfma_f32_32x32x16_bf16 v[80:95], v[24:27], v[216:219], v[80:95]
    ds_read_b64_tr_b16 v[24:25], v16 offset:49152
    ds_read_b64_tr_b16 v[26:27], v16 offset:49664
    v_exp_f32 v1, v1
    v_max_f32 v56, 0x358637bd, v56
    v_max_f32 v57, 0x358637bd, v57
    v_max_f32 v58, 0x358637bd, v58
    s_waitcnt lgkmcnt(4)
    v_mfma_f32_32x32x16_bf16 v[64:79], v[28:31], v[220:223], v[64:79]
    ds_read_b64_tr_b16 v[28:29], v16 offset:57344
    ds_read_b64_tr_b16 v[30:31], v16 offset:57856
    v_max_f32 v59, 0x358637bd, v59
    v_add_f32 v56, v56, v14
    v_add_f32 v57, v57, v15
    v_add_f32 v58, v58, v9
    v_add_f32 v59, v59, v1
    s_waitcnt lgkmcnt(4)
    v_mfma_f32_32x32x16_bf16 v[80:95], v[20:23], v[220:223], v[80:95]
    ds_read_b64_tr_b16 v[20:21], v17 offset:49152
    ds_read_b64_tr_b16 v[22:23], v17 offset:49664
    v_cvt_pk_bf16_f32 v56, v56, v57
    v_cvt_pk_bf16_f32 v57, v58, v59
    ds_write_b64 v2, v[56:57] offset:160
    v_fmac_f32 v60, v4, v10
    v_fmac_f32 v61, v4, v11
    v_fmac_f32 v62, v4, v12
    s_waitcnt vmcnt(0)
    s_waitcnt lgkmcnt(5)
    v_mfma_f32_32x32x16_bf16 v[64:79], v[24:27], v[224:227], v[64:79]
    s_barrier
    v_fmac_f32 v63, v4, v13
    v_mul_f32 v60, v3, v60
    v_mul_f32 v61, v3, v61
    v_mul_f32 v62, v3, v62
    v_mul_f32 v63, v3, v63
    s_waitcnt lgkmcnt(3)
    v_mfma_f32_32x32x16_bf16 v[80:95], v[28:31], v[224:227], v[80:95]
    v_dot2c_f32_bf16 v5, s10, v24
    v_dot2c_f32_bf16 v5, s10, v25
    v_dot2c_f32_bf16 v5, s10, v26
    v_dot2c_f32_bf16 v5, s10, v27
    v_dot2c_f32_bf16 v6, s10, v28
    v_dot2c_f32_bf16 v6, s10, v29
    v_dot2c_f32_bf16 v6, s10, v30
    v_dot2c_f32_bf16 v6, s10, v31
    ds_read_b64_tr_b16 v[24:25], v17 offset:57344
    ds_read_b64_tr_b16 v[26:27], v17 offset:57856
    ds_read_b64_tr_b16 v[28:29], v18 offset:49152
    ds_read_b64_tr_b16 v[30:31], v18 offset:49664
    s_waitcnt lgkmcnt(5)
    v_mfma_f32_32x32x16_bf16 v[64:79], v[20:23], v[228:231], v[64:79]
    ds_read_b64_tr_b16 v[20:21], v18 offset:57344
    ds_read_b64_tr_b16 v[22:23], v18 offset:57856
    v_mul_f32 v14, 0x3fb8aa3b, v60
    v_mul_f32 v15, 0x3fb8aa3b, v61
    v_mul_f32 v9, 0x3fb8aa3b, v62
    v_mul_f32 v1, 0x3fb8aa3b, v63
    v_min_f32 v14, 0, v14
    s_waitcnt lgkmcnt(4)
    v_mfma_f32_32x32x16_bf16 v[80:95], v[24:27], v[228:231], v[80:95]
    ds_read_b64_tr_b16 v[24:25], v19 offset:49152
    ds_read_b64_tr_b16 v[26:27], v19 offset:49664
    v_min_f32 v15, 0, v15
    v_min_f32 v9, 0, v9
    v_min_f32 v1, 0, v1
    v_exp_f32 v14, v14
    s_waitcnt lgkmcnt(4)
    v_mfma_f32_32x32x16_bf16 v[64:79], v[28:31], v[232:235], v[64:79]
    ds_read_b64_tr_b16 v[28:29], v19 offset:57344
    ds_read_b64_tr_b16 v[30:31], v19 offset:57856
    v_exp_f32 v15, v15
    v_exp_f32 v9, v9
    v_exp_f32 v1, v1
    s_waitcnt lgkmcnt(4)
    v_mfma_f32_32x32x16_bf16 v[80:95], v[20:23], v[232:235], v[80:95]
    ds_read_b64_tr_b16 v[20:21], v16
    ds_read_b64_tr_b16 v[22:23], v16 offset:512
    v_max_f32 v60, 0x358637bd, v60
    v_max_f32 v61, 0x358637bd, v61
    v_max_f32 v62, 0x358637bd, v62
    v_max_f32 v63, 0x358637bd, v63
    s_waitcnt lgkmcnt(4)
    v_mfma_f32_32x32x16_bf16 v[64:79], v[24:27], v[236:239], v[64:79]
    ds_read_b64_tr_b16 v[24:25], v16 offset:8192
    ds_read_b64_tr_b16 v[26:27], v16 offset:8704
    v_add_f32 v60, v60, v14
    v_add_f32 v61, v61, v15
    v_add_f32 v62, v62, v9
    v_add_f32 v63, v63, v1
    v_cvt_pk_bf16_f32 v60, v60, v61
    s_waitcnt lgkmcnt(4)
    v_mfma_f32_32x32x16_bf16 v[80:95], v[28:31], v[236:239], v[80:95]
    ds_read_b64_tr_b16 v[28:29], v17
    ds_read_b64_tr_b16 v[30:31], v17 offset:512
    v_cvt_pk_bf16_f32 v61, v62, v63
    ds_write_b64 v2, v[60:61] offset:176
    s_waitcnt lgkmcnt(5)
    v_mfma_f32_32x32x16_bf16 v[64:79], v[20:23], v[240:243], v[64:79]
    s_barrier
    s_waitcnt lgkmcnt(3)
    v_mfma_f32_32x32x16_bf16 v[80:95], v[24:27], v[240:243], v[80:95]
    v_dot2c_f32_bf16 v5, s10, v20
    v_dot2c_f32_bf16 v5, s10, v21
    v_dot2c_f32_bf16 v5, s10, v22
    v_dot2c_f32_bf16 v5, s10, v23
    v_dot2c_f32_bf16 v6, s10, v24
    v_dot2c_f32_bf16 v6, s10, v25
    v_dot2c_f32_bf16 v6, s10, v26
    v_dot2c_f32_bf16 v6, s10, v27
    ds_read_b64_tr_b16 v[20:21], v17 offset:8192
    ds_read_b64_tr_b16 v[22:23], v17 offset:8704
    ds_read_b64_tr_b16 v[24:25], v18
    ds_read_b64_tr_b16 v[26:27], v18 offset:512
    s_waitcnt lgkmcnt(5)
    v_mfma_f32_32x32x16_bf16 v[64:79], v[28:31], v[244:247], v[64:79]
    ds_read_b64_tr_b16 v[28:29], v18 offset:8192
    ds_read_b64_tr_b16 v[30:31], v18 offset:8704
    s_waitcnt lgkmcnt(4)
    v_mfma_f32_32x32x16_bf16 v[80:95], v[20:23], v[244:247], v[80:95]
    ds_read_b64_tr_b16 v[20:21], v19
    ds_read_b64_tr_b16 v[22:23], v19 offset:512
    ds_write_b32 v8, v5
    v_mov_b32 v5, 0
    ds_write_b32 v8, v6 offset:2048
    v_mov_b32 v6, 0
    s_waitcnt lgkmcnt(6)
    v_mfma_f32_32x32x16_bf16 v[64:79], v[24:27], v[248:251], v[64:79]
    ds_read_b64_tr_b16 v[24:25], v19 offset:8192
    ds_read_b64_tr_b16 v[26:27], v19 offset:8704
    s_waitcnt lgkmcnt(6)
    v_mfma_f32_32x32x16_bf16 v[80:95], v[28:31], v[248:251], v[80:95]
    s_waitcnt lgkmcnt(4)
    v_mfma_f32_32x32x16_bf16 v[64:79], v[20:23], v[252:255], v[64:79]
    s_waitcnt lgkmcnt(0)
    v_mfma_f32_32x32x16_bf16 v[80:95], v[24:27], v[252:255], v[80:95]
    s_barrier
    v_mbcnt_lo_u32_b32 v14, -1, 0
    v_mbcnt_hi_u32_b32 v14, -1, v14
    v_lshrrev_b32 v15, 5, v14
    v_lshlrev_b32 v15, 10, v15
    v_lshl_add_u32 v15, v14, 5, v15
    v_add_u32 v15, s13, v15
    ds_read_b128 v[10:13], v15
    v_lshl_add_u32 v14, v14, 2, s14
    s_waitcnt lgkmcnt(0)
    v_add_f32 v1, v10, v11
    v_add_f32 v12, v12, v13
    v_add_f32 v1, v1, v12
    ds_read_b128 v[10:13], v15 offset:16
    s_waitcnt lgkmcnt(0)
    v_add_f32 v10, v10, v11
    v_add_f32 v12, v12, v13
    v_add_f32 v1, v1, v10
    v_add_f32 v1, v1, v12
    ds_write_b32 v14, v1
    ds_read_b128 v[10:13], v7
    v_mbcnt_lo_u32_b32 v32, -1, 0
    v_mbcnt_hi_u32_b32 v32, -1, v32
    v_lshrrev_b32 v37, 5, v32
    v_bfe_u32 v38, v32, 4, 1
    v_bfe_u32 v39, v32, 2, 2
    v_and_b32 v40, 3, v32
    v_lshl_add_u32 v33, v37, 3, v39
    v_mul_u32_u24 v35, 0x148, v33
    v_lshl_add_u32 v35, v38, 5, v35
    v_lshl_add_u32 v35, v40, 3, v35
    s_mul_i32 s3, s98, 40
    s_add_u32 s3, s3, 0x10000
    v_add_u32 v35, s3, v35
    v_and_b32 v34, 31, v32
    v_cmp_lt_u32 vcc, 19, v34
    v_add_u32 v36, 0xa400, v35
    v_mul_u32_u24 v34, 0x50, v34
    v_lshl_add_u32 v34, v37, 4, v34
    s_lshl_b32 s3, s98, 13
    v_add_u32 v34, s3, v34
    v_lshl_add_u32 v38, v32, 4, s3
    v_lshl_add_u32 v37, v37, 12, v34
    v_lshlrev_b32 v32, 4, v32
    v_mov_b32 v33, s10
    s_waitcnt lgkmcnt(0)
    v_fmac_f32 v64, v4, v10
    v_fmac_f32 v65, v4, v11
    v_fmac_f32 v66, v4, v12
    v_fmac_f32 v67, v4, v13
    ds_read_b128 v[10:13], v7 offset:32
    v_mul_f32 v64, v3, v64
    v_mul_f32 v65, v3, v65
    v_mul_f32 v66, v3, v66
    v_mul_f32 v67, v3, v67
    v_cvt_pk_bf16_f32 v64, v64, v65
    v_cvt_pk_bf16_f32 v65, v66, v67
    ds_write_b64 v2, v[64:65] offset:41984
    s_waitcnt lgkmcnt(1)
    v_fmac_f32 v68, v4, v10
    v_fmac_f32 v69, v4, v11
    v_fmac_f32 v70, v4, v12
    v_fmac_f32 v71, v4, v13
    ds_read_b128 v[10:13], v7 offset:64
    v_mul_f32 v68, v3, v68
    v_mul_f32 v69, v3, v69
    v_mul_f32 v70, v3, v70
    v_mul_f32 v71, v3, v71
    v_cvt_pk_bf16_f32 v68, v68, v69
    v_cvt_pk_bf16_f32 v69, v70, v71
    ds_write_b64 v2, v[68:69] offset:42000
    s_waitcnt lgkmcnt(1)
    v_fmac_f32 v72, v4, v10
    v_fmac_f32 v73, v4, v11
    v_fmac_f32 v74, v4, v12
    v_fmac_f32 v75, v4, v13
    ds_read_b128 v[10:13], v7 offset:96
    v_mul_f32 v72, v3, v72
    v_mul_f32 v73, v3, v73
    v_mul_f32 v74, v3, v74
    v_mul_f32 v75, v3, v75
    v_cvt_pk_bf16_f32 v72, v72, v73
    v_cvt_pk_bf16_f32 v73, v74, v75
    ds_write_b64 v2, v[72:73] offset:42016
    s_waitcnt lgkmcnt(1)
    v_fmac_f32 v76, v4, v10
    v_fmac_f32 v77, v4, v11
    v_fmac_f32 v78, v4, v12
    v_fmac_f32 v79, v4, v13
    ds_read_b128 v[10:13], v7 offset:128
    v_mul_f32 v76, v3, v76
    v_mul_f32 v77, v3, v77
    v_mul_f32 v78, v3, v78
    v_mul_f32 v79, v3, v79
    v_cvt_pk_bf16_f32 v76, v76, v77
    v_cvt_pk_bf16_f32 v77, v78, v79
    ds_write_b64 v2, v[76:77] offset:42032
    s_waitcnt lgkmcnt(1)
    v_fmac_f32 v80, v4, v10
    v_fmac_f32 v81, v4, v11
    v_fmac_f32 v82, v4, v12
    v_fmac_f32 v83, v4, v13
    ds_read_b128 v[10:13], v7 offset:160
    v_mul_f32 v80, v3, v80
    v_mul_f32 v81, v3, v81
    v_mul_f32 v82, v3, v82
    v_mul_f32 v83, v3, v83
    v_cvt_pk_bf16_f32 v80, v80, v81
    v_cvt_pk_bf16_f32 v81, v82, v83
    ds_write_b64 v2, v[80:81] offset:42112
    s_waitcnt lgkmcnt(1)
    v_fmac_f32 v84, v4, v10
    v_fmac_f32 v85, v4, v11
    v_fmac_f32 v86, v4, v12
    v_fmac_f32 v87, v4, v13
    ds_read_b128 v[10:13], v7 offset:192
    v_mul_f32 v84, v3, v84
    v_mul_f32 v85, v3, v85
    v_mul_f32 v86, v3, v86
    v_mul_f32 v87, v3, v87
    v_cvt_pk_bf16_f32 v84, v84, v85
    v_cvt_pk_bf16_f32 v85, v86, v87
    ds_write_b64 v2, v[84:85] offset:42128
    s_waitcnt lgkmcnt(1)
    v_fmac_f32 v88, v4, v10
    v_fmac_f32 v89, v4, v11
    v_fmac_f32 v90, v4, v12
    v_fmac_f32 v91, v4, v13
    ds_read_b128 v[10:13], v7 offset:224
    v_mul_f32 v88, v3, v88
    v_mul_f32 v89, v3, v89
    v_mul_f32 v90, v3, v90
    v_mul_f32 v91, v3, v91
    v_cvt_pk_bf16_f32 v88, v88, v89
    v_cvt_pk_bf16_f32 v89, v90, v91
    ds_write_b64 v2, v[88:89] offset:42144
    s_waitcnt lgkmcnt(1)
    v_fmac_f32 v92, v4, v10
    v_fmac_f32 v93, v4, v11
    v_fmac_f32 v94, v4, v12
    v_fmac_f32 v95, v4, v13
    v_mul_f32 v92, v3, v92
    v_mul_f32 v93, v3, v93
    v_mul_f32 v94, v3, v94
    v_mul_f32 v95, v3, v95
    v_cvt_pk_bf16_f32 v92, v92, v93
    v_cvt_pk_bf16_f32 v93, v94, v95
    ds_write_b64 v2, v[92:93] offset:42160
    ds_read_b64_tr_b16 v[200:201], v35
    ds_read_b64_tr_b16 v[202:203], v35 offset:1312
    ds_read_b64_tr_b16 v[208:209], v35 offset:5248
    ds_read_b64_tr_b16 v[210:211], v35 offset:6560
    ds_read_b64_tr_b16 v[216:217], v35 offset:10496
    ds_read_b64_tr_b16 v[218:219], v35 offset:11808
    ds_read_b64_tr_b16 v[224:225], v35 offset:15744
    ds_read_b64_tr_b16 v[226:227], v35 offset:17056
    ds_read_b64_tr_b16 v[232:233], v35 offset:20992
    ds_read_b64_tr_b16 v[234:235], v35 offset:22304
    ds_read_b64_tr_b16 v[240:241], v35 offset:26240
    ds_read_b64_tr_b16 v[242:243], v35 offset:27552
    ds_read_b64_tr_b16 v[248:249], v35 offset:31488
    ds_read_b64_tr_b16 v[250:251], v35 offset:32800
    ds_read_b64_tr_b16 v[48:49], v35 offset:36736
    ds_read_b64_tr_b16 v[50:51], v35 offset:38048
    s_waitcnt lgkmcnt(15)
    s_barrier
    ds_read_b64_tr_b16 v[204:205], v36
    ds_read_b64_tr_b16 v[206:207], v36 offset:1312
    ds_read_b64_tr_b16 v[212:213], v36 offset:5248
    ds_read_b64_tr_b16 v[214:215], v36 offset:6560
    ds_read_b64_tr_b16 v[220:221], v36 offset:10496
    ds_read_b64_tr_b16 v[222:223], v36 offset:11808
    ds_read_b64_tr_b16 v[228:229], v36 offset:15744
    ds_read_b64_tr_b16 v[230:231], v36 offset:17056
    ds_read_b64_tr_b16 v[236:237], v36 offset:20992
    ds_read_b64_tr_b16 v[238:239], v36 offset:22304
    ds_read_b64_tr_b16 v[244:245], v36 offset:26240
    ds_read_b64_tr_b16 v[246:247], v36 offset:27552
    ds_read_b64_tr_b16 v[252:253], v36 offset:31488
    ds_read_b64_tr_b16 v[254:255], v36 offset:32800
    ds_read_b64_tr_b16 v[52:53], v36 offset:36736
    ds_read_b64_tr_b16 v[54:55], v36 offset:38048
    s_waitcnt lgkmcnt(15)
    v_cndmask_b32 v204, v204, v33, vcc
    v_cndmask_b32 v205, v205, v33, vcc
    s_waitcnt lgkmcnt(14)
    v_cndmask_b32 v206, v206, v33, vcc
    v_cndmask_b32 v207, v207, v33, vcc
    s_waitcnt lgkmcnt(13)
    v_cndmask_b32 v212, v212, v33, vcc
    v_cndmask_b32 v213, v213, v33, vcc
    s_waitcnt lgkmcnt(12)
    v_cndmask_b32 v214, v214, v33, vcc
    v_cndmask_b32 v215, v215, v33, vcc
    v_mfma_f32_32x32x16_bf16 v[64:79], v[200:203], v[204:207], 0
    s_waitcnt lgkmcnt(11)
    v_cndmask_b32 v220, v220, v33, vcc
    v_cndmask_b32 v221, v221, v33, vcc
    s_waitcnt lgkmcnt(10)
    v_cndmask_b32 v222, v222, v33, vcc
    v_cndmask_b32 v223, v223, v33, vcc
    v_mfma_f32_32x32x16_bf16 v[64:79], v[208:211], v[212:215], v[64:79]
    s_waitcnt lgkmcnt(9)
    v_cndmask_b32 v228, v228, v33, vcc
    v_cndmask_b32 v229, v229, v33, vcc
    s_waitcnt lgkmcnt(8)
    v_cndmask_b32 v230, v230, v33, vcc
    v_cndmask_b32 v231, v231, v33, vcc
    v_mfma_f32_32x32x16_bf16 v[64:79], v[216:219], v[220:223], v[64:79]
    s_waitcnt lgkmcnt(7)
    v_cndmask_b32 v236, v236, v33, vcc
    v_cndmask_b32 v237, v237, v33, vcc
    s_waitcnt lgkmcnt(6)
    v_cndmask_b32 v238, v238, v33, vcc
    v_cndmask_b32 v239, v239, v33, vcc
    v_mfma_f32_32x32x16_bf16 v[64:79], v[224:227], v[228:231], v[64:79]
    s_waitcnt lgkmcnt(5)
    v_cndmask_b32 v244, v244, v33, vcc
    v_cndmask_b32 v245, v245, v33, vcc
    s_waitcnt lgkmcnt(4)
    v_cndmask_b32 v246, v246, v33, vcc
    v_cndmask_b32 v247, v247, v33, vcc
    v_mfma_f32_32x32x16_bf16 v[64:79], v[232:235], v[236:239], v[64:79]
    s_waitcnt lgkmcnt(3)
    v_cndmask_b32 v252, v252, v33, vcc
    v_cndmask_b32 v253, v253, v33, vcc
    s_waitcnt lgkmcnt(2)
    v_cndmask_b32 v254, v254, v33, vcc
    v_cndmask_b32 v255, v255, v33, vcc
    v_mfma_f32_32x32x16_bf16 v[64:79], v[240:243], v[244:247], v[64:79]
    s_waitcnt lgkmcnt(1)
    v_cndmask_b32 v52, v52, v33, vcc
    v_cndmask_b32 v53, v53, v33, vcc
    s_waitcnt lgkmcnt(0)
    v_cndmask_b32 v54, v54, v33, vcc
    v_cndmask_b32 v55, v55, v33, vcc
    v_mfma_f32_32x32x16_bf16 v[64:79], v[248:251], v[252:255], v[64:79]
    s_nop 0
    v_mfma_f32_32x32x16_bf16 v[64:79], v[48:51], v[52:55], v[64:79]
    s_nop 11
    ds_write_b128 v34, v[64:67]
    ds_write_b128 v34, v[68:71] offset:32
    ds_write_b128 v37, v[72:75] offset:64
    ds_read_b128 v[200:203], v38
    ds_read_b128 v[204:207], v38 offset:1024
    s_waitcnt lgkmcnt(1)
    buffer_store_dwordx4 v[200:203], v32, s[56:59], 0 offen sc1
    s_waitcnt lgkmcnt(0)
    buffer_store_dwordx4 v[204:207], v32, s[56:59], 0 offen offset:1024 sc1
    s_mov_b32 s28, s8
    s_mov_b32 s29, s9
    s_mov_b32 s30, 0x100
    s_mov_b32 s31, 0x20000
    v_mbcnt_lo_u32_b32 v20, -1, 0
    v_mbcnt_hi_u32_b32 v20, -1, v20
    v_and_b32 v20, 7, v20
    v_lshlrev_b32 v20, 4, v20
    s_mov_b32 s3, 0
    s_waitcnt vmcnt(0)
    s_cmp_lg_u32 s98, 0
    s_cbranch_scc1 K1KV_ce
K1KV_cl:
    buffer_load_dword v21, v20, s[28:31], 0 offen sc1
    s_add_u32 s3, s3, 1
    s_waitcnt vmcnt(0)
    v_cmp_ne_u32 vcc, 32, v21
    s_nop 4
    s_cbranch_vccz K1KV_ce
    s_cmp_gt_u32 s3, 0x4000
    s_cbranch_scc1 K1KV_ce
    s_sleep 4
    s_branch K1KV_cl
K1KV_ce:
    s_barrier
    s_setprio 0
    s_branch P2
K1KV_end:
.p2align 6
P2:
    s_load_dwordx2 s[4:5], s[0:1], 0
    s_load_dwordx2 s[18:19], s[0:1], 56
    v_mbcnt_lo_u32_b32 v14, -1, 0
    v_mbcnt_hi_u32_b32 v14, -1, v14
    s_and_b32 s48, s98, 3
    v_lshlrev_b32 v0, 4, v14
    v_add_u32 v1, 0x1000, v0
    s_mov_b32 s56, 0
    s_and_b32 s3, s2, 7
    s_lshr_b32 s6, s2, 3
    s_lshr_b32 s49, s3, 1
    s_lshl_b32 s49, s49, 3
    s_and_b32 s7, s6, 7
    s_add_u32 s49, s49, s7
    s_and_b32 s50, s3, 1
    s_lshl_b32 s50, s50, 2
    s_lshr_b32 s6, s6, 3
    s_add_u32 s50, s50, s6
    s_mul_i32 s6, s6, 3
    s_add_u32 s57, s7, s6
    s_cmp_ge_u32 s57, 12
    s_cselect_b32 s6, 12, 0
    s_sub_u32 s57, s57, s6
    s_and_b32 s57, s57, 0
    s_mul_i32 s3, s48, 0x78000
    s_mul_i32 s6, s50, 0x1400
    s_add_u32 s3, s3, s6
    s_add_u32 s28, s22, s3
    s_addc_u32 s29, s23, 0
    s_add_u32 s28, s28, 0xa00000
    s_addc_u32 s29, s29, 0
    s_sub_u32 s30, 0x2a8000, s3
    s_mov_b32 s31, 0x20000
    s_waitcnt lgkmcnt(0)
    s_cmp_ge_u32 s98, 4
    s_cbranch_scc1 P2S
    s_lshr_b32 s3, s49, 1
    s_lshl_b32 s3, s3, 7
    s_add_u32 s12, s22, s3
    s_addc_u32 s13, s23, 0
    s_add_u32 s12, s12, 0x9c0000
    s_addc_u32 s13, s13, 0
    s_sub_u32 s14, 0x800, s3
    s_mov_b32 s15, 0x20000
    v_and_b32 v15, 15, v14
    v_min_u32 v15, 11, v15
    v_lshlrev_b32 v15, 2, v15
    s_lshl_b32 s70, s57, 10
    s_mul_i32 s82, s57, 0xa000
    s_add_u32 s57, s57, 1
    s_cmp_eq_u32 s57, 12
    s_cselect_b32 s57, 0, s57
    buffer_load_dwordx4 v[32:35], v0, s[28:31], s82 offen sc1
    buffer_load_dwordx4 v[36:39], v0, s[28:31], s82 offen offset:1024 sc1
    buffer_load_dwordx4 v[40:43], v0, s[28:31], s82 offen offset:2048 sc1
    buffer_load_dwordx4 v[44:47], v0, s[28:31], s82 offen offset:3072 sc1
    buffer_load_dwordx4 v[48:51], v1, s[28:31], s82 offen sc1
    s_lshl_b32 s71, s57, 10
    s_mul_i32 s83, s57, 0xa000
    s_add_u32 s57, s57, 1
    s_cmp_eq_u32 s57, 12
    s_cselect_b32 s57, 0, s57
    buffer_load_dwordx4 v[68:71], v0, s[28:31], s83 offen sc1
    buffer_load_dwordx4 v[72:75], v0, s[28:31], s83 offen offset:1024 sc1
    buffer_load_dwordx4 v[76:79], v0, s[28:31], s83 offen offset:2048 sc1
    buffer_load_dwordx4 v[80:83], v0, s[28:31], s83 offen offset:3072 sc1
    buffer_load_dwordx4 v[84:87], v1, s[28:31], s83 offen sc1
    s_lshl_b32 s72, s57, 10
    s_mul_i32 s84, s57, 0xa000
    s_add_u32 s57, s57, 1
    s_cmp_eq_u32 s57, 12
    s_cselect_b32 s57, 0, s57
    buffer_load_dwordx4 v[104:107], v0, s[28:31], s84 offen sc1
    buffer_load_dwordx4 v[108:111], v0, s[28:31], s84 offen offset:1024 sc1
    buffer_load_dwordx4 v[112:115], v0, s[28:31], s84 offen offset:2048 sc1
    buffer_load_dwordx4 v[116:119], v0, s[28:31], s84 offen offset:3072 sc1
    buffer_load_dwordx4 v[120:123], v1, s[28:31], s84 offen sc1
    s_lshl_b32 s73, s57, 10
    s_mul_i32 s85, s57, 0xa000
    s_add_u32 s57, s57, 1
    s_cmp_eq_u32 s57, 12
    s_cselect_b32 s57, 0, s57
    buffer_load_dwordx4 v[140:143], v0, s[28:31], s85 offen sc1
    buffer_load_dwordx4 v[144:147], v0, s[28:31], s85 offen offset:1024 sc1
    buffer_load_dwordx4 v[148:151], v0, s[28:31], s85 offen offset:2048 sc1
    buffer_load_dwordx4 v[152:155], v0, s[28:31], s85 offen offset:3072 sc1
    buffer_load_dwordx4 v[156:159], v1, s[28:31], s85 offen sc1
    buffer_load_dword v12, v15, s[12:15], 0 offen sc1
    s_mul_i32 s16, s48, 0x5000
    s_add_u32 s16, s16, 0x14000
    v_add_u32 v5, s16, v0
    s_lshl_b32 s74, s57, 10
    s_mul_i32 s86, s57, 0xa000
    s_add_u32 s57, s57, 1
    s_cmp_eq_u32 s57, 12
    s_cselect_b32 s57, 0, s57
    s_add_u32 m0, s16, 0
    s_add_u32 s3, s86, 0
    buffer_load_dwordx4 v0, s[28:31], s3 offen sc1 lds
    s_add_u32 m0, s16, 0x400
    s_add_u32 s3, s86, 0x400
    buffer_load_dwordx4 v0, s[28:31], s3 offen sc1 lds
    s_add_u32 m0, s16, 0x800
    s_add_u32 s3, s86, 0x800
    buffer_load_dwordx4 v0, s[28:31], s3 offen sc1 lds
    s_add_u32 m0, s16, 0xc00
    s_add_u32 s3, s86, 0xc00
    buffer_load_dwordx4 v0, s[28:31], s3 offen sc1 lds
    s_add_u32 m0, s16, 0x1000
    s_add_u32 s3, s86, 0x1000
    buffer_load_dwordx4 v0, s[28:31], s3 offen sc1 lds
    s_lshl_b32 s75, s57, 10
    s_mul_i32 s87, s57, 0xa000
    s_add_u32 s57, s57, 1
    s_cmp_eq_u32 s57, 12
    s_cselect_b32 s57, 0, s57
    s_add_u32 m0, s16, 0x1400
    s_add_u32 s3, s87, 0
    buffer_load_dwordx4 v0, s[28:31], s3 offen sc1 lds
    s_add_u32 m0, s16, 0x1800
    s_add_u32 s3, s87, 0x400
    buffer_load_dwordx4 v0, s[28:31], s3 offen sc1 lds
    s_add_u32 m0, s16, 0x1c00
    s_add_u32 s3, s87, 0x800
    buffer_load_dwordx4 v0, s[28:31], s3 offen sc1 lds
    s_add_u32 m0, s16, 0x2000
    s_add_u32 s3, s87, 0xc00
    buffer_load_dwordx4 v0, s[28:31], s3 offen sc1 lds
    s_add_u32 m0, s16, 0x2400
    s_add_u32 s3, s87, 0x1000
    buffer_load_dwordx4 v0, s[28:31], s3 offen sc1 lds
    s_lshl_b32 s76, s57, 10
    s_mul_i32 s88, s57, 0xa000
    s_add_u32 s57, s57, 1
    s_cmp_eq_u32 s57, 12
    s_cselect_b32 s57, 0, s57
    s_add_u32 m0, s16, 0x2800
    s_add_u32 s3, s88, 0
    buffer_load_dwordx4 v0, s[28:31], s3 offen sc1 lds
    s_add_u32 m0, s16, 0x2c00
    s_add_u32 s3, s88, 0x400
    buffer_load_dwordx4 v0, s[28:31], s3 offen sc1 lds
    s_add_u32 m0, s16, 0x3000
    s_add_u32 s3, s88, 0x800
    buffer_load_dwordx4 v0, s[28:31], s3 offen sc1 lds
    s_add_u32 m0, s16, 0x3400
    s_add_u32 s3, s88, 0xc00
    buffer_load_dwordx4 v0, s[28:31], s3 offen sc1 lds
    s_add_u32 m0, s16, 0x3800
    s_add_u32 s3, s88, 0x1000
    buffer_load_dwordx4 v0, s[28:31], s3 offen sc1 lds
    s_lshl_b32 s77, s57, 10
    s_mul_i32 s89, s57, 0xa000
    s_add_u32 s57, s57, 1
    s_cmp_eq_u32 s57, 12
    s_cselect_b32 s57, 0, s57
    s_add_u32 m0, s16, 0x3c00
    s_add_u32 s3, s89, 0
    buffer_load_dwordx4 v0, s[28:31], s3 offen sc1 lds
    s_add_u32 m0, s16, 0x4000
    s_add_u32 s3, s89, 0x400
    buffer_load_dwordx4 v0, s[28:31], s3 offen sc1 lds
    s_add_u32 m0, s16, 0x4400
    s_add_u32 s3, s89, 0x800
    buffer_load_dwordx4 v0, s[28:31], s3 offen sc1 lds
    s_add_u32 m0, s16, 0x4800
    s_add_u32 s3, s89, 0xc00
    buffer_load_dwordx4 v0, s[28:31], s3 offen sc1 lds
    s_add_u32 m0, s16, 0x4c00
    s_add_u32 s3, s89, 0x1000
    buffer_load_dwordx4 v0, s[28:31], s3 offen sc1 lds
    s_lshl_b32 s78, s57, 10
    s_mul_i32 s90, s57, 0xa000
    s_add_u32 s57, s57, 1
    s_cmp_eq_u32 s57, 12
    s_cselect_b32 s57, 0, s57
    s_lshl_b32 s79, s57, 10
    s_mul_i32 s91, s57, 0xa000
    s_add_u32 s57, s57, 1
    s_cmp_eq_u32 s57, 12
    s_cselect_b32 s57, 0, s57
    s_lshl_b32 s80, s57, 10
    s_mul_i32 s92, s57, 0xa000
    s_add_u32 s57, s57, 1
    s_cmp_eq_u32 s57, 12
    s_cselect_b32 s57, 0, s57
    s_lshl_b32 s81, s57, 10
    s_mul_i32 s93, s57, 0xa000
    s_add_u32 s3, s48, 0
    s_and_b32 s3, s3, 3
    s_mul_i32 s6, s3, 0xc000
    v_add_u32 v8, s6, v0
    s_add_u32 s3, s48, 1
    s_and_b32 s3, s3, 3
    s_mul_i32 s6, s3, 0xc000
    v_add_u32 v9, s6, v0
    s_sub_u32 s6, s48, 1
    s_and_b32 s6, s6, 3
    s_mul_i32 s6, s6, 0x5000
    s_add_u32 s6, s6, 0x14000
    v_add_u32 v251, s6, v0
    s_add_u32 s3, s48, 2
    s_and_b32 s3, s3, 3
    s_mul_i32 s6, s3, 0xc000
    v_add_u32 v10, s6, v0
    s_sub_u32 s6, s48, 2
    s_and_b32 s6, s6, 3
    s_mul_i32 s6, s6, 0x5000
    s_add_u32 s6, s6, 0x15400
    v_add_u32 v252, s6, v0
    s_add_u32 s3, s48, 3
    s_and_b32 s3, s3, 3
    s_mul_i32 s6, s3, 0xc000
    v_add_u32 v11, s6, v0
    s_sub_u32 s6, s48, 3
    s_and_b32 s6, s6, 3
    s_mul_i32 s6, s6, 0x5000
    s_add_u32 s6, s6, 0x16800
    v_add_u32 v253, s6, v0
    s_mul_i32 s3, s49, 0x30000
    s_mul_i32 s6, s48, 0x3000
    s_add_u32 s3, s3, s6
    s_add_u32 s24, s22, s3
    s_addc_u32 s25, s23, 0
    s_sub_u32 s26, 0x600000, s3
    s_mov_b32 s27, 0x20000
    s_lshl_b32 s3, s49, 2
    s_add_u32 s3, s3, s48
    s_mul_i32 s3, s3, 0x5000
    s_mul_i32 s7, s50, 0xa0
    s_add_u32 s3, s3, s7
    s_add_u32 s40, s4, s3
    s_addc_u32 s41, s5, 0
    s_sub_u32 s42, 0x280000, s3
    s_mov_b32 s43, 0x20000
    s_add_u32 s44, s18, s3
    s_addc_u32 s45, s19, 0
    s_sub_u32 s46, 0x280000, s3
    s_mov_b32 s47, 0x20000
    v_and_b32 v13, 15, v14
    v_mul_u32_u24 v2, 0x500, v13
    v_lshrrev_b32 v13, 4, v14
    v_lshl_add_u32 v2, v13, 3, v2
    buffer_load_dwordx2 v[240:241], v2, s[40:43], 0 offen
    buffer_load_dwordx2 v[242:243], v2, s[40:43], 0 offen offset:32
    buffer_load_dwordx2 v[244:245], v2, s[40:43], 0 offen offset:64
    buffer_load_dwordx2 v[246:247], v2, s[40:43], 0 offen offset:96
    buffer_load_dwordx2 v[248:249], v2, s[40:43], 0 offen offset:128
    s_waitcnt vmcnt(25)
    v_cmp_ne_u32 vcc, 1, v12
    s_nop 4
    s_cbranch_vccz P2D_go
P2D_poll:
    buffer_load_dword v12, v15, s[12:15], 0 offen sc1
    s_add_u32 s56, s56, 1
    s_waitcnt vmcnt(0)
    v_cmp_ne_u32 vcc, 1, v12
    s_nop 4
    s_cbranch_vccz P2D_go
    s_cmp_gt_u32 s56, 16384
    s_cbranch_scc1 P2D_go
    s_sleep 4
    s_branch P2D_poll
P2D_go:
    buffer_load_dwordx4 v[16:19], v8, s[24:27], s70 offen sc1
    buffer_load_dwordx4 v[20:23], v9, s[24:27], s70 offen sc1
    buffer_load_dwordx4 v[24:27], v10, s[24:27], s70 offen sc1
    buffer_load_dwordx4 v[28:31], v11, s[24:27], s70 offen sc1
    buffer_load_dwordx4 v[52:55], v8, s[24:27], s71 offen sc1
    buffer_load_dwordx4 v[56:59], v9, s[24:27], s71 offen sc1
    buffer_load_dwordx4 v[60:63], v10, s[24:27], s71 offen sc1
    buffer_load_dwordx4 v[64:67], v11, s[24:27], s71 offen sc1
    buffer_load_dwordx4 v[88:91], v8, s[24:27], s72 offen sc1
    buffer_load_dwordx4 v[92:95], v9, s[24:27], s72 offen sc1
    buffer_load_dwordx4 v[96:99], v10, s[24:27], s72 offen sc1
    buffer_load_dwordx4 v[100:103], v11, s[24:27], s72 offen sc1
    buffer_load_dwordx4 v[124:127], v8, s[24:27], s73 offen sc1
    buffer_load_dwordx4 v[128:131], v9, s[24:27], s73 offen sc1
    buffer_load_dwordx4 v[132:135], v10, s[24:27], s73 offen sc1
    buffer_load_dwordx4 v[136:139], v11, s[24:27], s73 offen sc1
    s_mul_i32 s3, s48, 0x1400
    v_add_u32 v4, s3, v0
    v_add_u32 v13, 0xf000, v4
    s_waitcnt vmcnt(21)
    s_waitcnt vmcnt(15)
    v_mfma_f32_16x16x32_bf16 v[160:163], v[32:35], v[16:19], 0
    v_mfma_f32_16x16x32_bf16 v[164:167], v[36:39], v[16:19], 0
    v_mfma_f32_16x16x32_bf16 v[168:171], v[40:43], v[16:19], 0
    v_mfma_f32_16x16x32_bf16 v[172:175], v[44:47], v[16:19], 0
    v_mfma_f32_16x16x32_bf16 v[176:179], v[48:51], v[16:19], 0
    buffer_load_dwordx4 v[16:19], v8, s[24:27], s74 offen sc1
    s_waitcnt vmcnt(15)
    v_mfma_f32_16x16x32_bf16 v[180:183], v[32:35], v[20:23], 0
    v_mfma_f32_16x16x32_bf16 v[184:187], v[36:39], v[20:23], 0
    v_mfma_f32_16x16x32_bf16 v[188:191], v[40:43], v[20:23], 0
    v_mfma_f32_16x16x32_bf16 v[192:195], v[44:47], v[20:23], 0
    v_mfma_f32_16x16x32_bf16 v[196:199], v[48:51], v[20:23], 0
    buffer_load_dwordx4 v[20:23], v9, s[24:27], s74 offen sc1
    s_waitcnt vmcnt(15)
    v_mfma_f32_16x16x32_bf16 v[200:203], v[32:35], v[24:27], 0
    v_mfma_f32_16x16x32_bf16 v[204:207], v[36:39], v[24:27], 0
    v_mfma_f32_16x16x32_bf16 v[208:211], v[40:43], v[24:27], 0
    v_mfma_f32_16x16x32_bf16 v[212:215], v[44:47], v[24:27], 0
    v_mfma_f32_16x16x32_bf16 v[216:219], v[48:51], v[24:27], 0
    buffer_load_dwordx4 v[24:27], v10, s[24:27], s74 offen sc1
    s_waitcnt vmcnt(15)
    v_mfma_f32_16x16x32_bf16 v[220:223], v[32:35], v[28:31], 0
    v_mfma_f32_16x16x32_bf16 v[224:227], v[36:39], v[28:31], 0
    v_mfma_f32_16x16x32_bf16 v[228:231], v[40:43], v[28:31], 0
    v_mfma_f32_16x16x32_bf16 v[232:235], v[44:47], v[28:31], 0
    v_mfma_f32_16x16x32_bf16 v[236:239], v[48:51], v[28:31], 0
    buffer_load_dwordx4 v[28:31], v11, s[24:27], s74 offen sc1
    ds_read_b128 v[32:35], v5
    ds_read_b128 v[36:39], v5 offset:1024
    ds_read_b128 v[40:43], v5 offset:2048
    ds_read_b128 v[44:47], v5 offset:3072
    ds_read_b128 v[48:51], v5 offset:4096
    s_waitcnt vmcnt(15)
    v_mfma_f32_16x16x32_bf16 v[160:163], v[68:71], v[52:55], v[160:163]
    v_mfma_f32_16x16x32_bf16 v[164:167], v[72:75], v[52:55], v[164:167]
    v_mfma_f32_16x16x32_bf16 v[168:171], v[76:79], v[52:55], v[168:171]
    v_mfma_f32_16x16x32_bf16 v[172:175], v[80:83], v[52:55], v[172:175]
    v_mfma_f32_16x16x32_bf16 v[176:179], v[84:87], v[52:55], v[176:179]
    buffer_load_dwordx4 v[52:55], v8, s[24:27], s75 offen sc1
    s_waitcnt vmcnt(15)
    v_mfma_f32_16x16x32_bf16 v[180:183], v[68:71], v[56:59], v[180:183]
    v_mfma_f32_16x16x32_bf16 v[184:187], v[72:75], v[56:59], v[184:187]
    v_mfma_f32_16x16x32_bf16 v[188:191], v[76:79], v[56:59], v[188:191]
    v_mfma_f32_16x16x32_bf16 v[192:195], v[80:83], v[56:59], v[192:195]
    v_mfma_f32_16x16x32_bf16 v[196:199], v[84:87], v[56:59], v[196:199]
    buffer_load_dwordx4 v[56:59], v9, s[24:27], s75 offen sc1
    s_waitcnt vmcnt(15)
    v_mfma_f32_16x16x32_bf16 v[200:203], v[68:71], v[60:63], v[200:203]
    v_mfma_f32_16x16x32_bf16 v[204:207], v[72:75], v[60:63], v[204:207]
    v_mfma_f32_16x16x32_bf16 v[208:211], v[76:79], v[60:63], v[208:211]
    v_mfma_f32_16x16x32_bf16 v[212:215], v[80:83], v[60:63], v[212:215]
    v_mfma_f32_16x16x32_bf16 v[216:219], v[84:87], v[60:63], v[216:219]
    buffer_load_dwordx4 v[60:63], v10, s[24:27], s75 offen sc1
    s_waitcnt vmcnt(15)
    v_mfma_f32_16x16x32_bf16 v[220:223], v[68:71], v[64:67], v[220:223]
    v_mfma_f32_16x16x32_bf16 v[224:227], v[72:75], v[64:67], v[224:227]
    v_mfma_f32_16x16x32_bf16 v[228:231], v[76:79], v[64:67], v[228:231]
    v_mfma_f32_16x16x32_bf16 v[232:235], v[80:83], v[64:67], v[232:235]
    v_mfma_f32_16x16x32_bf16 v[236:239], v[84:87], v[64:67], v[236:239]
    buffer_load_dwordx4 v[64:67], v11, s[24:27], s75 offen sc1
    ds_read_b128 v[68:71], v5 offset:5120
    ds_read_b128 v[72:75], v5 offset:6144
    ds_read_b128 v[76:79], v5 offset:7168
    ds_read_b128 v[80:83], v5 offset:8192
    ds_read_b128 v[84:87], v5 offset:9216
    s_waitcnt vmcnt(15)
    v_mfma_f32_16x16x32_bf16 v[160:163], v[104:107], v[88:91], v[160:163]
    v_mfma_f32_16x16x32_bf16 v[164:167], v[108:111], v[88:91], v[164:167]
    v_mfma_f32_16x16x32_bf16 v[168:171], v[112:115], v[88:91], v[168:171]
    v_mfma_f32_16x16x32_bf16 v[172:175], v[116:119], v[88:91], v[172:175]
    v_mfma_f32_16x16x32_bf16 v[176:179], v[120:123], v[88:91], v[176:179]
    buffer_load_dwordx4 v[88:91], v8, s[24:27], s76 offen sc1
    s_waitcnt vmcnt(15)
    v_mfma_f32_16x16x32_bf16 v[180:183], v[104:107], v[92:95], v[180:183]
    v_mfma_f32_16x16x32_bf16 v[184:187], v[108:111], v[92:95], v[184:187]
    v_mfma_f32_16x16x32_bf16 v[188:191], v[112:115], v[92:95], v[188:191]
    v_mfma_f32_16x16x32_bf16 v[192:195], v[116:119], v[92:95], v[192:195]
    v_mfma_f32_16x16x32_bf16 v[196:199], v[120:123], v[92:95], v[196:199]
    buffer_load_dwordx4 v[92:95], v9, s[24:27], s76 offen sc1
    s_waitcnt vmcnt(15)
    v_mfma_f32_16x16x32_bf16 v[200:203], v[104:107], v[96:99], v[200:203]
    v_mfma_f32_16x16x32_bf16 v[204:207], v[108:111], v[96:99], v[204:207]
    v_mfma_f32_16x16x32_bf16 v[208:211], v[112:115], v[96:99], v[208:211]
    v_mfma_f32_16x16x32_bf16 v[212:215], v[116:119], v[96:99], v[212:215]
    v_mfma_f32_16x16x32_bf16 v[216:219], v[120:123], v[96:99], v[216:219]
    buffer_load_dwordx4 v[96:99], v10, s[24:27], s76 offen sc1
    s_waitcnt vmcnt(15)
    v_mfma_f32_16x16x32_bf16 v[220:223], v[104:107], v[100:103], v[220:223]
    v_mfma_f32_16x16x32_bf16 v[224:227], v[108:111], v[100:103], v[224:227]
    v_mfma_f32_16x16x32_bf16 v[228:231], v[112:115], v[100:103], v[228:231]
    v_mfma_f32_16x16x32_bf16 v[232:235], v[116:119], v[100:103], v[232:235]
    v_mfma_f32_16x16x32_bf16 v[236:239], v[120:123], v[100:103], v[236:239]
    buffer_load_dwordx4 v[100:103], v11, s[24:27], s76 offen sc1
    ds_read_b128 v[104:107], v5 offset:10240
    ds_read_b128 v[108:111], v5 offset:11264
    ds_read_b128 v[112:115], v5 offset:12288
    ds_read_b128 v[116:119], v5 offset:13312
    ds_read_b128 v[120:123], v5 offset:14336
    s_waitcnt vmcnt(15)
    v_mfma_f32_16x16x32_bf16 v[160:163], v[140:143], v[124:127], v[160:163]
    v_mfma_f32_16x16x32_bf16 v[164:167], v[144:147], v[124:127], v[164:167]
    v_mfma_f32_16x16x32_bf16 v[168:171], v[148:151], v[124:127], v[168:171]
    v_mfma_f32_16x16x32_bf16 v[172:175], v[152:155], v[124:127], v[172:175]
    v_mfma_f32_16x16x32_bf16 v[176:179], v[156:159], v[124:127], v[176:179]
    buffer_load_dwordx4 v[124:127], v8, s[24:27], s77 offen sc1
    s_waitcnt vmcnt(15)
    v_mfma_f32_16x16x32_bf16 v[180:183], v[140:143], v[128:131], v[180:183]
    v_mfma_f32_16x16x32_bf16 v[184:187], v[144:147], v[128:131], v[184:187]
    v_mfma_f32_16x16x32_bf16 v[188:191], v[148:151], v[128:131], v[188:191]
    v_mfma_f32_16x16x32_bf16 v[192:195], v[152:155], v[128:131], v[192:195]
    v_mfma_f32_16x16x32_bf16 v[196:199], v[156:159], v[128:131], v[196:199]
    buffer_load_dwordx4 v[128:131], v9, s[24:27], s77 offen sc1
    s_waitcnt vmcnt(15)
    v_mfma_f32_16x16x32_bf16 v[200:203], v[140:143], v[132:135], v[200:203]
    v_mfma_f32_16x16x32_bf16 v[204:207], v[144:147], v[132:135], v[204:207]
    v_mfma_f32_16x16x32_bf16 v[208:211], v[148:151], v[132:135], v[208:211]
    v_mfma_f32_16x16x32_bf16 v[212:215], v[152:155], v[132:135], v[212:215]
    v_mfma_f32_16x16x32_bf16 v[216:219], v[156:159], v[132:135], v[216:219]
    buffer_load_dwordx4 v[132:135], v10, s[24:27], s77 offen sc1
    s_waitcnt vmcnt(15)
    v_mfma_f32_16x16x32_bf16 v[220:223], v[140:143], v[136:139], v[220:223]
    v_mfma_f32_16x16x32_bf16 v[224:227], v[144:147], v[136:139], v[224:227]
    v_mfma_f32_16x16x32_bf16 v[228:231], v[148:151], v[136:139], v[228:231]
    v_mfma_f32_16x16x32_bf16 v[232:235], v[152:155], v[136:139], v[232:235]
    v_mfma_f32_16x16x32_bf16 v[236:239], v[156:159], v[136:139], v[236:239]
    buffer_load_dwordx4 v[136:139], v11, s[24:27], s77 offen sc1
    ds_read_b128 v[140:143], v5 offset:15360
    ds_read_b128 v[144:147], v5 offset:16384
    ds_read_b128 v[148:151], v5 offset:17408
    ds_read_b128 v[152:155], v5 offset:18432
    ds_read_b128 v[156:159], v5 offset:19456
    s_waitcnt vmcnt(15) lgkmcnt(15)
    v_mfma_f32_16x16x32_bf16 v[160:163], v[32:35], v[16:19], v[160:163]
    v_mfma_f32_16x16x32_bf16 v[164:167], v[36:39], v[16:19], v[164:167]
    v_mfma_f32_16x16x32_bf16 v[168:171], v[40:43], v[16:19], v[168:171]
    v_mfma_f32_16x16x32_bf16 v[172:175], v[44:47], v[16:19], v[172:175]
    v_mfma_f32_16x16x32_bf16 v[176:179], v[48:51], v[16:19], v[176:179]
    buffer_load_dwordx4 v[16:19], v8, s[24:27], s78 offen sc1
    s_waitcnt vmcnt(15)
    v_mfma_f32_16x16x32_bf16 v[180:183], v[32:35], v[20:23], v[180:183]
    v_mfma_f32_16x16x32_bf16 v[184:187], v[36:39], v[20:23], v[184:187]
    v_mfma_f32_16x16x32_bf16 v[188:191], v[40:43], v[20:23], v[188:191]
    v_mfma_f32_16x16x32_bf16 v[192:195], v[44:47], v[20:23], v[192:195]
    v_mfma_f32_16x16x32_bf16 v[196:199], v[48:51], v[20:23], v[196:199]
    buffer_load_dwordx4 v[20:23], v9, s[24:27], s78 offen sc1
    s_waitcnt vmcnt(15)
    v_mfma_f32_16x16x32_bf16 v[200:203], v[32:35], v[24:27], v[200:203]
    v_mfma_f32_16x16x32_bf16 v[204:207], v[36:39], v[24:27], v[204:207]
    v_mfma_f32_16x16x32_bf16 v[208:211], v[40:43], v[24:27], v[208:211]
    v_mfma_f32_16x16x32_bf16 v[212:215], v[44:47], v[24:27], v[212:215]
    v_mfma_f32_16x16x32_bf16 v[216:219], v[48:51], v[24:27], v[216:219]
    buffer_load_dwordx4 v[24:27], v10, s[24:27], s78 offen sc1
    s_waitcnt vmcnt(15)
    v_mfma_f32_16x16x32_bf16 v[220:223], v[32:35], v[28:31], v[220:223]
    v_mfma_f32_16x16x32_bf16 v[224:227], v[36:39], v[28:31], v[224:227]
    v_mfma_f32_16x16x32_bf16 v[228:231], v[40:43], v[28:31], v[228:231]
    v_mfma_f32_16x16x32_bf16 v[232:235], v[44:47], v[28:31], v[232:235]
    v_mfma_f32_16x16x32_bf16 v[236:239], v[48:51], v[28:31], v[236:239]
    buffer_load_dwordx4 v[28:31], v11, s[24:27], s78 offen sc1
    buffer_load_dwordx4 v[32:35], v0, s[28:31], s90 offen sc1
    buffer_load_dwordx4 v[36:39], v0, s[28:31], s90 offen offset:1024 sc1
    buffer_load_dwordx4 v[40:43], v0, s[28:31], s90 offen offset:2048 sc1
    buffer_load_dwordx4 v[44:47], v0, s[28:31], s90 offen offset:3072 sc1
    buffer_load_dwordx4 v[48:51], v1, s[28:31], s90 offen sc1
    s_waitcnt vmcnt(20) lgkmcnt(14)
    v_mfma_f32_16x16x32_bf16 v[160:163], v[68:71], v[52:55], v[160:163]
    s_waitcnt lgkmcnt(13)
    v_mfma_f32_16x16x32_bf16 v[164:167], v[72:75], v[52:55], v[164:167]
    s_waitcnt lgkmcnt(12)
    v_mfma_f32_16x16x32_bf16 v[168:171], v[76:79], v[52:55], v[168:171]
    s_waitcnt lgkmcnt(11)
    v_mfma_f32_16x16x32_bf16 v[172:175], v[80:83], v[52:55], v[172:175]
    s_waitcnt lgkmcnt(10)
    v_mfma_f32_16x16x32_bf16 v[176:179], v[84:87], v[52:55], v[176:179]
    buffer_load_dwordx4 v[52:55], v8, s[24:27], s79 offen sc1
    s_waitcnt vmcnt(20)
    v_mfma_f32_16x16x32_bf16 v[180:183], v[68:71], v[56:59], v[180:183]
    v_mfma_f32_16x16x32_bf16 v[184:187], v[72:75], v[56:59], v[184:187]
    v_mfma_f32_16x16x32_bf16 v[188:191], v[76:79], v[56:59], v[188:191]
    v_mfma_f32_16x16x32_bf16 v[192:195], v[80:83], v[56:59], v[192:195]
    v_mfma_f32_16x16x32_bf16 v[196:199], v[84:87], v[56:59], v[196:199]
    buffer_load_dwordx4 v[56:59], v9, s[24:27], s79 offen sc1
    s_waitcnt vmcnt(20)
    v_mfma_f32_16x16x32_bf16 v[200:203], v[68:71], v[60:63], v[200:203]
    v_mfma_f32_16x16x32_bf16 v[204:207], v[72:75], v[60:63], v[204:207]
    v_mfma_f32_16x16x32_bf16 v[208:211], v[76:79], v[60:63], v[208:211]
    v_mfma_f32_16x16x32_bf16 v[212:215], v[80:83], v[60:63], v[212:215]
    v_mfma_f32_16x16x32_bf16 v[216:219], v[84:87], v[60:63], v[216:219]
    buffer_load_dwordx4 v[60:63], v10, s[24:27], s79 offen sc1
    s_waitcnt vmcnt(20)
    v_mfma_f32_16x16x32_bf16 v[220:223], v[68:71], v[64:67], v[220:223]
    v_mfma_f32_16x16x32_bf16 v[224:227], v[72:75], v[64:67], v[224:227]
    v_mfma_f32_16x16x32_bf16 v[228:231], v[76:79], v[64:67], v[228:231]
    v_mfma_f32_16x16x32_bf16 v[232:235], v[80:83], v[64:67], v[232:235]
    v_mfma_f32_16x16x32_bf16 v[236:239], v[84:87], v[64:67], v[236:239]
    buffer_load_dwordx4 v[64:67], v11, s[24:27], s79 offen sc1
    buffer_load_dwordx4 v[68:71], v0, s[28:31], s91 offen sc1
    buffer_load_dwordx4 v[72:75], v0, s[28:31], s91 offen offset:1024 sc1
    buffer_load_dwordx4 v[76:79], v0, s[28:31], s91 offen offset:2048 sc1
    buffer_load_dwordx4 v[80:83], v0, s[28:31], s91 offen offset:3072 sc1
    buffer_load_dwordx4 v[84:87], v1, s[28:31], s91 offen sc1
    s_waitcnt vmcnt(25) lgkmcnt(9)
    v_mfma_f32_16x16x32_bf16 v[160:163], v[104:107], v[88:91], v[160:163]
    s_waitcnt lgkmcnt(8)
    v_mfma_f32_16x16x32_bf16 v[164:167], v[108:111], v[88:91], v[164:167]
    s_waitcnt lgkmcnt(7)
    v_mfma_f32_16x16x32_bf16 v[168:171], v[112:115], v[88:91], v[168:171]
    s_waitcnt lgkmcnt(6)
    v_mfma_f32_16x16x32_bf16 v[172:175], v[116:119], v[88:91], v[172:175]
    s_waitcnt lgkmcnt(5)
    v_mfma_f32_16x16x32_bf16 v[176:179], v[120:123], v[88:91], v[176:179]
    buffer_load_dwordx4 v[88:91], v8, s[24:27], s80 offen sc1
    s_waitcnt vmcnt(25)
    v_mfma_f32_16x16x32_bf16 v[180:183], v[104:107], v[92:95], v[180:183]
    v_mfma_f32_16x16x32_bf16 v[184:187], v[108:111], v[92:95], v[184:187]
    v_mfma_f32_16x16x32_bf16 v[188:191], v[112:115], v[92:95], v[188:191]
    v_mfma_f32_16x16x32_bf16 v[192:195], v[116:119], v[92:95], v[192:195]
    v_mfma_f32_16x16x32_bf16 v[196:199], v[120:123], v[92:95], v[196:199]
    buffer_load_dwordx4 v[92:95], v9, s[24:27], s80 offen sc1
    s_waitcnt vmcnt(25)
    v_mfma_f32_16x16x32_bf16 v[200:203], v[104:107], v[96:99], v[200:203]
    v_mfma_f32_16x16x32_bf16 v[204:207], v[108:111], v[96:99], v[204:207]
    v_mfma_f32_16x16x32_bf16 v[208:211], v[112:115], v[96:99], v[208:211]
    v_mfma_f32_16x16x32_bf16 v[212:215], v[116:119], v[96:99], v[212:215]
    v_mfma_f32_16x16x32_bf16 v[216:219], v[120:123], v[96:99], v[216:219]
    buffer_load_dwordx4 v[96:99], v10, s[24:27], s80 offen sc1
    s_waitcnt vmcnt(25)
    v_mfma_f32_16x16x32_bf16 v[220:223], v[104:107], v[100:103], v[220:223]
    v_mfma_f32_16x16x32_bf16 v[224:227], v[108:111], v[100:103], v[224:227]
    v_mfma_f32_16x16x32_bf16 v[228:231], v[112:115], v[100:103], v[228:231]
    v_mfma_f32_16x16x32_bf16 v[232:235], v[116:119], v[100:103], v[232:235]
    v_mfma_f32_16x16x32_bf16 v[236:239], v[120:123], v[100:103], v[236:239]
    buffer_load_dwordx4 v[100:103], v11, s[24:27], s80 offen sc1
    buffer_load_dwordx4 v[104:107], v0, s[28:31], s92 offen sc1
    buffer_load_dwordx4 v[108:111], v0, s[28:31], s92 offen offset:1024 sc1
    buffer_load_dwordx4 v[112:115], v0, s[28:31], s92 offen offset:2048 sc1
    buffer_load_dwordx4 v[116:119], v0, s[28:31], s92 offen offset:3072 sc1
    buffer_load_dwordx4 v[120:123], v1, s[28:31], s92 offen sc1
    s_waitcnt vmcnt(30) lgkmcnt(4)
    v_mfma_f32_16x16x32_bf16 v[160:163], v[140:143], v[124:127], v[160:163]
    s_waitcnt lgkmcnt(3)
    v_mfma_f32_16x16x32_bf16 v[164:167], v[144:147], v[124:127], v[164:167]
    s_waitcnt lgkmcnt(2)
    v_mfma_f32_16x16x32_bf16 v[168:171], v[148:151], v[124:127], v[168:171]
    s_waitcnt lgkmcnt(1)
    v_mfma_f32_16x16x32_bf16 v[172:175], v[152:155], v[124:127], v[172:175]
    s_waitcnt lgkmcnt(0)
    v_mfma_f32_16x16x32_bf16 v[176:179], v[156:159], v[124:127], v[176:179]
    buffer_load_dwordx4 v[124:127], v8, s[24:27], s81 offen sc1
    s_waitcnt vmcnt(30)
    v_mfma_f32_16x16x32_bf16 v[180:183], v[140:143], v[128:131], v[180:183]
    v_mfma_f32_16x16x32_bf16 v[184:187], v[144:147], v[128:131], v[184:187]
    v_mfma_f32_16x16x32_bf16 v[188:191], v[148:151], v[128:131], v[188:191]
    v_mfma_f32_16x16x32_bf16 v[192:195], v[152:155], v[128:131], v[192:195]
    v_mfma_f32_16x16x32_bf16 v[196:199], v[156:159], v[128:131], v[196:199]
    buffer_load_dwordx4 v[128:131], v9, s[24:27], s81 offen sc1
    s_waitcnt vmcnt(30)
    v_mfma_f32_16x16x32_bf16 v[200:203], v[140:143], v[132:135], v[200:203]
    v_mfma_f32_16x16x32_bf16 v[204:207], v[144:147], v[132:135], v[204:207]
    v_mfma_f32_16x16x32_bf16 v[208:211], v[148:151], v[132:135], v[208:211]
    v_mfma_f32_16x16x32_bf16 v[212:215], v[152:155], v[132:135], v[212:215]
    v_mfma_f32_16x16x32_bf16 v[216:219], v[156:159], v[132:135], v[216:219]
    buffer_load_dwordx4 v[132:135], v10, s[24:27], s81 offen sc1
    s_waitcnt vmcnt(30)
    v_mfma_f32_16x16x32_bf16 v[220:223], v[140:143], v[136:139], v[220:223]
    v_mfma_f32_16x16x32_bf16 v[224:227], v[144:147], v[136:139], v[224:227]
    v_mfma_f32_16x16x32_bf16 v[228:231], v[148:151], v[136:139], v[228:231]
    v_mfma_f32_16x16x32_bf16 v[232:235], v[152:155], v[136:139], v[232:235]
    v_mfma_f32_16x16x32_bf16 v[236:239], v[156:159], v[136:139], v[236:239]
    buffer_load_dwordx4 v[136:139], v11, s[24:27], s81 offen sc1
    buffer_load_dwordx4 v[140:143], v0, s[28:31], s93 offen sc1
    buffer_load_dwordx4 v[144:147], v0, s[28:31], s93 offen offset:1024 sc1
    buffer_load_dwordx4 v[148:151], v0, s[28:31], s93 offen offset:2048 sc1
    buffer_load_dwordx4 v[152:155], v0, s[28:31], s93 offen offset:3072 sc1
    buffer_load_dwordx4 v[156:159], v1, s[28:31], s93 offen sc1
    s_waitcnt vmcnt(31)
    v_mfma_f32_16x16x32_bf16 v[160:163], v[32:35], v[16:19], v[160:163]
    s_waitcnt vmcnt(30)
    v_mfma_f32_16x16x32_bf16 v[164:167], v[36:39], v[16:19], v[164:167]
    s_waitcnt vmcnt(29)
    v_mfma_f32_16x16x32_bf16 v[168:171], v[40:43], v[16:19], v[168:171]
    s_waitcnt vmcnt(28)
    v_mfma_f32_16x16x32_bf16 v[172:175], v[44:47], v[16:19], v[172:175]
    s_waitcnt vmcnt(27)
    v_mfma_f32_16x16x32_bf16 v[176:179], v[48:51], v[16:19], v[176:179]
    v_mfma_f32_16x16x32_bf16 v[180:183], v[32:35], v[20:23], v[180:183]
    v_mfma_f32_16x16x32_bf16 v[184:187], v[36:39], v[20:23], v[184:187]
    v_mfma_f32_16x16x32_bf16 v[188:191], v[40:43], v[20:23], v[188:191]
    v_mfma_f32_16x16x32_bf16 v[192:195], v[44:47], v[20:23], v[192:195]
    v_mfma_f32_16x16x32_bf16 v[196:199], v[48:51], v[20:23], v[196:199]
    v_mfma_f32_16x16x32_bf16 v[200:203], v[32:35], v[24:27], v[200:203]
    v_mfma_f32_16x16x32_bf16 v[204:207], v[36:39], v[24:27], v[204:207]
    v_mfma_f32_16x16x32_bf16 v[208:211], v[40:43], v[24:27], v[208:211]
    v_mfma_f32_16x16x32_bf16 v[212:215], v[44:47], v[24:27], v[212:215]
    v_mfma_f32_16x16x32_bf16 v[216:219], v[48:51], v[24:27], v[216:219]
    v_mfma_f32_16x16x32_bf16 v[220:223], v[32:35], v[28:31], v[220:223]
    v_mfma_f32_16x16x32_bf16 v[224:227], v[36:39], v[28:31], v[224:227]
    v_mfma_f32_16x16x32_bf16 v[228:231], v[40:43], v[28:31], v[228:231]
    v_mfma_f32_16x16x32_bf16 v[232:235], v[44:47], v[28:31], v[232:235]
    v_mfma_f32_16x16x32_bf16 v[236:239], v[48:51], v[28:31], v[236:239]
    s_waitcnt vmcnt(22)
    v_mfma_f32_16x16x32_bf16 v[160:163], v[68:71], v[52:55], v[160:163]
    s_waitcnt vmcnt(21)
    v_mfma_f32_16x16x32_bf16 v[164:167], v[72:75], v[52:55], v[164:167]
    s_waitcnt vmcnt(20)
    v_mfma_f32_16x16x32_bf16 v[168:171], v[76:79], v[52:55], v[168:171]
    s_waitcnt vmcnt(19)
    v_mfma_f32_16x16x32_bf16 v[172:175], v[80:83], v[52:55], v[172:175]
    s_waitcnt vmcnt(18)
    v_mfma_f32_16x16x32_bf16 v[176:179], v[84:87], v[52:55], v[176:179]
    v_mfma_f32_16x16x32_bf16 v[180:183], v[68:71], v[56:59], v[180:183]
    v_mfma_f32_16x16x32_bf16 v[184:187], v[72:75], v[56:59], v[184:187]
    v_mfma_f32_16x16x32_bf16 v[188:191], v[76:79], v[56:59], v[188:191]
    v_mfma_f32_16x16x32_bf16 v[192:195], v[80:83], v[56:59], v[192:195]
    v_mfma_f32_16x16x32_bf16 v[196:199], v[84:87], v[56:59], v[196:199]
    v_mfma_f32_16x16x32_bf16 v[200:203], v[68:71], v[60:63], v[200:203]
    v_mfma_f32_16x16x32_bf16 v[204:207], v[72:75], v[60:63], v[204:207]
    v_mfma_f32_16x16x32_bf16 v[208:211], v[76:79], v[60:63], v[208:211]
    v_mfma_f32_16x16x32_bf16 v[212:215], v[80:83], v[60:63], v[212:215]
    v_mfma_f32_16x16x32_bf16 v[216:219], v[84:87], v[60:63], v[216:219]
    v_mfma_f32_16x16x32_bf16 v[220:223], v[68:71], v[64:67], v[220:223]
    v_mfma_f32_16x16x32_bf16 v[224:227], v[72:75], v[64:67], v[224:227]
    v_mfma_f32_16x16x32_bf16 v[228:231], v[76:79], v[64:67], v[228:231]
    v_mfma_f32_16x16x32_bf16 v[232:235], v[80:83], v[64:67], v[232:235]
    v_mfma_f32_16x16x32_bf16 v[236:239], v[84:87], v[64:67], v[236:239]
    s_waitcnt vmcnt(13)
    v_mfma_f32_16x16x32_bf16 v[160:163], v[104:107], v[88:91], v[160:163]
    s_waitcnt vmcnt(12)
    v_mfma_f32_16x16x32_bf16 v[164:167], v[108:111], v[88:91], v[164:167]
    s_waitcnt vmcnt(11)
    v_mfma_f32_16x16x32_bf16 v[168:171], v[112:115], v[88:91], v[168:171]
    s_waitcnt vmcnt(10)
    v_mfma_f32_16x16x32_bf16 v[172:175], v[116:119], v[88:91], v[172:175]
    s_waitcnt vmcnt(9)
    v_mfma_f32_16x16x32_bf16 v[176:179], v[120:123], v[88:91], v[176:179]
    v_mfma_f32_16x16x32_bf16 v[180:183], v[104:107], v[92:95], v[180:183]
    v_mfma_f32_16x16x32_bf16 v[184:187], v[108:111], v[92:95], v[184:187]
    v_mfma_f32_16x16x32_bf16 v[188:191], v[112:115], v[92:95], v[188:191]
    v_mfma_f32_16x16x32_bf16 v[192:195], v[116:119], v[92:95], v[192:195]
    v_mfma_f32_16x16x32_bf16 v[196:199], v[120:123], v[92:95], v[196:199]
    v_mfma_f32_16x16x32_bf16 v[200:203], v[104:107], v[96:99], v[200:203]
    v_mfma_f32_16x16x32_bf16 v[204:207], v[108:111], v[96:99], v[204:207]
    v_mfma_f32_16x16x32_bf16 v[208:211], v[112:115], v[96:99], v[208:211]
    v_mfma_f32_16x16x32_bf16 v[212:215], v[116:119], v[96:99], v[212:215]
    v_mfma_f32_16x16x32_bf16 v[216:219], v[120:123], v[96:99], v[216:219]
    v_mfma_f32_16x16x32_bf16 v[220:223], v[104:107], v[100:103], v[220:223]
    v_mfma_f32_16x16x32_bf16 v[224:227], v[108:111], v[100:103], v[224:227]
    v_mfma_f32_16x16x32_bf16 v[228:231], v[112:115], v[100:103], v[228:231]
    v_mfma_f32_16x16x32_bf16 v[232:235], v[116:119], v[100:103], v[232:235]
    v_mfma_f32_16x16x32_bf16 v[236:239], v[120:123], v[100:103], v[236:239]
    s_waitcnt vmcnt(4)
    v_mfma_f32_16x16x32_bf16 v[180:183], v[140:143], v[128:131], v[180:183]
    v_lshlrev_b32 v16, 16, v240
    v_and_b32 v17, 0xffff0000, v240
    s_waitcnt vmcnt(3)
    v_mfma_f32_16x16x32_bf16 v[184:187], v[144:147], v[128:131], v[184:187]
    v_lshlrev_b32 v18, 16, v241
    v_and_b32 v19, 0xffff0000, v241
    s_waitcnt vmcnt(2)
    v_mfma_f32_16x16x32_bf16 v[188:191], v[148:151], v[128:131], v[188:191]
    v_lshlrev_b32 v20, 16, v242
    v_and_b32 v21, 0xffff0000, v242
    s_waitcnt vmcnt(1)
    v_mfma_f32_16x16x32_bf16 v[192:195], v[152:155], v[128:131], v[192:195]
    v_lshlrev_b32 v22, 16, v243
    v_and_b32 v23, 0xffff0000, v243
    s_waitcnt vmcnt(0)
    v_mfma_f32_16x16x32_bf16 v[196:199], v[156:159], v[128:131], v[196:199]
    v_lshlrev_b32 v24, 16, v244
    v_and_b32 v25, 0xffff0000, v244
    v_mfma_f32_16x16x32_bf16 v[200:203], v[140:143], v[132:135], v[200:203]
    v_lshlrev_b32 v26, 16, v245
    v_and_b32 v27, 0xffff0000, v245
    v_mfma_f32_16x16x32_bf16 v[204:207], v[144:147], v[132:135], v[204:207]
    v_lshlrev_b32 v28, 16, v246
    v_and_b32 v29, 0xffff0000, v246
    v_mfma_f32_16x16x32_bf16 v[208:211], v[148:151], v[132:135], v[208:211]
    v_lshlrev_b32 v30, 16, v247
    v_and_b32 v31, 0xffff0000, v247
    v_mfma_f32_16x16x32_bf16 v[212:215], v[152:155], v[132:135], v[212:215]
    v_lshlrev_b32 v32, 16, v248
    v_and_b32 v33, 0xffff0000, v248
    v_mfma_f32_16x16x32_bf16 v[216:219], v[156:159], v[132:135], v[216:219]
    v_lshlrev_b32 v34, 16, v249
    v_and_b32 v35, 0xffff0000, v249
    v_mfma_f32_16x16x32_bf16 v[220:223], v[140:143], v[136:139], v[220:223]
    ds_write_b128 v5, v[180:183]
    v_mfma_f32_16x16x32_bf16 v[224:227], v[144:147], v[136:139], v[224:227]
    ds_write_b128 v5, v[184:187] offset:1024
    v_mfma_f32_16x16x32_bf16 v[228:231], v[148:151], v[136:139], v[228:231]
    ds_write_b128 v5, v[188:191] offset:2048
    v_mfma_f32_16x16x32_bf16 v[232:235], v[152:155], v[136:139], v[232:235]
    ds_write_b128 v5, v[192:195] offset:3072
    v_mfma_f32_16x16x32_bf16 v[236:239], v[156:159], v[136:139], v[236:239]
    ds_write_b128 v5, v[196:199] offset:4096
    v_mfma_f32_16x16x32_bf16 v[160:163], v[140:143], v[124:127], v[160:163]
    ds_write_b128 v5, v[200:203] offset:5120
    v_mfma_f32_16x16x32_bf16 v[164:167], v[144:147], v[124:127], v[164:167]
    ds_write_b128 v5, v[204:207] offset:6144
    v_mfma_f32_16x16x32_bf16 v[168:171], v[148:151], v[124:127], v[168:171]
    ds_write_b128 v5, v[208:211] offset:7168
    v_mfma_f32_16x16x32_bf16 v[172:175], v[152:155], v[124:127], v[172:175]
    ds_write_b128 v5, v[212:215] offset:8192
    v_mfma_f32_16x16x32_bf16 v[176:179], v[156:159], v[124:127], v[176:179]
    ds_write_b128 v5, v[216:219] offset:9216
    ds_write_b128 v5, v[220:223] offset:10240
    ds_write_b128 v5, v[224:227] offset:11264
    ds_write_b128 v5, v[228:231] offset:12288
    ds_write_b128 v5, v[232:235] offset:13312
    ds_write_b128 v5, v[236:239] offset:14336
    s_waitcnt lgkmcnt(0)
    s_barrier
    ds_read_b128 v[36:39], v251
    ds_read_b128 v[56:59], v252
    ds_read_b128 v[76:79], v253
    ds_read_b128 v[180:183], v4
    ds_read_b128 v[200:203], v4 offset:20480
    ds_read_b128 v[220:223], v4 offset:40960
    ds_read_b128 v[96:99], v13
    ds_read_b128 v[40:43], v251 offset:1024
    ds_read_b128 v[60:63], v252 offset:1024
    ds_read_b128 v[80:83], v253 offset:1024
    ds_read_b128 v[184:187], v4 offset:1024
    ds_read_b128 v[204:207], v4 offset:21504
    ds_read_b128 v[224:227], v4 offset:41984
    ds_read_b128 v[100:103], v13 offset:1024
    ds_read_b128 v[44:47], v251 offset:2048
    ds_read_b128 v[64:67], v252 offset:2048
    ds_read_b128 v[84:87], v253 offset:2048
    ds_read_b128 v[188:191], v4 offset:2048
    ds_read_b128 v[208:211], v4 offset:22528
    ds_read_b128 v[228:231], v4 offset:43008
    ds_read_b128 v[104:107], v13 offset:2048
    ds_read_b128 v[48:51], v251 offset:3072
    ds_read_b128 v[68:71], v252 offset:3072
    ds_read_b128 v[88:91], v253 offset:3072
    ds_read_b128 v[192:195], v4 offset:3072
    ds_read_b128 v[212:215], v4 offset:23552
    ds_read_b128 v[232:235], v4 offset:44032
    ds_read_b128 v[108:111], v13 offset:3072
    ds_read_b128 v[52:55], v251 offset:4096
    ds_read_b128 v[72:75], v252 offset:4096
    ds_read_b128 v[92:95], v253 offset:4096
    ds_read_b128 v[196:199], v4 offset:4096
    ds_read_b128 v[216:219], v4 offset:24576
    ds_read_b128 v[236:239], v4 offset:45056
    ds_read_b128 v[112:115], v13 offset:4096
    s_waitcnt lgkmcnt(15)
    v_add_f32 v160, v160, v36
    v_add_f32 v161, v161, v37
    v_add_f32 v162, v162, v38
    v_add_f32 v163, v163, v39
    v_add_f32 v160, v160, v56
    v_add_f32 v161, v161, v57
    v_add_f32 v162, v162, v58
    v_add_f32 v163, v163, v59
    v_add_f32 v160, v160, v76
    v_add_f32 v161, v161, v77
    v_add_f32 v162, v162, v78
    v_add_f32 v163, v163, v79
    v_mul_f32 v116, 0xbfb8aa3b, v160
    v_mul_f32 v117, 0xbfb8aa3b, v161
    v_mul_f32 v118, 0xbfb8aa3b, v162
    v_mul_f32 v119, 0xbfb8aa3b, v163
    v_exp_f32 v116, v116
    v_exp_f32 v117, v117
    v_exp_f32 v118, v118
    v_exp_f32 v119, v119
    v_add_f32 v180, v180, v200
    v_add_f32 v181, v181, v201
    v_add_f32 v182, v182, v202
    v_add_f32 v183, v183, v203
    v_add_f32 v96, v96, v220
    v_add_f32 v97, v97, v221
    v_add_f32 v98, v98, v222
    v_add_f32 v99, v99, v223
    v_add_f32 v116, 1.0, v116
    v_add_f32 v117, 1.0, v117
    v_add_f32 v118, 1.0, v118
    v_add_f32 v119, 1.0, v119
    v_add_f32 v180, v180, v96
    v_add_f32 v181, v181, v97
    v_add_f32 v182, v182, v98
    v_add_f32 v183, v183, v99
    v_rcp_f32 v116, v116
    v_rcp_f32 v117, v117
    v_rcp_f32 v118, v118
    v_rcp_f32 v119, v119
    v_mul_f32 v180, v180, v160
    v_mul_f32 v181, v181, v161
    v_mul_f32 v182, v182, v162
    v_mul_f32 v183, v183, v163
    v_fmac_f32 v16, v180, v116
    v_fmac_f32 v17, v181, v117
    v_fmac_f32 v18, v182, v118
    v_fmac_f32 v19, v183, v119
    v_cvt_pk_bf16_f32 v180, v16, v17
    v_cvt_pk_bf16_f32 v181, v18, v19
    buffer_store_dwordx2 v[180:181], v2, s[44:47], 0 offen
    v_add_f32 v164, v164, v40
    v_add_f32 v165, v165, v41
    v_add_f32 v166, v166, v42
    v_add_f32 v167, v167, v43
    v_add_f32 v164, v164, v60
    v_add_f32 v165, v165, v61
    v_add_f32 v166, v166, v62
    v_add_f32 v167, v167, v63
    v_add_f32 v164, v164, v80
    v_add_f32 v165, v165, v81
    v_add_f32 v166, v166, v82
    v_add_f32 v167, v167, v83
    v_mul_f32 v120, 0xbfb8aa3b, v164
    v_mul_f32 v121, 0xbfb8aa3b, v165
    v_mul_f32 v122, 0xbfb8aa3b, v166
    v_mul_f32 v123, 0xbfb8aa3b, v167
    v_exp_f32 v120, v120
    v_exp_f32 v121, v121
    v_exp_f32 v122, v122
    v_exp_f32 v123, v123
    v_add_f32 v184, v184, v204
    v_add_f32 v185, v185, v205
    v_add_f32 v186, v186, v206
    v_add_f32 v187, v187, v207
    v_add_f32 v100, v100, v224
    v_add_f32 v101, v101, v225
    v_add_f32 v102, v102, v226
    v_add_f32 v103, v103, v227
    v_add_f32 v120, 1.0, v120
    v_add_f32 v121, 1.0, v121
    v_add_f32 v122, 1.0, v122
    v_add_f32 v123, 1.0, v123
    v_add_f32 v184, v184, v100
    v_add_f32 v185, v185, v101
    v_add_f32 v186, v186, v102
    v_add_f32 v187, v187, v103
    v_rcp_f32 v120, v120
    v_rcp_f32 v121, v121
    v_rcp_f32 v122, v122
    v_rcp_f32 v123, v123
    v_mul_f32 v184, v184, v164
    v_mul_f32 v185, v185, v165
    v_mul_f32 v186, v186, v166
    v_mul_f32 v187, v187, v167
    v_fmac_f32 v20, v184, v120
    v_fmac_f32 v21, v185, v121
    v_fmac_f32 v22, v186, v122
    v_fmac_f32 v23, v187, v123
    v_cvt_pk_bf16_f32 v184, v20, v21
    v_cvt_pk_bf16_f32 v185, v22, v23
    buffer_store_dwordx2 v[184:185], v2, s[44:47], 0 offen offset:32
    v_add_f32 v168, v168, v44
    v_add_f32 v169, v169, v45
    v_add_f32 v170, v170, v46
    v_add_f32 v171, v171, v47
    v_add_f32 v168, v168, v64
    v_add_f32 v169, v169, v65
    v_add_f32 v170, v170, v66
    v_add_f32 v171, v171, v67
    v_add_f32 v168, v168, v84
    v_add_f32 v169, v169, v85
    v_add_f32 v170, v170, v86
    v_add_f32 v171, v171, v87
    v_mul_f32 v124, 0xbfb8aa3b, v168
    v_mul_f32 v125, 0xbfb8aa3b, v169
    v_mul_f32 v126, 0xbfb8aa3b, v170
    v_mul_f32 v127, 0xbfb8aa3b, v171
    v_exp_f32 v124, v124
    v_exp_f32 v125, v125
    v_exp_f32 v126, v126
    v_exp_f32 v127, v127
    v_add_f32 v188, v188, v208
    v_add_f32 v189, v189, v209
    v_add_f32 v190, v190, v210
    v_add_f32 v191, v191, v211
    s_waitcnt lgkmcnt(14)
    v_add_f32 v104, v104, v228
    v_add_f32 v105, v105, v229
    v_add_f32 v106, v106, v230
    v_add_f32 v107, v107, v231
    v_add_f32 v124, 1.0, v124
    v_add_f32 v125, 1.0, v125
    v_add_f32 v126, 1.0, v126
    v_add_f32 v127, 1.0, v127
    v_add_f32 v188, v188, v104
    v_add_f32 v189, v189, v105
    v_add_f32 v190, v190, v106
    v_add_f32 v191, v191, v107
    v_rcp_f32 v124, v124
    v_rcp_f32 v125, v125
    v_rcp_f32 v126, v126
    v_rcp_f32 v127, v127
    v_mul_f32 v188, v188, v168
    v_mul_f32 v189, v189, v169
    v_mul_f32 v190, v190, v170
    v_mul_f32 v191, v191, v171
    v_fmac_f32 v24, v188, v124
    v_fmac_f32 v25, v189, v125
    v_fmac_f32 v26, v190, v126
    v_fmac_f32 v27, v191, v127
    v_cvt_pk_bf16_f32 v188, v24, v25
    v_cvt_pk_bf16_f32 v189, v26, v27
    buffer_store_dwordx2 v[188:189], v2, s[44:47], 0 offen offset:64
    s_waitcnt lgkmcnt(13)
    v_add_f32 v172, v172, v48
    v_add_f32 v173, v173, v49
    v_add_f32 v174, v174, v50
    v_add_f32 v175, v175, v51
    s_waitcnt lgkmcnt(12)
    v_add_f32 v172, v172, v68
    v_add_f32 v173, v173, v69
    v_add_f32 v174, v174, v70
    v_add_f32 v175, v175, v71
    s_waitcnt lgkmcnt(11)
    v_add_f32 v172, v172, v88
    v_add_f32 v173, v173, v89
    v_add_f32 v174, v174, v90
    v_add_f32 v175, v175, v91
    v_mul_f32 v128, 0xbfb8aa3b, v172
    v_mul_f32 v129, 0xbfb8aa3b, v173
    v_mul_f32 v130, 0xbfb8aa3b, v174
    v_mul_f32 v131, 0xbfb8aa3b, v175
    v_exp_f32 v128, v128
    v_exp_f32 v129, v129
    v_exp_f32 v130, v130
    v_exp_f32 v131, v131
    s_waitcnt lgkmcnt(9)
    v_add_f32 v192, v192, v212
    v_add_f32 v193, v193, v213
    v_add_f32 v194, v194, v214
    v_add_f32 v195, v195, v215
    s_waitcnt lgkmcnt(7)
    v_add_f32 v108, v108, v232
    v_add_f32 v109, v109, v233
    v_add_f32 v110, v110, v234
    v_add_f32 v111, v111, v235
    v_add_f32 v128, 1.0, v128
    v_add_f32 v129, 1.0, v129
    v_add_f32 v130, 1.0, v130
    v_add_f32 v131, 1.0, v131
    v_add_f32 v192, v192, v108
    v_add_f32 v193, v193, v109
    v_add_f32 v194, v194, v110
    v_add_f32 v195, v195, v111
    v_rcp_f32 v128, v128
    v_rcp_f32 v129, v129
    v_rcp_f32 v130, v130
    v_rcp_f32 v131, v131
    v_mul_f32 v192, v192, v172
    v_mul_f32 v193, v193, v173
    v_mul_f32 v194, v194, v174
    v_mul_f32 v195, v195, v175
    v_fmac_f32 v28, v192, v128
    v_fmac_f32 v29, v193, v129
    v_fmac_f32 v30, v194, v130
    v_fmac_f32 v31, v195, v131
    v_cvt_pk_bf16_f32 v192, v28, v29
    v_cvt_pk_bf16_f32 v193, v30, v31
    buffer_store_dwordx2 v[192:193], v2, s[44:47], 0 offen offset:96
    s_waitcnt lgkmcnt(6)
    v_add_f32 v176, v176, v52
    v_add_f32 v177, v177, v53
    v_add_f32 v178, v178, v54
    v_add_f32 v179, v179, v55
    s_waitcnt lgkmcnt(5)
    v_add_f32 v176, v176, v72
    v_add_f32 v177, v177, v73
    v_add_f32 v178, v178, v74
    v_add_f32 v179, v179, v75
    s_waitcnt lgkmcnt(4)
    v_add_f32 v176, v176, v92
    v_add_f32 v177, v177, v93
    v_add_f32 v178, v178, v94
    v_add_f32 v179, v179, v95
    v_mul_f32 v132, 0xbfb8aa3b, v176
    v_mul_f32 v133, 0xbfb8aa3b, v177
    v_mul_f32 v134, 0xbfb8aa3b, v178
    v_mul_f32 v135, 0xbfb8aa3b, v179
    v_exp_f32 v132, v132
    v_exp_f32 v133, v133
    v_exp_f32 v134, v134
    v_exp_f32 v135, v135
    s_waitcnt lgkmcnt(2)
    v_add_f32 v196, v196, v216
    v_add_f32 v197, v197, v217
    v_add_f32 v198, v198, v218
    v_add_f32 v199, v199, v219
    s_waitcnt lgkmcnt(0)
    v_add_f32 v112, v112, v236
    v_add_f32 v113, v113, v237
    v_add_f32 v114, v114, v238
    v_add_f32 v115, v115, v239
    v_add_f32 v132, 1.0, v132
    v_add_f32 v133, 1.0, v133
    v_add_f32 v134, 1.0, v134
    v_add_f32 v135, 1.0, v135
    v_add_f32 v196, v196, v112
    v_add_f32 v197, v197, v113
    v_add_f32 v198, v198, v114
    v_add_f32 v199, v199, v115
    v_rcp_f32 v132, v132
    v_rcp_f32 v133, v133
    v_rcp_f32 v134, v134
    v_rcp_f32 v135, v135
    v_mul_f32 v196, v196, v176
    v_mul_f32 v197, v197, v177
    v_mul_f32 v198, v198, v178
    v_mul_f32 v199, v199, v179
    v_fmac_f32 v32, v196, v132
    v_fmac_f32 v33, v197, v133
    v_fmac_f32 v34, v198, v134
    v_fmac_f32 v35, v199, v135
    v_cvt_pk_bf16_f32 v196, v32, v33
    v_cvt_pk_bf16_f32 v197, v34, v35
    buffer_store_dwordx2 v[196:197], v2, s[44:47], 0 offen offset:128
    s_endpgm
P2S:
    s_setprio 3
    s_mul_i32 s3, s48, 0x46000
    s_sub_u32 s51, 0x1e0000, s3
    s_add_u32 s3, s51, 0
    buffer_load_dwordx4 v[68:71], v0, s[28:31], s3 offen sc1
    s_add_u32 s3, s51, 0
    buffer_load_dwordx4 v[72:75], v0, s[28:31], s3 offen offset:1024 sc1
    s_add_u32 s3, s51, 0
    buffer_load_dwordx4 v[76:79], v0, s[28:31], s3 offen offset:2048 sc1
    s_add_u32 s3, s51, 0
    buffer_load_dwordx4 v[80:83], v0, s[28:31], s3 offen offset:3072 sc1
    s_add_u32 s3, s51, 0
    buffer_load_dwordx4 v[84:87], v1, s[28:31], s3 offen sc1
    s_mul_i32 s3, s49, 0x14000
    s_mul_i32 s7, s48, 0x1400
    s_add_u32 s3, s3, s7
    s_add_u32 s32, s22, s3
    s_addc_u32 s33, s23, 0
    s_add_u32 s32, s32, 0x600000
    s_addc_u32 s33, s33, 0
    s_sub_u32 s34, 0x280000, s3
    s_mov_b32 s35, 0x20000
    s_mul_i32 s3, s48, 0x6c00
    s_add_u32 s36, s22, s3
    s_addc_u32 s37, s23, 0
    s_add_u32 s36, s36, 0x980000
    s_addc_u32 s37, s37, 0
    s_sub_u32 s38, 0x1b000, s3
    s_mov_b32 s39, 0x20000
    s_add_u32 s52, s22, 0x880000
    s_addc_u32 s53, s23, 0
    s_mov_b32 s54, 0xe0000
    s_mov_b32 s55, 0x20000
    s_add_u32 s8, s22, 0x980000
    s_addc_u32 s9, s23, 0
    s_mov_b32 s10, 0x1b000
    s_mov_b32 s11, 0x20000
    s_mul_i32 s16, s48, 0x5000
    v_add_u32 v3, s16, v0
    s_lshl_b32 s3, s2, 2
    s_add_u32 s3, s3, s48
    s_lshl_b32 s3, s3, 2
    v_lshrrev_b32 v88, 4, v14
    v_add_u32 v88, s3, v88
    v_and_b32 v98, 15, v14
    v_mul_u32_u24 v101, 0xe000, v98
    v_lshl_add_u32 v101, v88, 4, v101
    v_mul_u32_u24 v89, 0x2703, v88
    v_lshrrev_b32 v89, 20, v89
    v_mul_u32_u24 v89, 0x70, v89
    v_add_u32 v101, v101, v89
    v_cmp_gt_u32 vcc, 0xd20, v88
    v_mov_b32 v100, 0x40000000
    s_nop 0
    v_cndmask_b32 v101, v100, v101, vcc
    v_mul_u32_u24 v90, 0x3334, v88
    v_lshrrev_b32 v90, 16, v90
    v_mul_u32_u24 v91, 5, v90
    v_sub_u32 v91, v88, v91
    v_mul_u32_u24 v89, 0xc31, v90
    v_lshrrev_b32 v89, 16, v89
    v_mul_u32_u24 v99, 21, v89
    v_sub_u32 v90, v90, v99
    v_and_b32 v95, 7, v89
    v_lshrrev_b32 v89, 3, v89
    v_mul_u32_u24 v92, 5, v95
    v_add_u32 v91, v91, v92
    v_lshrrev_b32 v93, 3, v91
    v_bfe_u32 v94, v91, 2, 1
    v_and_b32 v99, 1, v91
    v_lshl_add_u32 v94, v94, 1, v99
    v_lshlrev_b32 v94, 8, v94
    v_bfe_u32 v99, v91, 1, 1
    v_lshl_add_u32 v94, v99, 3, v94
    v_lshl_add_u32 v95, v92, 2, v90
    v_lshrrev_b32 v96, 4, v95
    v_and_b32 v95, 15, v95
    v_add_u32 v99, -1, v96
    v_add_u32 v97, v96, v99
    v_ashrrev_i32 v99, 1, v99
    v_sub_u32 v97, v97, v99
    v_add_u32 v92, v92, v98
    v_lshrrev_b32 v96, 2, v92
    v_and_b32 v92, 3, v92
    v_and_b32 v99, 3, v96
    v_lshl_add_u32 v92, v92, 2, v99
    v_lshrrev_b32 v96, 2, v96
    v_lshl_add_u32 v96, v96, 1, 18
    v_cmp_eq_u32 s[6:7], 20, v90
    s_nop 1
    v_cndmask_b32 v97, v97, v96, s[6:7]
    v_cndmask_b32 v95, v95, v92, s[6:7]
    v_mov_b32 v99, 1
    v_mov_b32 v96, 5
    v_cndmask_b32 v99, v99, v96, s[6:7]
    v_add_u32 v97, v97, v93
    v_mul_u32_u24 v89, 27, v89
    v_add_u32 v97, v97, v89
    v_lshl_add_u32 v94, v95, 4, v94
    v_lshl_add_u32 v94, v97, 10, v94
    v_cmp_lt_u32 s[6:7], v98, v99
    s_nop 0
    s_and_b64 vcc, vcc, s[6:7]
    v_cndmask_b32 v94, v100, v94, vcc
    buffer_load_dwordx4 v[136:139], v101, s[52:55], 0 offen sc1
P2S_kb:
    s_waitcnt vmcnt(0)
    v_cmp_eq_u32 vcc, -1, v136
    s_nop 4
    s_cbranch_vccnz P2S_kr
P2S_kx:
    v_add_f32 v136, v136, v136 row_ror:8
    v_add_f32 v137, v137, v137 row_ror:8
    v_add_f32 v138, v138, v138 row_ror:8
    v_add_f32 v139, v139, v139 row_ror:8
    v_add_f32 v136, v136, v136 row_ror:4
    v_add_f32 v137, v137, v137 row_ror:4
    v_add_f32 v138, v138, v138 row_ror:4
    v_add_f32 v139, v139, v139 row_ror:4
    v_add_f32 v136, v136, v136 row_ror:2
    v_add_f32 v137, v137, v137 row_ror:2
    v_add_f32 v138, v138, v138 row_ror:2
    v_add_f32 v139, v139, v139 row_ror:2
    v_add_f32 v136, v136, v136 row_ror:1
    v_add_f32 v137, v137, v137 row_ror:1
    v_add_f32 v138, v138, v138 row_ror:1
    v_add_f32 v139, v139, v139 row_ror:1
    v_cvt_pk_bf16_f32 v136, v136, v137
    v_cvt_pk_bf16_f32 v137, v138, v139
    buffer_store_dwordx2 v[136:137], v94, s[8:11], 0 offen sc1
    s_add_u32 m0, s16, 0
    s_mov_b32 s3, 0
    buffer_load_dwordx4 v0, s[32:35], s3 offen sc1 lds
    s_add_u32 m0, s16, 0x400
    s_mov_b32 s3, 0x400
    buffer_load_dwordx4 v0, s[32:35], s3 offen sc1 lds
    s_add_u32 m0, s16, 0x800
    s_mov_b32 s3, 0x800
    buffer_load_dwordx4 v0, s[32:35], s3 offen sc1 lds
    s_add_u32 m0, s16, 0xc00
    s_mov_b32 s3, 0xc00
    buffer_load_dwordx4 v0, s[32:35], s3 offen sc1 lds
    s_add_u32 m0, s16, 0x1000
    s_mov_b32 s3, 0x1000
    buffer_load_dwordx4 v0, s[32:35], s3 offen sc1 lds
    s_add_u32 m0, s16, 0x1400
    s_mov_b32 s3, 0x5000
    buffer_load_dwordx4 v0, s[32:35], s3 offen sc1 lds
    s_add_u32 m0, s16, 0x1800
    s_mov_b32 s3, 0x5400
    buffer_load_dwordx4 v0, s[32:35], s3 offen sc1 lds
    s_add_u32 m0, s16, 0x1c00
    s_mov_b32 s3, 0x5800
    buffer_load_dwordx4 v0, s[32:35], s3 offen sc1 lds
    s_add_u32 m0, s16, 0x2000
    s_mov_b32 s3, 0x5c00
    buffer_load_dwordx4 v0, s[32:35], s3 offen sc1 lds
    s_add_u32 m0, s16, 0x2400
    s_mov_b32 s3, 0x6000
    buffer_load_dwordx4 v0, s[32:35], s3 offen sc1 lds
    s_add_u32 m0, s16, 0x2800
    s_mov_b32 s3, 0xa000
    buffer_load_dwordx4 v0, s[32:35], s3 offen sc1 lds
    s_add_u32 m0, s16, 0x2c00
    s_mov_b32 s3, 0xa400
    buffer_load_dwordx4 v0, s[32:35], s3 offen sc1 lds
    s_add_u32 m0, s16, 0x3000
    s_mov_b32 s3, 0xa800
    buffer_load_dwordx4 v0, s[32:35], s3 offen sc1 lds
    s_add_u32 m0, s16, 0x3400
    s_mov_b32 s3, 0xac00
    buffer_load_dwordx4 v0, s[32:35], s3 offen sc1 lds
    s_add_u32 m0, s16, 0x3800
    s_mov_b32 s3, 0xb000
    buffer_load_dwordx4 v0, s[32:35], s3 offen sc1 lds
    s_add_u32 m0, s16, 0x3c00
    s_mov_b32 s3, 0xf000
    buffer_load_dwordx4 v0, s[32:35], s3 offen sc1 lds
    s_add_u32 m0, s16, 0x4000
    s_mov_b32 s3, 0xf400
    buffer_load_dwordx4 v0, s[32:35], s3 offen sc1 lds
    s_add_u32 m0, s16, 0x4400
    s_mov_b32 s3, 0xf800
    buffer_load_dwordx4 v0, s[32:35], s3 offen sc1 lds
    s_add_u32 m0, s16, 0x4800
    s_mov_b32 s3, 0xfc00
    buffer_load_dwordx4 v0, s[32:35], s3 offen sc1 lds
    s_add_u32 m0, s16, 0x4c00
    s_mov_b32 s3, 0x10000
    buffer_load_dwordx4 v0, s[32:35], s3 offen sc1 lds
    s_waitcnt vmcnt(0)
    s_mov_b32 s3, 0x4800
    buffer_load_dwordx4 v[16:19], v0, s[36:39], s3 offen sc1
    s_mov_b32 s3, 0x4800
    buffer_load_dwordx4 v[20:23], v0, s[36:39], s3 offen offset:1024 sc1
    s_mov_b32 s3, 0x4800
    buffer_load_dwordx4 v[24:27], v0, s[36:39], s3 offen offset:2048 sc1
    s_mov_b32 s3, 0x4800
    buffer_load_dwordx4 v[28:31], v0, s[36:39], s3 offen offset:3072 sc1
    s_mov_b32 s3, 0x4800
    buffer_load_dwordx4 v[32:35], v1, s[36:39], s3 offen sc1
    s_mov_b32 s3, 0x4800
    buffer_load_dwordx4 v[36:39], v1, s[36:39], s3 offen offset:1024 sc1
    s_mov_b32 s3, 0x4800
    buffer_load_dwordx4 v[40:43], v1, s[36:39], s3 offen offset:2048 sc1
    s_mov_b32 s3, 0x4800
    buffer_load_dwordx4 v[44:47], v1, s[36:39], s3 offen offset:3072 sc1
    s_mov_b32 s3, 0x6800
    buffer_load_dwordx4 v[48:51], v0, s[36:39], s3 offen sc1
    s_mov_b32 s3, 0
    buffer_load_dwordx4 v[52:55], v0, s[36:39], s3 offen sc1
    s_mov_b32 s3, 0
    buffer_load_dwordx4 v[56:59], v0, s[36:39], s3 offen offset:1024 sc1
    s_mov_b32 s3, 0
    buffer_load_dwordx4 v[60:63], v0, s[36:39], s3 offen offset:2048 sc1
P2S_bk0:
    s_waitcnt vmcnt(11)
    v_max_u32 v4, v16, v18
    s_waitcnt vmcnt(10)
    v_max3_u32 v4, v4, v20, v22
    s_waitcnt vmcnt(9)
    v_max3_u32 v4, v4, v24, v26
    s_waitcnt vmcnt(8)
    v_max3_u32 v4, v4, v28, v30
    s_waitcnt vmcnt(7)
    v_max3_u32 v4, v4, v32, v34
    s_waitcnt vmcnt(6)
    v_max3_u32 v4, v4, v36, v38
    s_waitcnt vmcnt(5)
    v_max3_u32 v4, v4, v40, v42
    s_waitcnt vmcnt(4)
    v_max3_u32 v4, v4, v44, v46
    s_waitcnt vmcnt(3)
    v_max3_u32 v4, v4, v48, v50
    v_cmp_eq_u32 vcc, -1, v4
    s_nop 4
    s_cbranch_vccnz P2S_rt0
P2S_bk0x:
    ds_read_b128 v[240:243], v3
    ds_read_b128 v[244:247], v3 offset:1024
    ds_read_b128 v[248:251], v3 offset:2048
    s_waitcnt lgkmcnt(2)
    v_mfma_f32_16x16x32_bf16 v[88:91], v[16:19], v[240:243], 0
    ds_read_b128 v[252:255], v3 offset:1024
    s_waitcnt lgkmcnt(2)
    v_mfma_f32_16x16x32_bf16 v[88:91], v[20:23], v[244:247], v[88:91]
    ds_read_b128 v[240:243], v3 offset:2048
    s_waitcnt lgkmcnt(2)
    v_mfma_f32_16x16x32_bf16 v[88:91], v[24:27], v[248:251], v[88:91]
    ds_read_b128 v[244:247], v3 offset:3072
    s_waitcnt lgkmcnt(2)
    v_mfma_f32_16x16x32_bf16 v[92:95], v[28:31], v[252:255], 0
    ds_read_b128 v[248:251], v3 offset:4096
    s_waitcnt lgkmcnt(2)
    v_mfma_f32_16x16x32_bf16 v[92:95], v[32:35], v[240:243], v[92:95]
    ds_read_b128 v[252:255], v3 offset:3072
    s_waitcnt lgkmcnt(2)
    v_mfma_f32_16x16x32_bf16 v[92:95], v[36:39], v[244:247], v[92:95]
    ds_read_b128 v[240:243], v3 offset:4096
    s_waitcnt lgkmcnt(2)
    v_mfma_f32_16x16x32_bf16 v[92:95], v[40:43], v[248:251], v[92:95]
    ds_read_b128 v[244:247], v3 offset:5120
    s_waitcnt lgkmcnt(2)
    v_mfma_f32_16x16x32_bf16 v[96:99], v[44:47], v[252:255], 0
    ds_read_b128 v[248:251], v3 offset:6144
    s_waitcnt lgkmcnt(2)
    v_mfma_f32_16x16x32_bf16 v[96:99], v[48:51], v[240:243], v[96:99]
    ds_read_b128 v[252:255], v3 offset:7168
    s_waitcnt lgkmcnt(2)
    v_mfma_f32_16x16x32_bf16 v[100:103], v[16:19], v[244:247], 0
    ds_read_b128 v[240:243], v3 offset:6144
    s_waitcnt lgkmcnt(2)
    v_mfma_f32_16x16x32_bf16 v[100:103], v[20:23], v[248:251], v[100:103]
    ds_read_b128 v[244:247], v3 offset:7168
    s_waitcnt lgkmcnt(2)
    v_mfma_f32_16x16x32_bf16 v[100:103], v[24:27], v[252:255], v[100:103]
    ds_read_b128 v[248:251], v3 offset:8192
    s_waitcnt lgkmcnt(2)
    v_mfma_f32_16x16x32_bf16 v[104:107], v[28:31], v[240:243], 0
    ds_read_b128 v[252:255], v3 offset:9216
    s_waitcnt lgkmcnt(2)
    v_mfma_f32_16x16x32_bf16 v[104:107], v[32:35], v[244:247], v[104:107]
    ds_read_b128 v[240:243], v3 offset:8192
    s_waitcnt lgkmcnt(2)
    v_mfma_f32_16x16x32_bf16 v[104:107], v[36:39], v[248:251], v[104:107]
    ds_read_b128 v[244:247], v3 offset:9216
    s_waitcnt lgkmcnt(2)
    v_mfma_f32_16x16x32_bf16 v[104:107], v[40:43], v[252:255], v[104:107]
    ds_read_b128 v[248:251], v3 offset:10240
    s_waitcnt lgkmcnt(2)
    v_mfma_f32_16x16x32_bf16 v[108:111], v[44:47], v[240:243], 0
    ds_read_b128 v[252:255], v3 offset:11264
    s_waitcnt lgkmcnt(2)
    v_mfma_f32_16x16x32_bf16 v[108:111], v[48:51], v[244:247], v[108:111]
    ds_read_b128 v[240:243], v3 offset:12288
    s_waitcnt lgkmcnt(2)
    v_mfma_f32_16x16x32_bf16 v[112:115], v[16:19], v[248:251], 0
    ds_read_b128 v[244:247], v3 offset:11264
    s_waitcnt lgkmcnt(2)
    v_mfma_f32_16x16x32_bf16 v[112:115], v[20:23], v[252:255], v[112:115]
    ds_read_b128 v[248:251], v3 offset:12288
    s_waitcnt lgkmcnt(2)
    v_mfma_f32_16x16x32_bf16 v[112:115], v[24:27], v[240:243], v[112:115]
    ds_read_b128 v[252:255], v3 offset:13312
    s_waitcnt lgkmcnt(2)
    v_mfma_f32_16x16x32_bf16 v[116:119], v[28:31], v[244:247], 0
    ds_read_b128 v[240:243], v3 offset:14336
    s_waitcnt lgkmcnt(2)
    v_mfma_f32_16x16x32_bf16 v[116:119], v[32:35], v[248:251], v[116:119]
    ds_read_b128 v[244:247], v3 offset:13312
    s_waitcnt lgkmcnt(2)
    v_mfma_f32_16x16x32_bf16 v[116:119], v[36:39], v[252:255], v[116:119]
    ds_read_b128 v[248:251], v3 offset:14336
    s_waitcnt lgkmcnt(2)
    v_mfma_f32_16x16x32_bf16 v[116:119], v[40:43], v[240:243], v[116:119]
    ds_read_b128 v[252:255], v3 offset:15360
    s_waitcnt lgkmcnt(2)
    v_mfma_f32_16x16x32_bf16 v[120:123], v[44:47], v[244:247], 0
    ds_read_b128 v[240:243], v3 offset:16384
    s_waitcnt lgkmcnt(2)
    v_mfma_f32_16x16x32_bf16 v[120:123], v[48:51], v[248:251], v[120:123]
    ds_read_b128 v[244:247], v3 offset:17408
    s_waitcnt lgkmcnt(2)
    v_mfma_f32_16x16x32_bf16 v[124:127], v[16:19], v[252:255], 0
    ds_read_b128 v[248:251], v3 offset:16384
    s_waitcnt lgkmcnt(2)
    v_mfma_f32_16x16x32_bf16 v[124:127], v[20:23], v[240:243], v[124:127]
    ds_read_b128 v[252:255], v3 offset:17408
    s_waitcnt lgkmcnt(2)
    v_mfma_f32_16x16x32_bf16 v[124:127], v[24:27], v[244:247], v[124:127]
    ds_read_b128 v[240:243], v3 offset:18432
    s_waitcnt lgkmcnt(2)
    v_mfma_f32_16x16x32_bf16 v[128:131], v[28:31], v[248:251], 0
    ds_read_b128 v[244:247], v3 offset:19456
    s_waitcnt lgkmcnt(2)
    v_mfma_f32_16x16x32_bf16 v[128:131], v[32:35], v[252:255], v[128:131]
    ds_read_b128 v[248:251], v3 offset:18432
    s_waitcnt lgkmcnt(2)
    v_mfma_f32_16x16x32_bf16 v[128:131], v[36:39], v[240:243], v[128:131]
    ds_read_b128 v[252:255], v3 offset:19456
    s_waitcnt lgkmcnt(2)
    v_mfma_f32_16x16x32_bf16 v[128:131], v[40:43], v[244:247], v[128:131]
    s_waitcnt lgkmcnt(1)
    v_mfma_f32_16x16x32_bf16 v[132:135], v[44:47], v[248:251], 0
    s_waitcnt lgkmcnt(0)
    v_mfma_f32_16x16x32_bf16 v[132:135], v[48:51], v[252:255], v[132:135]
    s_mov_b32 s3, 0xc00
    buffer_load_dwordx4 v[16:19], v0, s[36:39], s3 offen sc1
    s_mov_b32 s3, 0xc00
    buffer_load_dwordx4 v[20:23], v0, s[36:39], s3 offen offset:1024 sc1
    s_mov_b32 s3, 0xc00
    buffer_load_dwordx4 v[24:27], v0, s[36:39], s3 offen offset:2048 sc1
    s_mov_b32 s3, 0xc00
    buffer_load_dwordx4 v[28:31], v0, s[36:39], s3 offen offset:3072 sc1
    s_add_u32 s3, s51, 0xa000
    buffer_load_dwordx4 v[32:35], v0, s[28:31], s3 offen sc1
    s_add_u32 s3, s51, 0xa000
    buffer_load_dwordx4 v[36:39], v0, s[28:31], s3 offen offset:1024 sc1
    s_add_u32 s3, s51, 0xa000
    buffer_load_dwordx4 v[40:43], v0, s[28:31], s3 offen offset:2048 sc1
    s_add_u32 s3, s51, 0xa000
    buffer_load_dwordx4 v[44:47], v0, s[28:31], s3 offen offset:3072 sc1
    s_add_u32 s3, s51, 0xa000
    buffer_load_dwordx4 v[48:51], v1, s[28:31], s3 offen sc1
    v_add_f32 v88, 0x358637bd, v88
    v_add_f32 v89, 0x358637bd, v89
    v_add_f32 v90, 0x358637bd, v90
    v_add_f32 v91, 0x358637bd, v91
    v_add_f32 v92, 0x358637bd, v92
    v_add_f32 v93, 0x358637bd, v93
    v_add_f32 v94, 0x358637bd, v94
    v_add_f32 v95, 0x358637bd, v95
    v_add_f32 v96, 0x358637bd, v96
    v_add_f32 v97, 0x358637bd, v97
    v_rcp_f32 v88, v88
    v_rcp_f32 v89, v89
    v_rcp_f32 v90, v90
    v_rcp_f32 v91, v91
    v_rcp_f32 v92, v92
    v_rcp_f32 v93, v93
    v_rcp_f32 v94, v94
    v_rcp_f32 v95, v95
    v_rcp_f32 v96, v96
    v_rcp_f32 v97, v97
    v_add_f32 v100, 0x358637bd, v100
    v_add_f32 v101, 0x358637bd, v101
    v_add_f32 v102, 0x358637bd, v102
    v_add_f32 v103, 0x358637bd, v103
    v_add_f32 v104, 0x358637bd, v104
    v_add_f32 v105, 0x358637bd, v105
    v_add_f32 v106, 0x358637bd, v106
    v_add_f32 v107, 0x358637bd, v107
    v_add_f32 v108, 0x358637bd, v108
    v_add_f32 v109, 0x358637bd, v109
    v_rcp_f32 v100, v100
    v_rcp_f32 v101, v101
    v_rcp_f32 v102, v102
    v_rcp_f32 v103, v103
    v_rcp_f32 v104, v104
    v_rcp_f32 v105, v105
    v_rcp_f32 v106, v106
    v_rcp_f32 v107, v107
    v_rcp_f32 v108, v108
    v_rcp_f32 v109, v109
    v_add_f32 v112, 0x358637bd, v112
    v_add_f32 v113, 0x358637bd, v113
    v_add_f32 v114, 0x358637bd, v114
    v_add_f32 v115, 0x358637bd, v115
    v_add_f32 v116, 0x358637bd, v116
    v_add_f32 v117, 0x358637bd, v117
    v_add_f32 v118, 0x358637bd, v118
    v_add_f32 v119, 0x358637bd, v119
    v_add_f32 v120, 0x358637bd, v120
    v_add_f32 v121, 0x358637bd, v121
    v_rcp_f32 v112, v112
    v_rcp_f32 v113, v113
    v_rcp_f32 v114, v114
    v_rcp_f32 v115, v115
    v_rcp_f32 v116, v116
    v_rcp_f32 v117, v117
    v_rcp_f32 v118, v118
    v_rcp_f32 v119, v119
    v_rcp_f32 v120, v120
    v_rcp_f32 v121, v121
    v_add_f32 v124, 0x358637bd, v124
    v_add_f32 v125, 0x358637bd, v125
    v_add_f32 v126, 0x358637bd, v126
    v_add_f32 v127, 0x358637bd, v127
    v_add_f32 v128, 0x358637bd, v128
    v_add_f32 v129, 0x358637bd, v129
    v_add_f32 v130, 0x358637bd, v130
    v_add_f32 v131, 0x358637bd, v131
    v_add_f32 v132, 0x358637bd, v132
    v_add_f32 v133, 0x358637bd, v133
    v_rcp_f32 v124, v124
    v_rcp_f32 v125, v125
    v_rcp_f32 v126, v126
    v_rcp_f32 v127, v127
    v_rcp_f32 v128, v128
    v_rcp_f32 v129, v129
    v_rcp_f32 v130, v130
    v_rcp_f32 v131, v131
    v_rcp_f32 v132, v132
    v_rcp_f32 v133, v133
P2S_bk1:
    s_waitcnt vmcnt(11)
    v_max_u32 v4, v52, v54
    s_waitcnt vmcnt(10)
    v_max3_u32 v4, v4, v56, v58
    s_waitcnt vmcnt(9)
    v_max3_u32 v4, v4, v60, v62
    v_cmp_eq_u32 vcc, -1, v4
    s_nop 4
    s_cbranch_vccnz P2S_rt1
P2S_bk1x:
    ds_read_b128 v[240:243], v3
    ds_read_b128 v[244:247], v3
    ds_read_b128 v[248:251], v3 offset:1024
    s_waitcnt lgkmcnt(2)
    v_mfma_f32_16x16x32_bf16 v[136:139], v[52:55], v[240:243], 0
    ds_read_b128 v[252:255], v3 offset:5120
    s_waitcnt lgkmcnt(2)
    v_mfma_f32_16x16x32_bf16 v[140:143], v[56:59], v[244:247], 0
    ds_read_b128 v[240:243], v3 offset:5120
    s_waitcnt lgkmcnt(2)
    v_mfma_f32_16x16x32_bf16 v[140:143], v[60:63], v[248:251], v[140:143]
    ds_read_b128 v[244:247], v3 offset:6144
    s_waitcnt lgkmcnt(2)
    v_mfma_f32_16x16x32_bf16 v[144:147], v[52:55], v[252:255], 0
    ds_read_b128 v[248:251], v3 offset:10240
    s_waitcnt lgkmcnt(2)
    v_mfma_f32_16x16x32_bf16 v[148:151], v[56:59], v[240:243], 0
    ds_read_b128 v[252:255], v3 offset:10240
    s_waitcnt lgkmcnt(2)
    v_mfma_f32_16x16x32_bf16 v[148:151], v[60:63], v[244:247], v[148:151]
    ds_read_b128 v[240:243], v3 offset:11264
    s_waitcnt lgkmcnt(2)
    v_mfma_f32_16x16x32_bf16 v[152:155], v[52:55], v[248:251], 0
    s_waitcnt lgkmcnt(1)
    v_mfma_f32_16x16x32_bf16 v[156:159], v[56:59], v[252:255], 0
    s_waitcnt lgkmcnt(0)
    v_mfma_f32_16x16x32_bf16 v[156:159], v[60:63], v[240:243], v[156:159]
    v_mul_f32 v136, v88, v136
    v_mul_f32 v137, v88, v137
    v_mul_f32 v138, v88, v138
    v_mul_f32 v139, v88, v139
    v_mul_f32 v140, v89, v140
    v_mul_f32 v141, v89, v141
    v_mul_f32 v142, v89, v142
    v_mul_f32 v143, v89, v143
    v_cvt_pk_bf16_f32 v136, v136, v137
    v_cvt_pk_bf16_f32 v137, v138, v139
    v_cvt_pk_bf16_f32 v138, v140, v141
    v_cvt_pk_bf16_f32 v139, v142, v143
    s_nop 1
    v_mfma_f32_16x16x32_bf16 v[160:163], v[68:71], v[136:139], 0
    v_mul_f32 v144, v100, v144
    v_mul_f32 v145, v100, v145
    v_mul_f32 v146, v100, v146
    v_mfma_f32_16x16x32_bf16 v[164:167], v[72:75], v[136:139], 0
    v_mul_f32 v147, v100, v147
    v_mul_f32 v148, v101, v148
    v_mul_f32 v149, v101, v149
    v_mfma_f32_16x16x32_bf16 v[168:171], v[76:79], v[136:139], 0
    v_mul_f32 v150, v101, v150
    v_mul_f32 v151, v101, v151
    v_cvt_pk_bf16_f32 v144, v144, v145
    v_mfma_f32_16x16x32_bf16 v[172:175], v[80:83], v[136:139], 0
    v_cvt_pk_bf16_f32 v145, v146, v147
    v_cvt_pk_bf16_f32 v146, v148, v149
    v_cvt_pk_bf16_f32 v147, v150, v151
    v_mfma_f32_16x16x32_bf16 v[176:179], v[84:87], v[136:139], 0
    ds_read_b128 v[244:247], v3 offset:15360
    ds_read_b128 v[248:251], v3 offset:15360
    ds_read_b128 v[252:255], v3 offset:16384
    s_waitcnt lgkmcnt(2)
    v_mfma_f32_16x16x32_bf16 v[136:139], v[52:55], v[244:247], 0
    s_waitcnt lgkmcnt(1)
    v_mfma_f32_16x16x32_bf16 v[140:143], v[56:59], v[248:251], 0
    s_waitcnt lgkmcnt(0)
    v_mfma_f32_16x16x32_bf16 v[140:143], v[60:63], v[252:255], v[140:143]
    s_mov_b32 s3, 0x1c00
    buffer_load_dwordx4 v[52:55], v0, s[36:39], s3 offen sc1
    s_mov_b32 s3, 0x1c00
    buffer_load_dwordx4 v[56:59], v0, s[36:39], s3 offen offset:1024 sc1
    s_mov_b32 s3, 0x1c00
    buffer_load_dwordx4 v[60:63], v0, s[36:39], s3 offen offset:2048 sc1
    s_mov_b32 s3, 0x1c00
    buffer_load_dwordx4 v[64:67], v0, s[36:39], s3 offen offset:3072 sc1
    v_mfma_f32_16x16x32_bf16 v[180:183], v[68:71], v[144:147], 0
    v_mul_f32 v152, v112, v152
    v_mul_f32 v153, v112, v153
    v_mul_f32 v154, v112, v154
    v_mfma_f32_16x16x32_bf16 v[184:187], v[72:75], v[144:147], 0
    v_mul_f32 v155, v112, v155
    v_mul_f32 v156, v113, v156
    v_mul_f32 v157, v113, v157
    v_mfma_f32_16x16x32_bf16 v[188:191], v[76:79], v[144:147], 0
    v_mul_f32 v158, v113, v158
    v_mul_f32 v159, v113, v159
    v_cvt_pk_bf16_f32 v152, v152, v153
    v_mfma_f32_16x16x32_bf16 v[192:195], v[80:83], v[144:147], 0
    v_cvt_pk_bf16_f32 v153, v154, v155
    v_cvt_pk_bf16_f32 v154, v156, v157
    v_cvt_pk_bf16_f32 v155, v158, v159
    v_mfma_f32_16x16x32_bf16 v[196:199], v[84:87], v[144:147], 0
    s_nop 0
    v_mfma_f32_16x16x32_bf16 v[200:203], v[68:71], v[152:155], 0
    v_mul_f32 v136, v124, v136
    v_mul_f32 v137, v124, v137
    v_mul_f32 v138, v124, v138
    v_mfma_f32_16x16x32_bf16 v[204:207], v[72:75], v[152:155], 0
    v_mul_f32 v139, v124, v139
    v_mul_f32 v140, v125, v140
    v_mul_f32 v141, v125, v141
    v_mfma_f32_16x16x32_bf16 v[208:211], v[76:79], v[152:155], 0
    v_mul_f32 v142, v125, v142
    v_mul_f32 v143, v125, v143
    v_cvt_pk_bf16_f32 v136, v136, v137
    v_mfma_f32_16x16x32_bf16 v[212:215], v[80:83], v[152:155], 0
    v_cvt_pk_bf16_f32 v137, v138, v139
    v_cvt_pk_bf16_f32 v138, v140, v141
    v_cvt_pk_bf16_f32 v139, v142, v143
    v_mfma_f32_16x16x32_bf16 v[216:219], v[84:87], v[152:155], 0
    s_nop 0
    v_mfma_f32_16x16x32_bf16 v[220:223], v[68:71], v[136:139], 0
    v_mfma_f32_16x16x32_bf16 v[224:227], v[72:75], v[136:139], 0
    v_mfma_f32_16x16x32_bf16 v[228:231], v[76:79], v[136:139], 0
    v_mfma_f32_16x16x32_bf16 v[232:235], v[80:83], v[136:139], 0
    v_mfma_f32_16x16x32_bf16 v[236:239], v[84:87], v[136:139], 0
    s_add_u32 s3, s51, 0x14000
    buffer_load_dwordx4 v[68:71], v0, s[28:31], s3 offen sc1
    s_add_u32 s3, s51, 0x14000
    buffer_load_dwordx4 v[72:75], v0, s[28:31], s3 offen offset:1024 sc1
    s_add_u32 s3, s51, 0x14000
    buffer_load_dwordx4 v[76:79], v0, s[28:31], s3 offen offset:2048 sc1
    s_add_u32 s3, s51, 0x14000
    buffer_load_dwordx4 v[80:83], v0, s[28:31], s3 offen offset:3072 sc1
    s_add_u32 s3, s51, 0x14000
    buffer_load_dwordx4 v[84:87], v1, s[28:31], s3 offen sc1
P2S_bk2:
    s_waitcnt vmcnt(17)
    v_max_u32 v4, v16, v18
    s_waitcnt vmcnt(16)
    v_max3_u32 v4, v4, v20, v22
    s_waitcnt vmcnt(15)
    v_max3_u32 v4, v4, v24, v26
    s_waitcnt vmcnt(14)
    v_max3_u32 v4, v4, v28, v30
    v_cmp_eq_u32 vcc, -1, v4
    s_nop 4
    s_cbranch_vccnz P2S_rt2
P2S_bk2x:
    ds_read_b128 v[240:243], v3
    ds_read_b128 v[244:247], v3 offset:1024
    ds_read_b128 v[248:251], v3 offset:1024
    s_waitcnt lgkmcnt(2)
    v_mfma_f32_16x16x32_bf16 v[136:139], v[16:19], v[240:243], 0
    ds_read_b128 v[252:255], v3 offset:2048
    s_waitcnt lgkmcnt(2)
    v_mfma_f32_16x16x32_bf16 v[136:139], v[20:23], v[244:247], v[136:139]
    ds_read_b128 v[240:243], v3 offset:5120
    s_waitcnt lgkmcnt(2)
    v_mfma_f32_16x16x32_bf16 v[140:143], v[24:27], v[248:251], 0
    ds_read_b128 v[244:247], v3 offset:6144
    s_waitcnt lgkmcnt(2)
    v_mfma_f32_16x16x32_bf16 v[140:143], v[28:31], v[252:255], v[140:143]
    ds_read_b128 v[248:251], v3 offset:6144
    s_waitcnt lgkmcnt(2)
    v_mfma_f32_16x16x32_bf16 v[144:147], v[16:19], v[240:243], 0
    ds_read_b128 v[252:255], v3 offset:7168
    s_waitcnt lgkmcnt(2)
    v_mfma_f32_16x16x32_bf16 v[144:147], v[20:23], v[244:247], v[144:147]
    ds_read_b128 v[240:243], v3 offset:10240
    s_waitcnt lgkmcnt(2)
    v_mfma_f32_16x16x32_bf16 v[148:151], v[24:27], v[248:251], 0
    ds_read_b128 v[244:247], v3 offset:11264
    s_waitcnt lgkmcnt(2)
    v_mfma_f32_16x16x32_bf16 v[148:151], v[28:31], v[252:255], v[148:151]
    ds_read_b128 v[248:251], v3 offset:11264
    s_waitcnt lgkmcnt(2)
    v_mfma_f32_16x16x32_bf16 v[152:155], v[16:19], v[240:243], 0
    ds_read_b128 v[252:255], v3 offset:12288
    s_waitcnt lgkmcnt(2)
    v_mfma_f32_16x16x32_bf16 v[152:155], v[20:23], v[244:247], v[152:155]
    s_waitcnt lgkmcnt(1)
    v_mfma_f32_16x16x32_bf16 v[156:159], v[24:27], v[248:251], 0
    s_waitcnt lgkmcnt(0)
    v_mfma_f32_16x16x32_bf16 v[156:159], v[28:31], v[252:255], v[156:159]
    v_mul_f32 v136, v90, v136
    v_mul_f32 v137, v90, v137
    v_mul_f32 v138, v90, v138
    v_mul_f32 v139, v90, v139
    v_mul_f32 v140, v91, v140
    v_mul_f32 v141, v91, v141
    v_mul_f32 v142, v91, v142
    v_mul_f32 v143, v91, v143
    v_cvt_pk_bf16_f32 v136, v136, v137
    v_cvt_pk_bf16_f32 v137, v138, v139
    v_cvt_pk_bf16_f32 v138, v140, v141
    v_cvt_pk_bf16_f32 v139, v142, v143
    s_waitcnt vmcnt(13)
    s_nop 0
    v_mfma_f32_16x16x32_bf16 v[160:163], v[32:35], v[136:139], v[160:163]
    v_mul_f32 v144, v102, v144
    v_mul_f32 v145, v102, v145
    v_mul_f32 v146, v102, v146
    s_waitcnt vmcnt(12)
    v_mfma_f32_16x16x32_bf16 v[164:167], v[36:39], v[136:139], v[164:167]
    v_mul_f32 v147, v102, v147
    v_mul_f32 v148, v103, v148
    v_mul_f32 v149, v103, v149
    s_waitcnt vmcnt(11)
    v_mfma_f32_16x16x32_bf16 v[168:171], v[40:43], v[136:139], v[168:171]
    v_mul_f32 v150, v103, v150
    v_mul_f32 v151, v103, v151
    v_cvt_pk_bf16_f32 v144, v144, v145
    s_waitcnt vmcnt(10)
    v_mfma_f32_16x16x32_bf16 v[172:175], v[44:47], v[136:139], v[172:175]
    v_cvt_pk_bf16_f32 v145, v146, v147
    v_cvt_pk_bf16_f32 v146, v148, v149
    v_cvt_pk_bf16_f32 v147, v150, v151
    s_waitcnt vmcnt(9)
    v_mfma_f32_16x16x32_bf16 v[176:179], v[48:51], v[136:139], v[176:179]
    ds_read_b128 v[240:243], v3 offset:15360
    ds_read_b128 v[244:247], v3 offset:16384
    ds_read_b128 v[248:251], v3 offset:16384
    s_waitcnt lgkmcnt(2)
    v_mfma_f32_16x16x32_bf16 v[136:139], v[16:19], v[240:243], 0
    ds_read_b128 v[252:255], v3 offset:17408
    s_waitcnt lgkmcnt(2)
    v_mfma_f32_16x16x32_bf16 v[136:139], v[20:23], v[244:247], v[136:139]
    s_waitcnt lgkmcnt(1)
    v_mfma_f32_16x16x32_bf16 v[140:143], v[24:27], v[248:251], 0
    s_waitcnt lgkmcnt(0)
    v_mfma_f32_16x16x32_bf16 v[140:143], v[28:31], v[252:255], v[140:143]
    s_mov_b32 s3, 0x2c00
    buffer_load_dwordx4 v[16:19], v0, s[36:39], s3 offen sc1
    s_mov_b32 s3, 0x2c00
    buffer_load_dwordx4 v[20:23], v0, s[36:39], s3 offen offset:1024 sc1
    s_mov_b32 s3, 0x2c00
    buffer_load_dwordx4 v[24:27], v0, s[36:39], s3 offen offset:2048 sc1
    s_mov_b32 s3, 0x2c00
    buffer_load_dwordx4 v[28:31], v0, s[36:39], s3 offen offset:3072 sc1
    v_mfma_f32_16x16x32_bf16 v[180:183], v[32:35], v[144:147], v[180:183]
    v_mul_f32 v152, v114, v152
    v_mul_f32 v153, v114, v153
    v_mul_f32 v154, v114, v154
    v_mfma_f32_16x16x32_bf16 v[184:187], v[36:39], v[144:147], v[184:187]
    v_mul_f32 v155, v114, v155
    v_mul_f32 v156, v115, v156
    v_mul_f32 v157, v115, v157
    v_mfma_f32_16x16x32_bf16 v[188:191], v[40:43], v[144:147], v[188:191]
    v_mul_f32 v158, v115, v158
    v_mul_f32 v159, v115, v159
    v_cvt_pk_bf16_f32 v152, v152, v153
    v_mfma_f32_16x16x32_bf16 v[192:195], v[44:47], v[144:147], v[192:195]
    v_cvt_pk_bf16_f32 v153, v154, v155
    v_cvt_pk_bf16_f32 v154, v156, v157
    v_cvt_pk_bf16_f32 v155, v158, v159
    v_mfma_f32_16x16x32_bf16 v[196:199], v[48:51], v[144:147], v[196:199]
    s_nop 0
    v_mfma_f32_16x16x32_bf16 v[200:203], v[32:35], v[152:155], v[200:203]
    v_mul_f32 v136, v126, v136
    v_mul_f32 v137, v126, v137
    v_mul_f32 v138, v126, v138
    v_mfma_f32_16x16x32_bf16 v[204:207], v[36:39], v[152:155], v[204:207]
    v_mul_f32 v139, v126, v139
    v_mul_f32 v140, v127, v140
    v_mul_f32 v141, v127, v141
    v_mfma_f32_16x16x32_bf16 v[208:211], v[40:43], v[152:155], v[208:211]
    v_mul_f32 v142, v127, v142
    v_mul_f32 v143, v127, v143
    v_cvt_pk_bf16_f32 v136, v136, v137
    v_mfma_f32_16x16x32_bf16 v[212:215], v[44:47], v[152:155], v[212:215]
    v_cvt_pk_bf16_f32 v137, v138, v139
    v_cvt_pk_bf16_f32 v138, v140, v141
    v_cvt_pk_bf16_f32 v139, v142, v143
    v_mfma_f32_16x16x32_bf16 v[216:219], v[48:51], v[152:155], v[216:219]
    s_nop 0
    v_mfma_f32_16x16x32_bf16 v[220:223], v[32:35], v[136:139], v[220:223]
    v_mfma_f32_16x16x32_bf16 v[224:227], v[36:39], v[136:139], v[224:227]
    v_mfma_f32_16x16x32_bf16 v[228:231], v[40:43], v[136:139], v[228:231]
    v_mfma_f32_16x16x32_bf16 v[232:235], v[44:47], v[136:139], v[232:235]
    v_mfma_f32_16x16x32_bf16 v[236:239], v[48:51], v[136:139], v[236:239]
    s_add_u32 s3, s51, 0x1e000
    buffer_load_dwordx4 v[32:35], v0, s[28:31], s3 offen sc1
    s_add_u32 s3, s51, 0x1e000
    buffer_load_dwordx4 v[36:39], v0, s[28:31], s3 offen offset:1024 sc1
    s_add_u32 s3, s51, 0x1e000
    buffer_load_dwordx4 v[40:43], v0, s[28:31], s3 offen offset:2048 sc1
    s_add_u32 s3, s51, 0x1e000
    buffer_load_dwordx4 v[44:47], v0, s[28:31], s3 offen offset:3072 sc1
    s_add_u32 s3, s51, 0x1e000
    buffer_load_dwordx4 v[48:51], v1, s[28:31], s3 offen sc1
P2S_bk3:
    s_waitcnt vmcnt(17)
    v_max_u32 v4, v52, v54
    s_waitcnt vmcnt(16)
    v_max3_u32 v4, v4, v56, v58
    s_waitcnt vmcnt(15)
    v_max3_u32 v4, v4, v60, v62
    s_waitcnt vmcnt(14)
    v_max3_u32 v4, v4, v64, v66
    v_cmp_eq_u32 vcc, -1, v4
    s_nop 4
    s_cbranch_vccnz P2S_rt3
P2S_bk3x:
    ds_read_b128 v[240:243], v3 offset:1024
    ds_read_b128 v[244:247], v3 offset:2048
    ds_read_b128 v[248:251], v3 offset:2048
    s_waitcnt lgkmcnt(2)
    v_mfma_f32_16x16x32_bf16 v[136:139], v[52:55], v[240:243], 0
    ds_read_b128 v[252:255], v3 offset:3072
    s_waitcnt lgkmcnt(2)
    v_mfma_f32_16x16x32_bf16 v[136:139], v[56:59], v[244:247], v[136:139]
    ds_read_b128 v[240:243], v3 offset:6144
    s_waitcnt lgkmcnt(2)
    v_mfma_f32_16x16x32_bf16 v[140:143], v[60:63], v[248:251], 0
    ds_read_b128 v[244:247], v3 offset:7168
    s_waitcnt lgkmcnt(2)
    v_mfma_f32_16x16x32_bf16 v[140:143], v[64:67], v[252:255], v[140:143]
    ds_read_b128 v[248:251], v3 offset:7168
    s_waitcnt lgkmcnt(2)
    v_mfma_f32_16x16x32_bf16 v[144:147], v[52:55], v[240:243], 0
    ds_read_b128 v[252:255], v3 offset:8192
    s_waitcnt lgkmcnt(2)
    v_mfma_f32_16x16x32_bf16 v[144:147], v[56:59], v[244:247], v[144:147]
    ds_read_b128 v[240:243], v3 offset:11264
    s_waitcnt lgkmcnt(2)
    v_mfma_f32_16x16x32_bf16 v[148:151], v[60:63], v[248:251], 0
    ds_read_b128 v[244:247], v3 offset:12288
    s_waitcnt lgkmcnt(2)
    v_mfma_f32_16x16x32_bf16 v[148:151], v[64:67], v[252:255], v[148:151]
    ds_read_b128 v[248:251], v3 offset:12288
    s_waitcnt lgkmcnt(2)
    v_mfma_f32_16x16x32_bf16 v[152:155], v[52:55], v[240:243], 0
    ds_read_b128 v[252:255], v3 offset:13312
    s_waitcnt lgkmcnt(2)
    v_mfma_f32_16x16x32_bf16 v[152:155], v[56:59], v[244:247], v[152:155]
    s_waitcnt lgkmcnt(1)
    v_mfma_f32_16x16x32_bf16 v[156:159], v[60:63], v[248:251], 0
    s_waitcnt lgkmcnt(0)
    v_mfma_f32_16x16x32_bf16 v[156:159], v[64:67], v[252:255], v[156:159]
    v_mul_f32 v136, v92, v136
    v_mul_f32 v137, v92, v137
    v_mul_f32 v138, v92, v138
    v_mul_f32 v139, v92, v139
    v_mul_f32 v140, v93, v140
    v_mul_f32 v141, v93, v141
    v_mul_f32 v142, v93, v142
    v_mul_f32 v143, v93, v143
    v_cvt_pk_bf16_f32 v136, v136, v137
    v_cvt_pk_bf16_f32 v137, v138, v139
    v_cvt_pk_bf16_f32 v138, v140, v141
    v_cvt_pk_bf16_f32 v139, v142, v143
    s_waitcnt vmcnt(13)
    s_nop 0
    v_mfma_f32_16x16x32_bf16 v[160:163], v[68:71], v[136:139], v[160:163]
    v_mul_f32 v144, v104, v144
    v_mul_f32 v145, v104, v145
    v_mul_f32 v146, v104, v146
    s_waitcnt vmcnt(12)
    v_mfma_f32_16x16x32_bf16 v[164:167], v[72:75], v[136:139], v[164:167]
    v_mul_f32 v147, v104, v147
    v_mul_f32 v148, v105, v148
    v_mul_f32 v149, v105, v149
    s_waitcnt vmcnt(11)
    v_mfma_f32_16x16x32_bf16 v[168:171], v[76:79], v[136:139], v[168:171]
    v_mul_f32 v150, v105, v150
    v_mul_f32 v151, v105, v151
    v_cvt_pk_bf16_f32 v144, v144, v145
    s_waitcnt vmcnt(10)
    v_mfma_f32_16x16x32_bf16 v[172:175], v[80:83], v[136:139], v[172:175]
    v_cvt_pk_bf16_f32 v145, v146, v147
    v_cvt_pk_bf16_f32 v146, v148, v149
    v_cvt_pk_bf16_f32 v147, v150, v151
    s_waitcnt vmcnt(9)
    v_mfma_f32_16x16x32_bf16 v[176:179], v[84:87], v[136:139], v[176:179]
    ds_read_b128 v[240:243], v3 offset:16384
    ds_read_b128 v[244:247], v3 offset:17408
    ds_read_b128 v[248:251], v3 offset:17408
    s_waitcnt lgkmcnt(2)
    v_mfma_f32_16x16x32_bf16 v[136:139], v[52:55], v[240:243], 0
    ds_read_b128 v[252:255], v3 offset:18432
    s_waitcnt lgkmcnt(2)
    v_mfma_f32_16x16x32_bf16 v[136:139], v[56:59], v[244:247], v[136:139]
    s_waitcnt lgkmcnt(1)
    v_mfma_f32_16x16x32_bf16 v[140:143], v[60:63], v[248:251], 0
    s_waitcnt lgkmcnt(0)
    v_mfma_f32_16x16x32_bf16 v[140:143], v[64:67], v[252:255], v[140:143]
    s_mov_b32 s3, 0x3c00
    buffer_load_dwordx4 v[52:55], v0, s[36:39], s3 offen sc1
    s_mov_b32 s3, 0x3c00
    buffer_load_dwordx4 v[56:59], v0, s[36:39], s3 offen offset:1024 sc1
    s_mov_b32 s3, 0x3c00
    buffer_load_dwordx4 v[60:63], v0, s[36:39], s3 offen offset:2048 sc1
    v_mfma_f32_16x16x32_bf16 v[180:183], v[68:71], v[144:147], v[180:183]
    v_mul_f32 v152, v116, v152
    v_mul_f32 v153, v116, v153
    v_mul_f32 v154, v116, v154
    v_mfma_f32_16x16x32_bf16 v[184:187], v[72:75], v[144:147], v[184:187]
    v_mul_f32 v155, v116, v155
    v_mul_f32 v156, v117, v156
    v_mul_f32 v157, v117, v157
    v_mfma_f32_16x16x32_bf16 v[188:191], v[76:79], v[144:147], v[188:191]
    v_mul_f32 v158, v117, v158
    v_mul_f32 v159, v117, v159
    v_cvt_pk_bf16_f32 v152, v152, v153
    v_mfma_f32_16x16x32_bf16 v[192:195], v[80:83], v[144:147], v[192:195]
    v_cvt_pk_bf16_f32 v153, v154, v155
    v_cvt_pk_bf16_f32 v154, v156, v157
    v_cvt_pk_bf16_f32 v155, v158, v159
    v_mfma_f32_16x16x32_bf16 v[196:199], v[84:87], v[144:147], v[196:199]
    s_nop 0
    v_mfma_f32_16x16x32_bf16 v[200:203], v[68:71], v[152:155], v[200:203]
    v_mul_f32 v136, v128, v136
    v_mul_f32 v137, v128, v137
    v_mul_f32 v138, v128, v138
    v_mfma_f32_16x16x32_bf16 v[204:207], v[72:75], v[152:155], v[204:207]
    v_mul_f32 v139, v128, v139
    v_mul_f32 v140, v129, v140
    v_mul_f32 v141, v129, v141
    v_mfma_f32_16x16x32_bf16 v[208:211], v[76:79], v[152:155], v[208:211]
    v_mul_f32 v142, v129, v142
    v_mul_f32 v143, v129, v143
    v_cvt_pk_bf16_f32 v136, v136, v137
    v_mfma_f32_16x16x32_bf16 v[212:215], v[80:83], v[152:155], v[212:215]
    v_cvt_pk_bf16_f32 v137, v138, v139
    v_cvt_pk_bf16_f32 v138, v140, v141
    v_cvt_pk_bf16_f32 v139, v142, v143
    v_mfma_f32_16x16x32_bf16 v[216:219], v[84:87], v[152:155], v[216:219]
    s_nop 0
    v_mfma_f32_16x16x32_bf16 v[220:223], v[68:71], v[136:139], v[220:223]
    v_mfma_f32_16x16x32_bf16 v[224:227], v[72:75], v[136:139], v[224:227]
    v_mfma_f32_16x16x32_bf16 v[228:231], v[76:79], v[136:139], v[228:231]
    v_mfma_f32_16x16x32_bf16 v[232:235], v[80:83], v[136:139], v[232:235]
    v_mfma_f32_16x16x32_bf16 v[236:239], v[84:87], v[136:139], v[236:239]
    s_add_u32 s3, s51, 0x28000
    buffer_load_dwordx4 v[68:71], v0, s[28:31], s3 offen sc1
    s_add_u32 s3, s51, 0x28000
    buffer_load_dwordx4 v[72:75], v0, s[28:31], s3 offen offset:1024 sc1
    s_add_u32 s3, s51, 0x28000
    buffer_load_dwordx4 v[76:79], v0, s[28:31], s3 offen offset:2048 sc1
    s_add_u32 s3, s51, 0x28000
    buffer_load_dwordx4 v[80:83], v0, s[28:31], s3 offen offset:3072 sc1
    s_add_u32 s3, s51, 0x28000
    buffer_load_dwordx4 v[84:87], v1, s[28:31], s3 offen sc1
P2S_bk4:
    s_waitcnt vmcnt(16)
    v_max_u32 v4, v16, v18
    s_waitcnt vmcnt(15)
    v_max3_u32 v4, v4, v20, v22
    s_waitcnt vmcnt(14)
    v_max3_u32 v4, v4, v24, v26
    s_waitcnt vmcnt(13)
    v_max3_u32 v4, v4, v28, v30
    v_cmp_eq_u32 vcc, -1, v4
    s_nop 4
    s_cbranch_vccnz P2S_rt4
P2S_bk4x:
    ds_read_b128 v[240:243], v3 offset:2048
    ds_read_b128 v[244:247], v3 offset:3072
    ds_read_b128 v[248:251], v3 offset:3072
    s_waitcnt lgkmcnt(2)
    v_mfma_f32_16x16x32_bf16 v[136:139], v[16:19], v[240:243], 0
    ds_read_b128 v[252:255], v3 offset:4096
    s_waitcnt lgkmcnt(2)
    v_mfma_f32_16x16x32_bf16 v[136:139], v[20:23], v[244:247], v[136:139]
    ds_read_b128 v[240:243], v3 offset:7168
    s_waitcnt lgkmcnt(2)
    v_mfma_f32_16x16x32_bf16 v[140:143], v[24:27], v[248:251], 0
    ds_read_b128 v[244:247], v3 offset:8192
    s_waitcnt lgkmcnt(2)
    v_mfma_f32_16x16x32_bf16 v[140:143], v[28:31], v[252:255], v[140:143]
    ds_read_b128 v[248:251], v3 offset:8192
    s_waitcnt lgkmcnt(2)
    v_mfma_f32_16x16x32_bf16 v[144:147], v[16:19], v[240:243], 0
    ds_read_b128 v[252:255], v3 offset:9216
    s_waitcnt lgkmcnt(2)
    v_mfma_f32_16x16x32_bf16 v[144:147], v[20:23], v[244:247], v[144:147]
    ds_read_b128 v[240:243], v3 offset:12288
    s_waitcnt lgkmcnt(2)
    v_mfma_f32_16x16x32_bf16 v[148:151], v[24:27], v[248:251], 0
    ds_read_b128 v[244:247], v3 offset:13312
    s_waitcnt lgkmcnt(2)
    v_mfma_f32_16x16x32_bf16 v[148:151], v[28:31], v[252:255], v[148:151]
    ds_read_b128 v[248:251], v3 offset:13312
    s_waitcnt lgkmcnt(2)
    v_mfma_f32_16x16x32_bf16 v[152:155], v[16:19], v[240:243], 0
    ds_read_b128 v[252:255], v3 offset:14336
    s_waitcnt lgkmcnt(2)
    v_mfma_f32_16x16x32_bf16 v[152:155], v[20:23], v[244:247], v[152:155]
    s_waitcnt lgkmcnt(1)
    v_mfma_f32_16x16x32_bf16 v[156:159], v[24:27], v[248:251], 0
    s_waitcnt lgkmcnt(0)
    v_mfma_f32_16x16x32_bf16 v[156:159], v[28:31], v[252:255], v[156:159]
    v_mul_f32 v136, v94, v136
    v_mul_f32 v137, v94, v137
    v_mul_f32 v138, v94, v138
    v_mul_f32 v139, v94, v139
    v_mul_f32 v140, v95, v140
    v_mul_f32 v141, v95, v141
    v_mul_f32 v142, v95, v142
    v_mul_f32 v143, v95, v143
    v_cvt_pk_bf16_f32 v136, v136, v137
    v_cvt_pk_bf16_f32 v137, v138, v139
    v_cvt_pk_bf16_f32 v138, v140, v141
    v_cvt_pk_bf16_f32 v139, v142, v143
    s_waitcnt vmcnt(12)
    s_nop 0
    v_mfma_f32_16x16x32_bf16 v[160:163], v[32:35], v[136:139], v[160:163]
    v_mul_f32 v144, v106, v144
    v_mul_f32 v145, v106, v145
    v_mul_f32 v146, v106, v146
    s_waitcnt vmcnt(11)
    v_mfma_f32_16x16x32_bf16 v[164:167], v[36:39], v[136:139], v[164:167]
    v_mul_f32 v147, v106, v147
    v_mul_f32 v148, v107, v148
    v_mul_f32 v149, v107, v149
    s_waitcnt vmcnt(10)
    v_mfma_f32_16x16x32_bf16 v[168:171], v[40:43], v[136:139], v[168:171]
    v_mul_f32 v150, v107, v150
    v_mul_f32 v151, v107, v151
    v_cvt_pk_bf16_f32 v144, v144, v145
    s_waitcnt vmcnt(9)
    v_mfma_f32_16x16x32_bf16 v[172:175], v[44:47], v[136:139], v[172:175]
    v_cvt_pk_bf16_f32 v145, v146, v147
    v_cvt_pk_bf16_f32 v146, v148, v149
    v_cvt_pk_bf16_f32 v147, v150, v151
    s_waitcnt vmcnt(8)
    v_mfma_f32_16x16x32_bf16 v[176:179], v[48:51], v[136:139], v[176:179]
    ds_read_b128 v[240:243], v3 offset:17408
    ds_read_b128 v[244:247], v3 offset:18432
    ds_read_b128 v[248:251], v3 offset:18432
    s_waitcnt lgkmcnt(2)
    v_mfma_f32_16x16x32_bf16 v[136:139], v[16:19], v[240:243], 0
    ds_read_b128 v[252:255], v3 offset:19456
    s_waitcnt lgkmcnt(2)
    v_mfma_f32_16x16x32_bf16 v[136:139], v[20:23], v[244:247], v[136:139]
    s_waitcnt lgkmcnt(1)
    v_mfma_f32_16x16x32_bf16 v[140:143], v[24:27], v[248:251], 0
    s_waitcnt lgkmcnt(0)
    v_mfma_f32_16x16x32_bf16 v[140:143], v[28:31], v[252:255], v[140:143]
    v_mfma_f32_16x16x32_bf16 v[180:183], v[32:35], v[144:147], v[180:183]
    v_mul_f32 v152, v118, v152
    v_mul_f32 v153, v118, v153
    v_mul_f32 v154, v118, v154
    v_mfma_f32_16x16x32_bf16 v[184:187], v[36:39], v[144:147], v[184:187]
    v_mul_f32 v155, v118, v155
    v_mul_f32 v156, v119, v156
    v_mul_f32 v157, v119, v157
    v_mfma_f32_16x16x32_bf16 v[188:191], v[40:43], v[144:147], v[188:191]
    v_mul_f32 v158, v119, v158
    v_mul_f32 v159, v119, v159
    v_cvt_pk_bf16_f32 v152, v152, v153
    v_mfma_f32_16x16x32_bf16 v[192:195], v[44:47], v[144:147], v[192:195]
    v_cvt_pk_bf16_f32 v153, v154, v155
    v_cvt_pk_bf16_f32 v154, v156, v157
    v_cvt_pk_bf16_f32 v155, v158, v159
    v_mfma_f32_16x16x32_bf16 v[196:199], v[48:51], v[144:147], v[196:199]
    s_nop 0
    v_mfma_f32_16x16x32_bf16 v[200:203], v[32:35], v[152:155], v[200:203]
    v_mul_f32 v136, v130, v136
    v_mul_f32 v137, v130, v137
    v_mul_f32 v138, v130, v138
    v_mfma_f32_16x16x32_bf16 v[204:207], v[36:39], v[152:155], v[204:207]
    v_mul_f32 v139, v130, v139
    v_mul_f32 v140, v131, v140
    v_mul_f32 v141, v131, v141
    v_mfma_f32_16x16x32_bf16 v[208:211], v[40:43], v[152:155], v[208:211]
    v_mul_f32 v142, v131, v142
    v_mul_f32 v143, v131, v143
    v_cvt_pk_bf16_f32 v136, v136, v137
    v_mfma_f32_16x16x32_bf16 v[212:215], v[44:47], v[152:155], v[212:215]
    v_cvt_pk_bf16_f32 v137, v138, v139
    v_cvt_pk_bf16_f32 v138, v140, v141
    v_cvt_pk_bf16_f32 v139, v142, v143
    v_mfma_f32_16x16x32_bf16 v[216:219], v[48:51], v[152:155], v[216:219]
    s_nop 0
    v_mfma_f32_16x16x32_bf16 v[220:223], v[32:35], v[136:139], v[220:223]
    v_mfma_f32_16x16x32_bf16 v[224:227], v[36:39], v[136:139], v[224:227]
    v_mfma_f32_16x16x32_bf16 v[228:231], v[40:43], v[136:139], v[228:231]
    v_mfma_f32_16x16x32_bf16 v[232:235], v[44:47], v[136:139], v[232:235]
    v_mfma_f32_16x16x32_bf16 v[236:239], v[48:51], v[136:139], v[236:239]
P2S_bk5:
    s_waitcnt vmcnt(7)
    v_max_u32 v4, v52, v54
    s_waitcnt vmcnt(6)
    v_max3_u32 v4, v4, v56, v58
    s_waitcnt vmcnt(5)
    v_max3_u32 v4, v4, v60, v62
    v_cmp_eq_u32 vcc, -1, v4
    s_nop 4
    s_cbranch_vccnz P2S_rt5
P2S_bk5x:
    ds_read_b128 v[240:243], v3 offset:3072
    ds_read_b128 v[244:247], v3 offset:4096
    ds_read_b128 v[248:251], v3 offset:4096
    s_waitcnt lgkmcnt(2)
    v_mfma_f32_16x16x32_bf16 v[136:139], v[52:55], v[240:243], 0
    ds_read_b128 v[252:255], v3 offset:8192
    s_waitcnt lgkmcnt(2)
    v_mfma_f32_16x16x32_bf16 v[136:139], v[56:59], v[244:247], v[136:139]
    ds_read_b128 v[240:243], v3 offset:9216
    s_waitcnt lgkmcnt(2)
    v_mfma_f32_16x16x32_bf16 v[140:143], v[60:63], v[248:251], 0
    ds_read_b128 v[244:247], v3 offset:9216
    s_waitcnt lgkmcnt(2)
    v_mfma_f32_16x16x32_bf16 v[144:147], v[52:55], v[252:255], 0
    ds_read_b128 v[248:251], v3 offset:13312
    s_waitcnt lgkmcnt(2)
    v_mfma_f32_16x16x32_bf16 v[144:147], v[56:59], v[240:243], v[144:147]
    ds_read_b128 v[252:255], v3 offset:14336
    s_waitcnt lgkmcnt(2)
    v_mfma_f32_16x16x32_bf16 v[148:151], v[60:63], v[244:247], 0
    ds_read_b128 v[240:243], v3 offset:14336
    s_waitcnt lgkmcnt(2)
    v_mfma_f32_16x16x32_bf16 v[152:155], v[52:55], v[248:251], 0
    s_waitcnt lgkmcnt(1)
    v_mfma_f32_16x16x32_bf16 v[152:155], v[56:59], v[252:255], v[152:155]
    s_waitcnt lgkmcnt(0)
    v_mfma_f32_16x16x32_bf16 v[156:159], v[60:63], v[240:243], 0
    v_mul_f32 v136, v96, v136
    v_mul_f32 v137, v96, v137
    v_mul_f32 v138, v96, v138
    v_mul_f32 v139, v96, v139
    v_mul_f32 v140, v97, v140
    v_mul_f32 v141, v97, v141
    v_mul_f32 v142, v97, v142
    v_mul_f32 v143, v97, v143
    v_cvt_pk_bf16_f32 v136, v136, v137
    v_cvt_pk_bf16_f32 v137, v138, v139
    v_cvt_pk_bf16_f32 v138, v140, v141
    v_cvt_pk_bf16_f32 v139, v142, v143
    s_waitcnt vmcnt(4)
    s_nop 0
    v_mfma_f32_16x16x32_bf16 v[160:163], v[68:71], v[136:139], v[160:163]
    v_mul_f32 v144, v108, v144
    v_mul_f32 v145, v108, v145
    v_mul_f32 v146, v108, v146
    s_waitcnt vmcnt(3)
    v_mfma_f32_16x16x32_bf16 v[164:167], v[72:75], v[136:139], v[164:167]
    v_mul_f32 v147, v108, v147
    v_mul_f32 v148, v109, v148
    v_mul_f32 v149, v109, v149
    s_waitcnt vmcnt(2)
    v_mfma_f32_16x16x32_bf16 v[168:171], v[76:79], v[136:139], v[168:171]
    v_mul_f32 v150, v109, v150
    v_mul_f32 v151, v109, v151
    v_cvt_pk_bf16_f32 v144, v144, v145
    s_waitcnt vmcnt(1)
    v_mfma_f32_16x16x32_bf16 v[172:175], v[80:83], v[136:139], v[172:175]
    v_cvt_pk_bf16_f32 v145, v146, v147
    v_cvt_pk_bf16_f32 v146, v148, v149
    v_cvt_pk_bf16_f32 v147, v150, v151
    s_waitcnt vmcnt(0)
    v_mfma_f32_16x16x32_bf16 v[176:179], v[84:87], v[136:139], v[176:179]
    ds_read_b128 v[244:247], v3 offset:18432
    ds_read_b128 v[248:251], v3 offset:19456
    ds_read_b128 v[252:255], v3 offset:19456
    s_waitcnt lgkmcnt(2)
    v_mfma_f32_16x16x32_bf16 v[136:139], v[52:55], v[244:247], 0
    s_waitcnt lgkmcnt(1)
    v_mfma_f32_16x16x32_bf16 v[136:139], v[56:59], v[248:251], v[136:139]
    s_waitcnt lgkmcnt(0)
    v_mfma_f32_16x16x32_bf16 v[140:143], v[60:63], v[252:255], 0
    v_mfma_f32_16x16x32_bf16 v[180:183], v[68:71], v[144:147], v[180:183]
    v_mul_f32 v152, v120, v152
    v_mul_f32 v153, v120, v153
    v_mul_f32 v154, v120, v154
    v_mfma_f32_16x16x32_bf16 v[184:187], v[72:75], v[144:147], v[184:187]
    v_mul_f32 v155, v120, v155
    v_mul_f32 v156, v121, v156
    v_mul_f32 v157, v121, v157
    v_mfma_f32_16x16x32_bf16 v[188:191], v[76:79], v[144:147], v[188:191]
    v_mul_f32 v158, v121, v158
    v_mul_f32 v159, v121, v159
    v_cvt_pk_bf16_f32 v152, v152, v153
    v_mfma_f32_16x16x32_bf16 v[192:195], v[80:83], v[144:147], v[192:195]
    v_cvt_pk_bf16_f32 v153, v154, v155
    v_cvt_pk_bf16_f32 v154, v156, v157
    v_cvt_pk_bf16_f32 v155, v158, v159
    v_mfma_f32_16x16x32_bf16 v[196:199], v[84:87], v[144:147], v[196:199]
    s_nop 0
    v_mfma_f32_16x16x32_bf16 v[200:203], v[68:71], v[152:155], v[200:203]
    v_mul_f32 v136, v132, v136
    v_mul_f32 v137, v132, v137
    v_mul_f32 v138, v132, v138
    v_mfma_f32_16x16x32_bf16 v[204:207], v[72:75], v[152:155], v[204:207]
    v_mul_f32 v139, v132, v139
    v_mul_f32 v140, v133, v140
    v_mul_f32 v141, v133, v141
    v_mfma_f32_16x16x32_bf16 v[208:211], v[76:79], v[152:155], v[208:211]
    v_mul_f32 v142, v133, v142
    v_mul_f32 v143, v133, v143
    v_cvt_pk_bf16_f32 v136, v136, v137
    v_mfma_f32_16x16x32_bf16 v[212:215], v[80:83], v[152:155], v[212:215]
    v_cvt_pk_bf16_f32 v137, v138, v139
    v_cvt_pk_bf16_f32 v138, v140, v141
    v_cvt_pk_bf16_f32 v139, v142, v143
    v_mfma_f32_16x16x32_bf16 v[216:219], v[84:87], v[152:155], v[216:219]
    s_nop 0
    v_mfma_f32_16x16x32_bf16 v[220:223], v[68:71], v[136:139], v[220:223]
    v_mfma_f32_16x16x32_bf16 v[224:227], v[72:75], v[136:139], v[224:227]
    v_mfma_f32_16x16x32_bf16 v[228:231], v[76:79], v[136:139], v[228:231]
    v_mfma_f32_16x16x32_bf16 v[232:235], v[80:83], v[136:139], v[232:235]
    v_mfma_f32_16x16x32_bf16 v[236:239], v[84:87], v[136:139], v[236:239]
    ds_write_b128 v3, v[160:163]
    ds_write_b128 v3, v[164:167] offset:1024
    ds_write_b128 v3, v[168:171] offset:2048
    ds_write_b128 v3, v[172:175] offset:3072
    ds_write_b128 v3, v[176:179] offset:4096
    ds_write_b128 v3, v[180:183] offset:5120
    ds_write_b128 v3, v[184:187] offset:6144
    ds_write_b128 v3, v[188:191] offset:7168
    ds_write_b128 v3, v[192:195] offset:8192
    ds_write_b128 v3, v[196:199] offset:9216
    ds_write_b128 v3, v[200:203] offset:10240
    ds_write_b128 v3, v[204:207] offset:11264
    ds_write_b128 v3, v[208:211] offset:12288
    ds_write_b128 v3, v[212:215] offset:13312
    ds_write_b128 v3, v[216:219] offset:14336
    ds_write_b128 v3, v[220:223] offset:15360
    ds_write_b128 v3, v[224:227] offset:16384
    ds_write_b128 v3, v[228:231] offset:17408
    ds_write_b128 v3, v[232:235] offset:18432
    ds_write_b128 v3, v[236:239] offset:19456
    s_waitcnt lgkmcnt(0)
    s_barrier
    s_endpgm
P2S_kr:
    s_sleep 2
    s_add_u32 s56, s56, 1
    s_cmp_gt_u32 s56, 16384
    s_cbranch_scc1 P2S_kx
    buffer_load_dwordx4 v[136:139], v101, s[52:55], 0 offen sc1
    s_waitcnt vmcnt(0)
    s_branch P2S_kb
P2S_rt0:
    s_sleep 2
    s_add_u32 s56, s56, 1
    s_cmp_gt_u32 s56, 16384
    s_cbranch_scc1 P2S_bk0x
    s_mov_b32 s3, 0x4800
    buffer_load_dwordx4 v[16:19], v0, s[36:39], s3 offen sc1
    s_mov_b32 s3, 0x4800
    buffer_load_dwordx4 v[20:23], v0, s[36:39], s3 offen offset:1024 sc1
    s_mov_b32 s3, 0x4800
    buffer_load_dwordx4 v[24:27], v0, s[36:39], s3 offen offset:2048 sc1
    s_mov_b32 s3, 0x4800
    buffer_load_dwordx4 v[28:31], v0, s[36:39], s3 offen offset:3072 sc1
    s_mov_b32 s3, 0x4800
    buffer_load_dwordx4 v[32:35], v1, s[36:39], s3 offen sc1
    s_mov_b32 s3, 0x4800
    buffer_load_dwordx4 v[36:39], v1, s[36:39], s3 offen offset:1024 sc1
    s_mov_b32 s3, 0x4800
    buffer_load_dwordx4 v[40:43], v1, s[36:39], s3 offen offset:2048 sc1
    s_mov_b32 s3, 0x4800
    buffer_load_dwordx4 v[44:47], v1, s[36:39], s3 offen offset:3072 sc1
    s_mov_b32 s3, 0x6800
    buffer_load_dwordx4 v[48:51], v0, s[36:39], s3 offen sc1
    s_waitcnt vmcnt(0)
    s_branch P2S_bk0
P2S_rt1:
    s_sleep 2
    s_add_u32 s56, s56, 1
    s_cmp_gt_u32 s56, 16384
    s_cbranch_scc1 P2S_bk1x
    s_mov_b32 s3, 0
    buffer_load_dwordx4 v[52:55], v0, s[36:39], s3 offen sc1
    s_mov_b32 s3, 0
    buffer_load_dwordx4 v[56:59], v0, s[36:39], s3 offen offset:1024 sc1
    s_mov_b32 s3, 0
    buffer_load_dwordx4 v[60:63], v0, s[36:39], s3 offen offset:2048 sc1
    s_waitcnt vmcnt(0)
    s_branch P2S_bk1
P2S_rt2:
    s_sleep 2
    s_add_u32 s56, s56, 1
    s_cmp_gt_u32 s56, 16384
    s_cbranch_scc1 P2S_bk2x
    s_mov_b32 s3, 0xc00
    buffer_load_dwordx4 v[16:19], v0, s[36:39], s3 offen sc1
    s_mov_b32 s3, 0xc00
    buffer_load_dwordx4 v[20:23], v0, s[36:39], s3 offen offset:1024 sc1
    s_mov_b32 s3, 0xc00
    buffer_load_dwordx4 v[24:27], v0, s[36:39], s3 offen offset:2048 sc1
    s_mov_b32 s3, 0xc00
    buffer_load_dwordx4 v[28:31], v0, s[36:39], s3 offen offset:3072 sc1
    s_waitcnt vmcnt(0)
    s_branch P2S_bk2
P2S_rt3:
    s_sleep 2
    s_add_u32 s56, s56, 1
    s_cmp_gt_u32 s56, 16384
    s_cbranch_scc1 P2S_bk3x
    s_mov_b32 s3, 0x1c00
    buffer_load_dwordx4 v[52:55], v0, s[36:39], s3 offen sc1
    s_mov_b32 s3, 0x1c00
    buffer_load_dwordx4 v[56:59], v0, s[36:39], s3 offen offset:1024 sc1
    s_mov_b32 s3, 0x1c00
    buffer_load_dwordx4 v[60:63], v0, s[36:39], s3 offen offset:2048 sc1
    s_mov_b32 s3, 0x1c00
    buffer_load_dwordx4 v[64:67], v0, s[36:39], s3 offen offset:3072 sc1
    s_waitcnt vmcnt(0)
    s_branch P2S_bk3
P2S_rt4:
    s_sleep 2
    s_add_u32 s56, s56, 1
    s_cmp_gt_u32 s56, 16384
    s_cbranch_scc1 P2S_bk4x
    s_mov_b32 s3, 0x2c00
    buffer_load_dwordx4 v[16:19], v0, s[36:39], s3 offen sc1
    s_mov_b32 s3, 0x2c00
    buffer_load_dwordx4 v[20:23], v0, s[36:39], s3 offen offset:1024 sc1
    s_mov_b32 s3, 0x2c00
    buffer_load_dwordx4 v[24:27], v0, s[36:39], s3 offen offset:2048 sc1
    s_mov_b32 s3, 0x2c00
    buffer_load_dwordx4 v[28:31], v0, s[36:39], s3 offen offset:3072 sc1
    s_waitcnt vmcnt(0)
    s_branch P2S_bk4
P2S_rt5:
    s_sleep 2
    s_add_u32 s56, s56, 1
    s_cmp_gt_u32 s56, 16384
    s_cbranch_scc1 P2S_bk5x
    s_mov_b32 s3, 0x3c00
    buffer_load_dwordx4 v[52:55], v0, s[36:39], s3 offen sc1
    s_mov_b32 s3, 0x3c00
    buffer_load_dwordx4 v[56:59], v0, s[36:39], s3 offen offset:1024 sc1
    s_mov_b32 s3, 0x3c00
    buffer_load_dwordx4 v[60:63], v0, s[36:39], s3 offen offset:2048 sc1
    s_waitcnt vmcnt(0)
    s_branch P2S_bk5
P2_end:
    s_endpgm

.section .rodata,"a"
.p2align 6
.amdhsa_kernel recurrent_scan__linear_attn_block__glu_gated_geglu__prompt_kernel
  .amdhsa_next_free_vgpr 256
  .amdhsa_next_free_sgpr 102
  .amdhsa_accum_offset 256
  .amdhsa_group_segment_fixed_size 0
  .amdhsa_kernarg_size 80
  .amdhsa_user_sgpr_count 2
  .amdhsa_user_sgpr_kernarg_segment_ptr 1
  .amdhsa_system_sgpr_workgroup_id_x 1
.end_amdhsa_kernel
```
